```python
import torch

def _softmax(x, axis=-1):
    return torch.softmax(x, dim=axis)

def _gelu(x):
    return torch.nn.functional.gelu(x, approximate='tanh')

def _silu(x):
    return torch.nn.functional.silu(x)

def _sigmoid(x):
    return torch.sigmoid(x)

def _layernorm(x, axis=-1, eps=1e-05):
    m = x.mean(dim=axis, keepdim=True)
    v = x.var(dim=axis, keepdim=True, unbiased=False)
    return (x - m) / torch.sqrt(v + eps)

def _scatter_add(tgt, idx, src, axis=0):
    return tgt.clone().index_add_(axis, idx, src)

def _segment_sum(src, seg, n):
    out = torch.zeros((n,) + src.shape[1:], dtype=src.dtype)
    return out.index_add_(0, seg, src)

def _pad(x, pw):
    flat = tuple((v for pair in reversed(pw) for v in pair))
    return torch.nn.functional.pad(x, flat)
kernel_name = 'standalone__swin_window_attn__vision'

def setup_inputs():

    _w = lambda a: (lambda t: t.to(torch.bfloat16) if t.is_floating_point() else t)(torch.as_tensor(a))
    H = W = 512 // 7 * 7
    C, win = (192, 7)
    return {'x': _w((lambda *s: torch.randn(*s, dtype=torch.bfloat16) * 0.2)(1, H, W, C)), 'wqkv': _w((lambda *s: torch.randn(*s, dtype=torch.bfloat16) * 0.2)(C, 3 * C)), 'wo': _w((lambda *s: torch.randn(*s, dtype=torch.bfloat16) * 0.05)(C, C))}

def reference(x, wqkv, wo):
    B, H, W, C = x.shape
    win = 7
    nh, nw = (H // win, W // win)
    xw = (lambda x, *d: x.permute(*d))(x.reshape(B, nh, win, nw, win, C), 0, 1, 3, 2, 4, 5)
    xw = xw.reshape(B * nh * nw, win * win, C)
    qkv = xw @ wqkv
    q, k, v = (qkv[..., :C].clone(), qkv[..., C:2 * C].clone(), qkv[..., 2 * C:].clone())
    scale = C ** (-0.5)
    p = _softmax(torch.einsum('bqc,bkc->bqk', q, k) * scale, axis=-1)
    o = torch.einsum('bqk,bkc->bqc', p, v) @ wo
    o = (lambda x, *d: x.permute(*d))(o.reshape(B, nh, nw, win, win, C), 0, 1, 3, 2, 4, 5)
    return o.reshape(B, H, W, C)
```

```asm
; @launch grid=(256,1,1) block=(256,1,1) lds=163840
.amdgcn_target "amdgcn-amd-amdhsa--gfx950"
.text
.globl standalone__swin_window_attn__vision_kernel
.p2align 12
.type standalone__swin_window_attn__vision_kernel,@function
standalone__swin_window_attn__vision_kernel:
    s_cmp_lt_u32 s2, 256
    s_cbranch_scc1 L_go
    s_endpgm
L_go:
    s_load_dwordx8 s[92:99], s[0:1], 0
    s_load_dwordx4 s[32:35], s[0:1], 32
    v_and_b32 v1, 63, v0
    v_lshrrev_b32 v2, 6, v0
    v_and_b32 v3, 15, v1
    v_readfirstlane_b32 s38, v2
    v_lshrrev_b32 v4, 4, v1
    v_lshlrev_b32 v220, 4, v1
    v_and_b32 v5, 16, v1
    v_mul_u32_u24 v5, 12, v5
    v_xor_b32 v220, v220, v5
    s_getpc_b64 s[90:91]
L_here:
    v_lshlrev_b32 v242, 7, v1
    s_getreg_b32 s3, hwreg(HW_REG_XCC_ID, 0, 4)
    s_lshr_b32 s36, s2, 3
    s_cmp_ge_u32 s36, 23
    s_cselect_b32 s20, -5, 9
    s_cmp_ge_u32 s36, 18
    s_cselect_b32 s20, s20, 0
    s_add_u32 s36, s36, s20
    s_cmp_lg_u32 s38, 0
    s_cbranch_scc1 L_nt0
    s_lshl_b32 s20, s36, 7
    v_lshl_add_u32 v5, v1, 12, s20
    v_min_u32 v5, L_main_done-L_here, v5
    s_mov_b64 exec, 3
    global_load_dword v243, v5, s[90:91]
    s_mov_b64 exec, -1
L_nt0:
    s_cmp_lt_u32 s36, 27
    s_cbranch_scc1 L_nt
    s_lshl2_add_u32 s20, s36, s38
    s_mul_i32 s20, s20, 2944
    s_add_u32 s20, s20, 4294657536
    v_add_u32 v5, s20, v242
    v_min_u32 v5, L_main_done-L_here, v5
    s_mov_b64 exec, 8388607
    global_load_dword v243, v5, s[90:91]
    s_mov_b64 exec, -1
L_nt:
    s_cmp_ge_u32 s36, 18
    s_cselect_b32 s20, 1, 0
    s_cselect_b32 s22, 18, 0
    s_cselect_b32 s23, 86, 43
    s_cselect_b32 s24, 3, 6
    s_sub_u32 s22, s36, s22
    s_mul_i32 s21, s22, s23
    s_lshr_b32 s21, s21, 8
    s_mul_i32 s24, s24, s21
    s_sub_u32 s22, s22, s24
    v_lshrrev_b32 v5, 3, v1
    v_and_b32 v6, 7, v1
    v_and_b32 v7, 1, v4
    v_xor_b32 v8, v6, v7
    v_mul_u32_u24 v9, 0x480, v5
    v_lshl_add_u32 v8, v8, 4, v9
    s_lshl_b32 s23, s38, 5
    v_xor_b32 v12, s23, v8
    s_lshl_b32 s23, s38, 6
    s_and_b32 s23, s23, 64
    v_xor_b32 v10, s23, v8
    v_xor_b32 v11, 32, v10
    s_lshl_b32 s23, s21, 2
    s_add_u32 s23, s23, s38
    s_mul_i32 s25, s23, 18432
    s_mul_i32 s23, s20, 768
    s_add_u32 s25, s25, s23
    s_add_u32 s24, s25, 9216
    s_mul_i32 s27, s38, 6144
    s_mov_b32 s100, s22
    v_mov_b32 v216, -1
    v_mov_b32 v217, -1
    v_mov_b32 v218, -1
    v_mov_b32 v219, -1
    v_lshlrev_b32 v7, 1, v7
    v_xor_b32 v13, v6, v7
    v_mul_u32_u24 v9, 0x180, v5
    v_lshl_add_u32 v9, v13, 4, v9
    v_xor_b32 v13, 64, v9
    s_lshl_b32 s26, s22, 2
    s_add_u32 s26, s26, s38
    s_mul_i32 s26, s26, 9216
    s_add_u32 s26, s26, 384
    s_mul_i32 s43, s38, 18432
    s_lshl_b32 s23, s22, 7
    s_add_u32 s43, s43, s23
    s_cmp_eq_u32 s20, 1
    s_cselect_b32 s26, s43, s26
    s_cselect_b64 vcc, -1, 0
    s_mul_i32 s43, s38, 3072
    v_cndmask_b32 v12, v12, v9, vcc
    s_and_b32 s23, s38, 1
    s_lshl1_add_u32 s23, s22, s23
    s_mul_i32 s23, s23, 6
    s_lshr_b32 s42, s38, 1
    s_lshl1_add_u32 s42, s21, s42
    s_add_u32 s23, s23, s42
    s_lshl_b32 s101, s23, 10
    s_mul_i32 s42, s3, 147456
    s_add_u32 s42, s42, 4194304
    s_lshl_b32 s3, s3, 5
    s_cmp_ge_u32 s36, 27
    s_waitcnt lgkmcnt(0)
    s_cbranch_scc1 L_np0
    s_mov_b32 s56, s94
    s_and_b32 s57, s95, 0xffff
    s_mov_b32 s58, 221184
    s_mov_b32 s59, 0x20000
    s_add_u32 m0, s27, 73728
    s_nop 0
    buffer_load_dwordx4 v10, s[56:59], s25 offen offset:0 lds
    s_add_u32 m0, s27, 74624
    s_nop 0
    buffer_load_dwordx4 v10, s[56:59], s25 offen offset:128 lds
    s_add_u32 m0, s27, 75520
    s_nop 0
    buffer_load_dwordx4 v10, s[56:59], s25 offen offset:256 lds
    s_add_u32 m0, s27, 76800
    s_nop 0
    buffer_load_dwordx4 v11, s[56:59], s24 offen offset:0 lds
    s_add_u32 m0, s27, 77696
    s_nop 0
    buffer_load_dwordx4 v11, s[56:59], s24 offen offset:128 lds
    s_add_u32 m0, s27, 78592
    s_nop 0
    buffer_load_dwordx4 v11, s[56:59], s24 offen offset:256 lds
    s_cmp_eq_u32 s20, 1
    s_cbranch_scc1 L_pl_n
    s_add_u32 m0, s43, 98304
    s_nop 0
    buffer_load_dwordx4 v12, s[56:59], s26 offen offset:0 lds
    s_add_u32 m0, s43, 99200
    s_nop 0
    buffer_load_dwordx4 v12, s[56:59], s26 offen offset:128 lds
    s_add_u32 m0, s43, 100096
    s_nop 0
    buffer_load_dwordx4 v12, s[56:59], s26 offen offset:256 lds
    s_add_u32 s12, s34, s42
    s_addc_u32 s13, s35, 0
    s_and_b32 s13, s13, 0xffff
    s_mov_b32 s14, 147456
    s_mov_b32 s15, 0x20000
    buffer_store_dwordx4 v[216:219], v220, s[12:15], s101 offen sc1
    s_branch L_np1
L_pl_n:
    s_mov_b32 s60, s96
    s_and_b32 s61, s97, 0xffff
    s_mov_b32 s62, 73728
    s_mov_b32 s63, 0x20000
    s_lshl_b32 s23, s21, 11
    s_add_u32 s24, s27, 98304
    s_add_u32 m0, s24, s23
    s_mul_i32 s25, s23, 3
    s_add_u32 s25, s25, s26
    buffer_load_dwordx4 v12, s[60:63], s25 offen offset:0 lds
    s_add_u32 s23, s23, 1024
    s_add_u32 m0, s24, s23
    s_mul_i32 s25, s23, 3
    s_add_u32 s25, s25, s26
    buffer_load_dwordx4 v13, s[60:63], s25 offen offset:0 lds
    s_add_u32 s23, s23, 1024
    s_cmp_eq_u32 s23, 6144
    s_cselect_b32 s23, 0, s23
    s_add_u32 m0, s24, s23
    s_mul_i32 s25, s23, 3
    s_add_u32 s25, s25, s26
    buffer_load_dwordx4 v12, s[60:63], s25 offen offset:0 lds
    s_add_u32 s23, s23, 1024
    s_add_u32 m0, s24, s23
    s_mul_i32 s25, s23, 3
    s_add_u32 s25, s25, s26
    buffer_load_dwordx4 v13, s[60:63], s25 offen offset:0 lds
    s_add_u32 s23, s23, 1024
    s_cmp_eq_u32 s23, 6144
    s_cselect_b32 s23, 0, s23
    s_add_u32 m0, s24, s23
    s_mul_i32 s25, s23, 3
    s_add_u32 s25, s25, s26
    buffer_load_dwordx4 v12, s[60:63], s25 offen offset:0 lds
    s_add_u32 s23, s23, 1024
    s_add_u32 m0, s24, s23
    s_mul_i32 s25, s23, 3
    s_add_u32 s25, s25, s26
    buffer_load_dwordx4 v13, s[60:63], s25 offen offset:0 lds
    s_add_u32 s12, s34, s42
    s_addc_u32 s13, s35, 0
    s_and_b32 s13, s13, 0xffff
    s_mov_b32 s14, 147456
    s_mov_b32 s15, 0x20000
    s_mul_i32 s23, s22, 24576
    s_add_u32 s26, s27, s23
    s_lshl_b32 s101, s21, 11
    s_add_u32 s101, s101, 73728
    s_add_u32 s26, s26, s101
    s_add_u32 s43, s26, 1024
    buffer_store_dwordx4 v[216:219], v220, s[12:15], s26 offen sc1
    buffer_store_dwordx4 v[216:219], v220, s[12:15], s43 offen sc1
    s_lshr_b32 s23, s38, 1
    s_lshl_b32 s23, s23, 10
    s_add_u32 s101, s101, s23
    s_branch L_np1
L_np0:
    s_add_u32 s12, s34, s42
    s_addc_u32 s13, s35, 0
    s_and_b32 s13, s13, 0xffff
    s_mov_b32 s14, 147456
    s_mov_b32 s15, 0x20000
    buffer_load_dword v30, off, s[12:15], 0 sc1
L_np1:
    s_mov_b32 s80, s32
    s_and_b32 s81, s33, 0xffff
    s_mov_b32 s82, 256
    s_mov_b32 s83, 0x20000
    buffer_load_dword v31, off, s[80:83], s3 sc1
    s_lshl_b32 s16, s2, 2
    s_mov_b32 s29, 58835169
    s_mov_b32 s31, 100270464
    s_add_u32 s16, s16, s38
    s_add_u32 s16, s16, 4096
    s_add_u32 s73, s2, 5120
    v_mov_b32 v244, 0xff800000
    v_lshrrev_b32 v45, 2, v3
    v_and_b32 v46, 3, v3
    v_mul_u32_u24 v44, 52, v1
    v_lshrrev_b32 v44, 8, v44
    s_and_b32 s30, s16, -4
    v_mul_u32_u24 v43, 0x1401, v44
    v_lshlrev_b32 v40, 10, v1
    v_sub_u32 v43, v43, v40
    v_add_u32 v40, s30, v43
    s_cmp_lt_u32 s73, 5329
    s_cselect_b32 s30, s73, s16
    v_mov_b32 v44, s30
    v_cmp_le_u32 vcc, 20, v1
    s_nop 1
    v_cndmask_b32 v40, v40, v44, vcc
    v_mul_hi_u32 v41, v40, s29
    v_mul_u32_u24 v42, 73, v41
    v_sub_u32 v42, v40, v42
    v_mul_u32_u24 v42, 0xa80, v42
    s_mov_b32 s30, 1373568
    v_mul_lo_u32 v41, v41, s30
    s_lshl_b32 s30, s38, 7
    s_add_u32 s30, s30, 1179648
    v_add3_u32 v14, v41, v42, s30
    s_mov_b32 s4, s92
    s_and_b32 s5, s93, 0xffff
    s_mov_b32 s6, s31
    s_mov_b32 s7, 0x20000
    s_lshr_b32 s40, s2, 3
    s_mul_i32 s43, s38, 6
    s_add_u32 s42, s40, s43
    s_sub_u32 s43, s42, 24
    s_cselect_b32 s42, s42, s43
    s_sub_u32 s43, s42, 24
    s_cselect_b32 s42, s42, s43
    s_mul_i32 s75, s42, 3072
    s_mul_hi_u32 s30, s16, s29
    s_mul_i32 s17, s30, 73
    s_sub_u32 s17, s16, s17
    s_mul_i32 s17, s17, 2688
    s_mul_i32 s30, s30, 1373568
    s_add_u32 s17, s17, s30
    s_mul_hi_u32 s30, s73, s29
    s_mul_i32 s18, s30, 73
    s_sub_u32 s18, s73, s18
    s_mul_i32 s18, s18, 2688
    s_mul_i32 s30, s30, 1373568
    s_add_u32 s18, s18, s30
    s_mov_b32 s39, 196224
    v_mul_u32_u24 v5, 0x180, v45
    v_mul_lo_u32 v6, v45, s39
    v_lshrrev_b32 v7, 1, v45
    v_mul_lo_u32 v7, v7, s39
    v_and_b32 v8, 1, v45
    v_mul_u32_u24 v8, 0x180, v8
    v_add_u32 v7, v7, v8
    v_mov_b32 v8, 2304
    v_cmp_eq_u32 vcc, 1, v45
    v_mov_b32 v9, 198528
    s_nop 0
    v_cndmask_b32 v8, v8, v9, vcc
    v_cmp_eq_u32 vcc, 2, v45
    v_mov_b32 v9, 393984
    s_nop 0
    v_cndmask_b32 v8, v8, v9, vcc
    v_cmp_eq_u32 vcc, 3, v45
    v_mov_b32 v9, 394368
    s_nop 0
    v_cndmask_b32 v8, v8, v9, vcc
    v_cmp_eq_u32 s[66:67], 1, v46
    v_cmp_eq_u32 s[68:69], 2, v46
    v_cmp_eq_u32 s[70:71], 3, v46
    v_lshlrev_b32 v12, 4, v4
    v_mul_lo_u32 v13, v46, s39
    v_add3_u32 v223, v13, v5, v12
    v_add_u32 v224, 784896, v5
    v_add_u32 v9, 981120, v5
    v_cndmask_b32 v224, v224, v9, s[66:67]
    v_add_u32 v9, 1177344, v5
    v_cndmask_b32 v224, v224, v9, s[68:69]
    v_add_u32 v9, 1536, v6
    v_cndmask_b32 v224, v224, v9, s[70:71]
    v_add_u32 v224, v224, v12
    v_add_u32 v225, 1920, v6
    v_add_u32 v9, 2304, v6
    v_cndmask_b32 v225, v225, v9, s[66:67]
    v_add_u32 v9, 786432, v7
    v_cndmask_b32 v225, v225, v9, s[68:69]
    v_add_u32 v9, 784896, v8
    v_cndmask_b32 v225, v225, v9, s[70:71]
    v_add_u32 v225, v225, v12
    v_cmp_eq_u32 s[66:67], 1, v2
    v_cmp_eq_u32 s[68:69], 2, v2
    v_cmp_eq_u32 s[70:71], 3, v2
    v_cndmask_b32 v15, v223, v224, s[66:67]
    v_cndmask_b32 v15, v15, v225, s[68:69]
    v_add_u32 v16, 0x80, v15
    v_add_u32 v9, 0x100, v224
    v_cndmask_b32 v15, v15, v9, s[70:71]
    v_add_u32 v9, 0x100, v225
    v_cndmask_b32 v16, v16, v9, s[70:71]
    v_lshrrev_b32 v5, 1, v1
    v_and_b32 v5, 28, v5
    ds_bpermute_b32 v17, v5, v15 offset:0
    ds_bpermute_b32 v18, v5, v15 offset:32
    ds_bpermute_b32 v19, v5, v16 offset:0
    ds_bpermute_b32 v20, v5, v16 offset:32
    s_add_u32 s30, s18, 256
    v_add_u32 v9, s30, v223
    v_cmp_gt_u32 vcc, 16, v1
    s_nop 1
    v_cndmask_b32 v9, v244, v9, vcc
    v_cndmask_b32 v14, v14, v9, s[70:71]
    ds_bpermute_b32 v112, v5, v14 offset:0
    ds_bpermute_b32 v113, v5, v14 offset:32
    ds_bpermute_b32 v114, v5, v14 offset:64
    v_and_b32 v12, 7, v1
    v_xor_b32 v12, v12, v4
    v_lshlrev_b32 v12, 4, v12
    v_xor_b32 v13, 64, v12
    s_lshl_b32 s41, s38, 12
    s_add_u32 s41, s41, 147456
    s_cmp_lt_u32 s73, 5329
    s_cselect_b32 s30, s31, 0
    s_waitcnt lgkmcnt(0)
    s_mov_b32 s76, s92
    s_and_b32 s77, s93, 0xffff
    s_mov_b32 s78, s30
    s_mov_b32 s79, 0x20000
    v_add_u32 v17, v17, v12
    v_add_u32 v18, v18, v13
    v_add_u32 v19, v19, v12
    v_add_u32 v20, v20, v13
    v_add_u32 v112, v112, v12
    v_add_u32 v113, v113, v13
    v_add_u32 v114, v114, v12
    s_cmp_ge_u32 s36, 27
    s_cbranch_scc1 L_np2
    v_lshrrev_b32 v5, 2, v3
    v_and_b32 v6, 3, v3
    v_lshrrev_b32 v7, 1, v3
    v_xor_b32 v7, v7, v4
    v_lshlrev_b32 v7, 4, v7
    v_lshl_add_u32 v7, v6, 7, v7
    v_mul_u32_u24 v8, 0xc00, v5
    s_lshr_b32 s23, s38, 1
    s_mul_i32 s23, s23, 12288
    s_add_u32 s23, s23, 73728
    v_add3_u32 v80, v7, v8, s23
    v_xor_b32 v81, 64, v80
    s_and_b32 s24, s38, 1
    s_cmp_ge_u32 s36, 18
    s_addc_u32 s26, s36, s3
    s_cmp_ge_u32 s36, 18
    s_addc_u32 s26, s26, 0
    s_cmp_lg_u32 s38, 3
    s_cselect_b32 s26, 0x1000, s26
    v_mov_b32 v9, 1
    s_cmp_ge_u32 s36, 18
    s_cbranch_scc1 L_pm_n
    s_lshl_b32 s24, s24, 9
    s_add_u32 s24, s24, 98304
    v_add3_u32 v82, v7, v8, s24
    v_xor_b32 v83, 64, v82
    s_add_u32 m0, s41, 0
    s_nop 0
    buffer_load_dwordx4 v17, s[76:79], s18 offen lds
    s_add_u32 m0, s41, 1024
    s_nop 0
    buffer_load_dwordx4 v18, s[76:79], s18 offen lds
    s_add_u32 m0, s41, 2048
    s_nop 0
    buffer_load_dwordx4 v19, s[76:79], s18 offen lds
    s_add_u32 m0, s41, 3072
    s_nop 0
    buffer_load_dwordx4 v20, s[76:79], s18 offen lds
    s_mul_i32 s23, s38, 3072
    s_add_u32 m0, s23, 122880
    s_nop 0
    buffer_load_dwordx4 v112, s[4:7], 0 offen lds
    s_add_u32 m0, s23, 123904
    s_nop 0
    buffer_load_dwordx4 v113, s[4:7], 0 offen lds
    s_add_u32 m0, s23, 124928
    s_nop 0
    buffer_load_dwordx4 v114, s[4:7], 0 offen lds
    s_waitcnt vmcnt(8)
    s_barrier
    ds_read_b128 v[176:179], v82 offset:0
    ds_read_b128 v[128:131], v80 offset:0
    ds_read_b128 v[152:155], v80 offset:512
    ds_read_b128 v[180:183], v83 offset:0
    ds_read_b128 v[132:135], v81 offset:0
    ds_read_b128 v[156:159], v81 offset:512
    ds_read_b128 v[184:187], v82 offset:1024
    ds_read_b128 v[136:139], v80 offset:1024
    ds_read_b128 v[160:163], v80 offset:1536
    ds_read_b128 v[188:191], v83 offset:1024
    ds_read_b128 v[140:143], v81 offset:1024
    ds_read_b128 v[164:167], v81 offset:1536
    ds_read_b128 v[192:195], v82 offset:2048
    ds_read_b128 v[144:147], v80 offset:2048
    ds_read_b128 v[168:171], v80 offset:2560
    s_waitcnt lgkmcnt(12)
    v_mfma_f32_16x16x32_bf16 v[200:203], v[128:131], v[176:179], 0
    v_mfma_f32_16x16x32_bf16 v[204:207], v[152:155], v[176:179], 0
    ds_read_b128 v[196:199], v83 offset:2048
    ds_read_b128 v[148:151], v81 offset:2048
    ds_read_b128 v[172:175], v81 offset:2560
    s_waitcnt lgkmcnt(12)
    v_mfma_f32_16x16x32_bf16 v[200:203], v[132:135], v[180:183], v[200:203]
    v_mfma_f32_16x16x32_bf16 v[204:207], v[156:159], v[180:183], v[204:207]
    s_waitcnt lgkmcnt(9)
    v_mfma_f32_16x16x32_bf16 v[200:203], v[136:139], v[184:187], v[200:203]
    v_mfma_f32_16x16x32_bf16 v[204:207], v[160:163], v[184:187], v[204:207]
    s_waitcnt lgkmcnt(6)
    v_mfma_f32_16x16x32_bf16 v[200:203], v[140:143], v[188:191], v[200:203]
    v_mfma_f32_16x16x32_bf16 v[204:207], v[164:167], v[188:191], v[204:207]
    s_waitcnt lgkmcnt(3)
    v_mfma_f32_16x16x32_bf16 v[200:203], v[144:147], v[192:195], v[200:203]
    v_mfma_f32_16x16x32_bf16 v[204:207], v[168:171], v[192:195], v[204:207]
    s_waitcnt lgkmcnt(0)
    v_mfma_f32_16x16x32_bf16 v[200:203], v[148:151], v[196:199], v[200:203]
    v_mfma_f32_16x16x32_bf16 v[204:207], v[172:175], v[196:199], v[204:207]
    s_nop 6
    v_mul_f32 v200, 0x3dd53b95, v200
    v_mul_f32 v201, 0x3dd53b95, v201
    v_cvt_pk_bf16_f32 v216, v200, v201
    v_min_u32 v216, -2, v216
    v_mul_f32 v202, 0x3dd53b95, v202
    v_mul_f32 v203, 0x3dd53b95, v203
    v_cvt_pk_bf16_f32 v217, v202, v203
    v_min_u32 v217, -2, v217
    v_mul_f32 v204, 0x3dd53b95, v204
    v_mul_f32 v205, 0x3dd53b95, v205
    v_cvt_pk_bf16_f32 v218, v204, v205
    v_min_u32 v218, -2, v218
    v_mul_f32 v206, 0x3dd53b95, v206
    v_mul_f32 v207, 0x3dd53b95, v207
    v_cvt_pk_bf16_f32 v219, v206, v207
    v_min_u32 v219, -2, v219
    buffer_store_dwordx4 v[216:219], v220, s[12:15], s101 offen
    s_barrier
    s_mov_b64 exec, 1
    buffer_store_byte v9, off, s[80:83], s26
    s_mov_b64 exec, -1
    s_branch L_np3
L_pm_n:
    v_lshrrev_b32 v7, 1, v6
    v_and_b32 v8, 2, v5
    v_xor_b32 v7, v7, v8
    v_and_b32 v8, 1, v4
    v_xor_b32 v8, s24, v8
    v_lshl_add_u32 v7, v8, 2, v7
    v_lshlrev_b32 v7, 4, v7
    v_and_b32 v8, 1, v3
    v_lshl_add_u32 v7, v8, 3, v7
    v_lshl_add_u32 v7, v5, 7, v7
    v_lshl_add_u32 v7, v4, 10, v7
    v_add_u32 v82, 98304, v7
    v_xor_b32 v83, 32, v82
    s_mov_b32 s23, 2
    s_mov_b32 s25, 3
    s_mul_i32 s27, s100, 24576
    s_mov_b32 s43, 0
    s_lshl1_add_u32 s43, s43, s24
    s_lshl_b32 s43, s43, 5
    s_add_u32 s101, s101, s27
    v_and_b32 v7, s25, v3
    v_mul_u32_u24 v7, 0x1800, v7
    v_lshl_add_u32 v7, v4, 8, v7
    v_and_b32 v10, 1, v4
    v_mul_u32_u24 v10, 12, v10
    v_add_u32 v8, s43, v3
    v_lshrrev_b32 v8, s23, v8
    v_xor_b32 v8, v8, v10
    v_lshl_add_u32 v84, v8, 4, v7
    v_add_u32 v8, s43, v3
    v_add_u32 v8, 16, v8
    v_lshrrev_b32 v8, s23, v8
    v_xor_b32 v8, v8, v10
    v_lshl_add_u32 v85, v8, 4, v7
    s_add_u32 m0, s41, 0
    s_nop 0
    buffer_load_dwordx4 v17, s[76:79], s18 offen lds
    s_add_u32 m0, s41, 1024
    s_nop 0
    buffer_load_dwordx4 v18, s[76:79], s18 offen lds
    s_add_u32 m0, s41, 2048
    s_nop 0
    buffer_load_dwordx4 v19, s[76:79], s18 offen lds
    s_add_u32 m0, s41, 3072
    s_nop 0
    buffer_load_dwordx4 v20, s[76:79], s18 offen lds
    s_mul_i32 s23, s38, 3072
    s_add_u32 m0, s23, 122880
    s_nop 0
    buffer_load_dwordx4 v112, s[4:7], 0 offen lds
    s_add_u32 m0, s23, 123904
    s_nop 0
    buffer_load_dwordx4 v113, s[4:7], 0 offen lds
    s_add_u32 m0, s23, 124928
    s_nop 0
    buffer_load_dwordx4 v114, s[4:7], 0 offen lds
    s_waitcnt vmcnt(8)
    s_barrier
    ds_read_b128 v[128:131], v80 offset:0
    ds_read_b128 v[152:155], v80 offset:512
    ds_read_b64_tr_b16 v[32:33], v82 offset:0
    ds_read_b64_tr_b16 v[34:35], v82 offset:512
    ds_read_b64_tr_b16 v[56:57], v83 offset:0
    ds_read_b64_tr_b16 v[58:59], v83 offset:512
    ds_read_b128 v[132:135], v81 offset:0
    ds_read_b128 v[156:159], v81 offset:512
    ds_read_b64_tr_b16 v[36:37], v82 offset:4096
    ds_read_b64_tr_b16 v[38:39], v82 offset:4608
    ds_read_b64_tr_b16 v[60:61], v83 offset:4096
    ds_read_b64_tr_b16 v[62:63], v83 offset:4608
    ds_read_b128 v[136:139], v80 offset:1024
    ds_read_b128 v[160:163], v80 offset:1536
    ds_read_b64_tr_b16 v[40:41], v82 offset:8192
    ds_read_b64_tr_b16 v[42:43], v82 offset:8704
    ds_read_b64_tr_b16 v[64:65], v83 offset:8192
    ds_read_b64_tr_b16 v[66:67], v83 offset:8704
    s_waitcnt lgkmcnt(12)
    v_mfma_f32_16x16x32_bf16 v[200:203], v[128:131], v[32:35], 0
    v_mfma_f32_16x16x32_bf16 v[204:207], v[152:155], v[32:35], 0
    v_mfma_f32_16x16x32_bf16 v[208:211], v[128:131], v[56:59], 0
    v_mfma_f32_16x16x32_bf16 v[212:215], v[152:155], v[56:59], 0
    ds_read_b128 v[140:143], v81 offset:1024
    ds_read_b128 v[164:167], v81 offset:1536
    ds_read_b64_tr_b16 v[44:45], v82 offset:12288
    ds_read_b64_tr_b16 v[46:47], v82 offset:12800
    ds_read_b64_tr_b16 v[68:69], v83 offset:12288
    ds_read_b64_tr_b16 v[70:71], v83 offset:12800
    s_waitcnt lgkmcnt(12)
    v_mfma_f32_16x16x32_bf16 v[200:203], v[132:135], v[36:39], v[200:203]
    v_mfma_f32_16x16x32_bf16 v[204:207], v[156:159], v[36:39], v[204:207]
    v_mfma_f32_16x16x32_bf16 v[208:211], v[132:135], v[60:63], v[208:211]
    v_mfma_f32_16x16x32_bf16 v[212:215], v[156:159], v[60:63], v[212:215]
    ds_read_b128 v[144:147], v80 offset:2048
    ds_read_b128 v[168:171], v80 offset:2560
    ds_read_b64_tr_b16 v[48:49], v82 offset:16384
    ds_read_b64_tr_b16 v[50:51], v82 offset:16896
    ds_read_b64_tr_b16 v[72:73], v83 offset:16384
    ds_read_b64_tr_b16 v[74:75], v83 offset:16896
    s_waitcnt lgkmcnt(12)
    v_mfma_f32_16x16x32_bf16 v[200:203], v[136:139], v[40:43], v[200:203]
    v_mfma_f32_16x16x32_bf16 v[204:207], v[160:163], v[40:43], v[204:207]
    v_mfma_f32_16x16x32_bf16 v[208:211], v[136:139], v[64:67], v[208:211]
    v_mfma_f32_16x16x32_bf16 v[212:215], v[160:163], v[64:67], v[212:215]
    ds_read_b128 v[148:151], v81 offset:2048
    ds_read_b128 v[172:175], v81 offset:2560
    ds_read_b64_tr_b16 v[52:53], v82 offset:20480
    ds_read_b64_tr_b16 v[54:55], v82 offset:20992
    ds_read_b64_tr_b16 v[76:77], v83 offset:20480
    ds_read_b64_tr_b16 v[78:79], v83 offset:20992
    s_waitcnt lgkmcnt(12)
    v_mfma_f32_16x16x32_bf16 v[200:203], v[140:143], v[44:47], v[200:203]
    v_mfma_f32_16x16x32_bf16 v[204:207], v[164:167], v[44:47], v[204:207]
    v_mfma_f32_16x16x32_bf16 v[208:211], v[140:143], v[68:71], v[208:211]
    v_mfma_f32_16x16x32_bf16 v[212:215], v[164:167], v[68:71], v[212:215]
    s_waitcnt lgkmcnt(6)
    v_mfma_f32_16x16x32_bf16 v[200:203], v[144:147], v[48:51], v[200:203]
    v_mfma_f32_16x16x32_bf16 v[204:207], v[168:171], v[48:51], v[204:207]
    v_mfma_f32_16x16x32_bf16 v[208:211], v[144:147], v[72:75], v[208:211]
    v_mfma_f32_16x16x32_bf16 v[212:215], v[168:171], v[72:75], v[212:215]
    s_waitcnt lgkmcnt(0)
    v_mfma_f32_16x16x32_bf16 v[200:203], v[148:151], v[52:55], v[200:203]
    v_mfma_f32_16x16x32_bf16 v[204:207], v[172:175], v[52:55], v[204:207]
    v_mfma_f32_16x16x32_bf16 v[208:211], v[148:151], v[76:79], v[208:211]
    v_mfma_f32_16x16x32_bf16 v[212:215], v[172:175], v[76:79], v[212:215]
    s_nop 4
    v_cvt_pk_bf16_f32 v176, v200, v201
    v_min_u32 v176, -2, v176
    v_cvt_pk_bf16_f32 v177, v202, v203
    v_min_u32 v177, -2, v177
    v_cvt_pk_bf16_f32 v178, v204, v205
    v_min_u32 v178, -2, v178
    v_cvt_pk_bf16_f32 v179, v206, v207
    v_min_u32 v179, -2, v179
    buffer_store_dwordx4 v[176:179], v84, s[12:15], s101 offen
    v_cvt_pk_bf16_f32 v180, v208, v209
    v_min_u32 v180, -2, v180
    v_cvt_pk_bf16_f32 v181, v210, v211
    v_min_u32 v181, -2, v181
    v_cvt_pk_bf16_f32 v182, v212, v213
    v_min_u32 v182, -2, v182
    v_cvt_pk_bf16_f32 v183, v214, v215
    v_min_u32 v183, -2, v183
    buffer_store_dwordx4 v[180:183], v85, s[12:15], s101 offen
    s_barrier
    s_mov_b64 exec, 1
    buffer_store_byte v9, off, s[80:83], s26
    s_mov_b64 exec, -1
    s_branch L_np3
L_np2:
    s_add_u32 m0, s41, 0
    s_nop 0
    buffer_load_dwordx4 v17, s[76:79], s18 offen lds
    s_add_u32 m0, s41, 1024
    s_nop 0
    buffer_load_dwordx4 v18, s[76:79], s18 offen lds
    s_add_u32 m0, s41, 2048
    s_nop 0
    buffer_load_dwordx4 v19, s[76:79], s18 offen lds
    s_add_u32 m0, s41, 3072
    s_nop 0
    buffer_load_dwordx4 v20, s[76:79], s18 offen lds
    s_mul_i32 s23, s38, 3072
    s_add_u32 m0, s23, 122880
    s_nop 0
    buffer_load_dwordx4 v112, s[4:7], 0 offen lds
    s_add_u32 m0, s23, 123904
    s_nop 0
    buffer_load_dwordx4 v113, s[4:7], 0 offen lds
    s_add_u32 m0, s23, 124928
    s_nop 0
    buffer_load_dwordx4 v114, s[4:7], 0 offen lds
L_np3:
    v_lshrrev_b32 v5, 1, v3
    v_xor_b32 v5, v5, v4
    v_lshlrev_b32 v5, 4, v5
    v_lshl_add_u32 v5, v3, 7, v5
    v_add_u32 v226, 147456, v5
    v_xor_b32 v227, 64, v226
    v_add_u32 v221, 0x10000, v220
    v_add_u32 v222, 0x20000, v220
    v_lshrrev_b32 v229, 1, v220
    v_lshrrev_b32 v230, 2, v220
    v_add_u32 v229, 0x20000, v229
    v_add_u32 v230, 0x20000, v230
    s_mov_b32 s8, s98
    s_and_b32 s9, s99, 0xffff
    s_mov_b32 s10, s30
    s_mov_b32 s11, 0x20000
    s_and_b32 s23, s38, 1
    s_lshl_b32 s24, s23, 9
    v_and_b32 v5, 60, v1
    v_lshl_add_u32 v5, v5, 2, s24
    v_and_b32 v6, 2, v1
    v_lshl_add_u32 v5, v6, 7, v5
    v_mul_u32_u24 v7, 0x60, v6
    v_xor_b32 v5, v5, v7
    v_and_b32 v7, 1, v1
    v_lshl_add_u32 v5, v7, 3, v5
    v_accvgpr_write_b32 a241, v5
    v_lshrrev_b32 v6, 1, v6
    v_xor_b32 v6, s38, v6
    v_lshrrev_b32 v9, 2, v3
    v_lshl_add_u32 v8, v9, 1, v7
    v_mad_u32_u24 v6, v6, 5, v8
    v_cmp_gt_u32 vcc, 5, v8
    v_add_u32 v10, 1, v6
    s_nop 0
    v_cndmask_b32 v6, 20, v6, vcc
    v_cndmask_b32 v10, 0, v10, vcc
    v_bfe_u32 v11, v6, 1, 3
    v_xor_b32 v11, v11, v4
    v_lshlrev_b32 v11, 4, v11
    v_lshl_add_u32 v11, v6, 7, v11
    v_add_u32 v115, 122880, v11
    v_xor_b32 v116, 64, v115
    v_subrev_u32 v117, 24576, v226
    v_subrev_u32 v118, 24576, v227
    v_lshrrev_b32 v11, 1, v4
    v_and_b32 v12, 1, v4
    v_lshlrev_b32 v13, 5, v11
    v_lshl_add_u32 v8, v12, 3, v13
    v_add_u32 v5, 154944, v8
    v_accvgpr_write_b32 a246, v5
    s_lshl_b32 s24, s23, 2
    s_add_u32 s24, s24, 152064
    v_mul_u32_u24 v6, 0x90, v6
    v_add3_u32 v228, v6, v8, s24
    s_lshl_b32 s24, s23, 5
    s_add_u32 s24, s24, 155248
    v_mul_u32_u24 v10, 0x190, v10
    v_lshl_add_u32 v8, v4, 2, v10
    v_add_u32 v8, s24, v8
    v_accvgpr_write_b32 a242, v8
    v_lshlrev_b32 v8, 5, v4
    v_lshl_add_u32 v8, v7, 4, v8
    v_add_u32 v8, 0x20000, v8
    s_mul_i32 s24, s38, 5
    v_lshl_add_u32 v6, v9, 1, s24
    v_mul_u32_u24 v10, 0x190, v6
    v_add_u32 v10, v10, v8
    v_accvgpr_write_b32 a243, v10
    v_mul_u32_u24 v10, 0x90, v6
    v_add_u32 v10, v10, v8
    v_accvgpr_write_b32 a248, v10
    s_lshl_b32 s24, s38, 10
    s_add_u32 s24, s24, 156032
    v_lshl_add_u32 v5, v4, 7, s24
    v_lshrrev_b32 v6, 3, v3
    v_lshl_add_u32 v5, v6, 5, v5
    v_and_b32 v6, 4, v3
    v_lshl_add_u32 v5, v6, 1, v5
    v_and_b32 v6, 2, v3
    v_lshl_add_u32 v5, v6, 3, v5
    v_lshl_add_u32 v5, v7, 1, v5
    v_accvgpr_write_b32 a244, v5
    v_lshl_add_u32 v5, v4, 5, s24
    v_add_u32 v6, 0x200, v5
    v_lshl_add_u32 v5, v3, 4, v5
    v_cmp_gt_u32 vcc, 2, v3
    s_nop 1
    v_cndmask_b32 v5, v6, v5, vcc
    v_accvgpr_write_b32 a245, v5
    v_accvgpr_write_b32 a168, 0
    v_accvgpr_write_b32 a169, 0
    v_accvgpr_write_b32 a170, 0
    v_accvgpr_write_b32 a171, 0
    v_accvgpr_write_b32 a172, 0
    v_accvgpr_write_b32 a173, 0
    v_accvgpr_write_b32 a174, 0
    v_accvgpr_write_b32 a175, 0
    v_accvgpr_write_b32 a176, 0
    v_accvgpr_write_b32 a177, 0
    v_accvgpr_write_b32 a178, 0
    v_accvgpr_write_b32 a179, 0
    v_accvgpr_write_b32 a180, 0
    v_accvgpr_write_b32 a181, 0
    v_accvgpr_write_b32 a182, 0
    v_accvgpr_write_b32 a183, 0
    v_accvgpr_write_b32 a184, 0
    v_accvgpr_write_b32 a185, 0
    v_accvgpr_write_b32 a186, 0
    v_accvgpr_write_b32 a187, 0
    v_accvgpr_write_b32 a188, 0
    v_accvgpr_write_b32 a189, 0
    v_accvgpr_write_b32 a190, 0
    v_accvgpr_write_b32 a191, 0
    v_lshlrev_b32 v15, 4, v3
    v_lshlrev_b32 v16, 3, v3
    v_mul_u32_u24 v5, 0x180, v4
    v_mul_lo_u32 v6, v4, s39
    v_lshrrev_b32 v7, 1, v4
    v_mul_lo_u32 v7, v7, s39
    v_and_b32 v8, 1, v4
    v_mul_u32_u24 v8, 0x180, v8
    v_add_u32 v7, v7, v8
    v_mov_b32 v8, 2304
    v_cmp_eq_u32 vcc, 1, v4
    v_mov_b32 v9, 198528
    s_nop 0
    v_cndmask_b32 v8, v8, v9, vcc
    v_cmp_eq_u32 vcc, 2, v4
    v_mov_b32 v9, 393984
    s_nop 0
    v_cndmask_b32 v8, v8, v9, vcc
    v_cmp_eq_u32 vcc, 3, v4
    v_mov_b32 v9, 394368
    s_nop 0
    v_cndmask_b32 v8, v8, v9, vcc
    v_add_u32 v232, v5, v15
    v_add_u32 v233, v5, v16
    v_add_u32 v234, v6, v15
    v_add_u32 v235, v6, v16
    v_add_u32 v236, v7, v15
    v_add_u32 v237, v7, v16
    v_add_u32 v238, v8, v15
    v_add_u32 v239, v8, v16
    v_accvgpr_write_b32 a247, 0
    v_accvgpr_write_b32 a255, 0
    s_mov_b32 s48, 0
    s_mov_b32 s49, 0
    s_mov_b32 s50, 0
    s_mov_b32 s51, 0xffff
    s_mov_b32 s54, 16
    s_mov_b32 s74, 384
    s_mov_b32 s19, 0
    s_mov_b32 s40, 0xffff
    s_mov_b32 s41, 0
    v_cndmask_b32 v240, v244, v15, s[50:51]
    v_cndmask_b32 v241, v244, v16, s[50:51]
    s_mov_b32 s20, s18
    s_add_u32 s21, s18, 196224
    s_add_u32 s22, s18, 392448
    s_add_u32 s23, s18, 588672
    s_add_u32 s24, s18, 784896
    s_add_u32 s25, s18, 981120
    s_add_u32 s26, s18, 1177344
    s_add_u32 s84, s90, L_b0-L_here
    s_mov_b32 s88, L_b1-L_b0
    s_mov_b32 s89, L_epi-L_b0
    s_addc_u32 s85, s91, 0
    s_and_b32 s85, s85, 0xffff
    s_mov_b32 s86, L_main_done-L_b0
    s_mov_b32 s87, 0x20000
    s_lshr_b32 s27, s2, 3
    s_lshl2_add_u32 s27, s27, s38
    s_lshl_b32 s27, s27, 7
    v_mov_b32 v242, v244
    v_writelane_b32 v242, s27, 0
    s_mov_b32 s37, 256
    v_lshlrev_b32 v27, 2, v1
    v_cmp_gt_u32 vcc, 8, v1
    s_nop 1
    v_cndmask_b32 v27, v244, v27, vcc
    v_mov_b32 v29, 0x01010101
    s_mov_b32 s27, 0x0101
    v_writelane_b32 v29, s27, 4
    v_writelane_b32 v29, 1, 7
    s_mov_b32 s64, s75
    v_add_u32 v21, s64, v220
    v_add_u32 v100, 73728, v21
    s_add_u32 s65, s64, 3072
    s_cmp_eq_u32 s65, 73728
    s_cselect_b32 s65, 0, s65
    v_add_u32 v22, s65, v220
    v_add_u32 v101, 73728, v22
    s_add_u32 s66, s65, 3072
    s_cmp_eq_u32 s66, 73728
    s_cselect_b32 s66, 0, s66
    v_add_u32 v23, s66, v220
    v_add_u32 v102, 73728, v23
    s_add_u32 s67, s66, 3072
    s_cmp_eq_u32 s67, 73728
    s_cselect_b32 s67, 0, s67
    v_add_u32 v24, s67, v220
    v_add_u32 v103, 73728, v24
    s_add_u32 s68, s67, 3072
    s_cmp_eq_u32 s68, 73728
    s_cselect_b32 s68, 0, s68
    v_add_u32 v25, s68, v220
    v_add_u32 v104, 73728, v25
    s_add_u32 s69, s68, 3072
    s_cmp_eq_u32 s69, 73728
    s_cselect_b32 s69, 0, s69
    v_add_u32 v26, s69, v220
    v_add_u32 v105, 73728, v26
    buffer_load_dword v28, v27, s[80:83], s3 offen sc1
    s_mov_b64 exec, 0
    s_cmp_eq_u32 s38, 0
    s_cbranch_scc1 L_pad0
    s_cmp_eq_u32 s38, 1
    s_cbranch_scc1 L_pad1
    s_cmp_eq_u32 s38, 2
    s_cbranch_scc1 L_pad2
    s_branch L_pad4
L_vax:
    s_mov_b64 exec, -1
    buffer_load_dword v31, v27, s[80:83], s3 offen sc1
    s_waitcnt vmcnt(2)
    s_barrier
    s_waitcnt vmcnt(1)
    v_cmp_gt_u32 vcc, v29, v28
    s_nop 0
    s_and_b32 s27, vcc_lo, 31
    s_cbranch_scc0 L_pm_x
L_pm:
    s_sub_u32 s37, s37, 1
    s_cbranch_scc1 L_alone
    buffer_load_dword v28, v27, s[80:83], s3 offen sc1
    s_waitcnt vmcnt(1)
    v_cmp_gt_u32 vcc, v29, v31
    s_nop 0
    s_and_b32 s27, vcc_lo, 31
    s_cbranch_scc0 L_pm_x
    buffer_load_dword v31, v27, s[80:83], s3 offen sc1
    s_waitcnt vmcnt(1)
    v_cmp_gt_u32 vcc, v29, v28
    s_nop 0
    s_and_b32 s27, vcc_lo, 31
    s_cbranch_scc1 L_pm
L_pm_x:
L_ldm:
    buffer_load_dwordx4 v[32:35], v21, s[12:15], 0 offen offset:0 sc1
    ds_read_b128 a[144:147], v115 offset:0
    ds_read_b128 a[148:151], v116 offset:0
    ds_read_b128 a[152:155], v115 offset:3072
    buffer_load_dwordx4 v[36:39], v21, s[12:15], 0 offen offset:1024 sc1
    ds_read_b128 a[156:159], v116 offset:3072
    ds_read_b128 a[160:163], v115 offset:6144
    ds_read_b128 a[164:167], v116 offset:6144
    buffer_load_dwordx4 v[40:43], v21, s[12:15], 0 offen offset:2048 sc1
    ds_read_b128 a[88:91], v117 offset:9216
    ds_read_b128 a[92:95], v118 offset:9216
    ds_read_b128 a[72:75], v226 offset:0
    buffer_load_dwordx4 v[44:47], v22, s[12:15], 0 offen offset:0 sc1
    ds_read_b128 a[76:79], v227 offset:0
    ds_read_b128 a[80:83], v226 offset:2048
    ds_read_b128 a[84:87], v227 offset:2048
    buffer_load_dwordx4 v[48:51], v22, s[12:15], 0 offen offset:1024 sc1
    ds_read_b128 a[96:99], v226 offset:4096
    ds_read_b128 a[100:103], v227 offset:4096
    ds_read_b128 a[104:107], v226 offset:6144
    buffer_load_dwordx4 v[52:55], v22, s[12:15], 0 offen offset:2048 sc1
    ds_read_b128 a[108:111], v227 offset:6144
    ds_read_b128 a[120:123], v226 offset:8192
    ds_read_b128 a[124:127], v227 offset:8192
    buffer_load_dwordx4 v[56:59], v23, s[12:15], 0 offen offset:0 sc1
    ds_read_b128 a[128:131], v226 offset:10240
    ds_read_b128 a[132:135], v227 offset:10240
    ds_read_b128 a[112:115], v226 offset:12288
    buffer_load_dwordx4 v[60:63], v23, s[12:15], 0 offen offset:1024 sc1
    ds_read_b128 a[116:119], v227 offset:12288
    ds_read_b128 a[136:139], v226 offset:14336
    ds_read_b128 a[140:143], v227 offset:14336
    v_mov_b32 v30, 0
    s_waitcnt vmcnt(7)
    ds_write_b128 v21, v[32:35] offset:0
    v_max3_u32 v30, v30, v32, v33
    v_max3_u32 v30, v30, v34, v35
    buffer_load_dwordx4 v[64:67], v23, s[12:15], 0 offen offset:2048 sc1
    s_waitcnt vmcnt(7)
    ds_write_b128 v21, v[36:39] offset:1024
    v_max3_u32 v30, v30, v36, v37
    v_max3_u32 v30, v30, v38, v39
    buffer_load_dwordx4 v[68:71], v24, s[12:15], 0 offen offset:0 sc1
    buffer_load_dword v28, v27, s[80:83], s3 offen sc1
    s_waitcnt vmcnt(8)
    ds_write_b128 v21, v[40:43] offset:2048
    v_max3_u32 v30, v30, v40, v41
    v_max3_u32 v30, v30, v42, v43
    buffer_load_dwordx4 v[72:75], v24, s[12:15], 0 offen offset:1024 sc1
    s_waitcnt vmcnt(8)
    ds_write_b128 v22, v[44:47] offset:0
    v_max3_u32 v30, v30, v44, v45
    v_max3_u32 v30, v30, v46, v47
    buffer_load_dwordx4 v[76:79], v24, s[12:15], 0 offen offset:2048 sc1
    s_waitcnt vmcnt(8)
    ds_write_b128 v22, v[48:51] offset:1024
    v_max3_u32 v30, v30, v48, v49
    v_max3_u32 v30, v30, v50, v51
    buffer_load_dwordx4 v[80:83], v25, s[12:15], 0 offen offset:0 sc1
    s_waitcnt vmcnt(8)
    ds_write_b128 v22, v[52:55] offset:2048
    v_max3_u32 v30, v30, v52, v53
    v_max3_u32 v30, v30, v54, v55
    buffer_load_dwordx4 v[84:87], v25, s[12:15], 0 offen offset:1024 sc1
    s_waitcnt vmcnt(8)
    ds_write_b128 v23, v[56:59] offset:0
    v_max3_u32 v30, v30, v56, v57
    v_max3_u32 v30, v30, v58, v59
    buffer_load_dwordx4 v[88:91], v25, s[12:15], 0 offen offset:2048 sc1
    s_waitcnt vmcnt(8)
    ds_write_b128 v23, v[60:63] offset:1024
    v_max3_u32 v30, v30, v60, v61
    v_max3_u32 v30, v30, v62, v63
    buffer_load_dwordx4 v[92:95], v26, s[12:15], 0 offen offset:0 sc1
    s_waitcnt vmcnt(8)
    ds_write_b128 v23, v[64:67] offset:2048
    v_max3_u32 v30, v30, v64, v65
    v_max3_u32 v30, v30, v66, v67
    buffer_load_dwordx4 v[96:99], v26, s[12:15], 0 offen offset:1024 sc1
    s_waitcnt vmcnt(8)
    ds_write_b128 v24, v[68:71] offset:0
    v_max3_u32 v30, v30, v68, v69
    v_max3_u32 v30, v30, v70, v71
    buffer_load_dwordx4 v[108:111], v26, s[12:15], 0 offen offset:2048 sc1
    s_waitcnt vmcnt(8)
    v_cmp_gt_u32 vcc, v29, v28
    s_nop 0
    s_and_b32 s27, vcc_lo, 224
    s_cbranch_scc1 L_nlate
    s_waitcnt vmcnt(7)
    ds_write_b128 v24, v[72:75] offset:1024
    v_max3_u32 v30, v30, v72, v73
    v_max3_u32 v30, v30, v74, v75
    buffer_load_dwordx4 v[124:127], v100, s[12:15], 0 offen offset:0 sc1
    s_waitcnt vmcnt(7)
    ds_write_b128 v24, v[76:79] offset:2048
    v_max3_u32 v30, v30, v76, v77
    v_max3_u32 v30, v30, v78, v79
    buffer_load_dwordx4 v[128:131], v100, s[12:15], 0 offen offset:1024 sc1
    s_waitcnt vmcnt(7)
    ds_write_b128 v25, v[80:83] offset:0
    v_max3_u32 v30, v30, v80, v81
    v_max3_u32 v30, v30, v82, v83
    buffer_load_dwordx4 v[132:135], v100, s[12:15], 0 offen offset:2048 sc1
    s_waitcnt vmcnt(7)
    ds_write_b128 v25, v[84:87] offset:1024
    v_max3_u32 v30, v30, v84, v85
    v_max3_u32 v30, v30, v86, v87
    buffer_load_dwordx4 v[136:139], v101, s[12:15], 0 offen offset:0 sc1
    s_waitcnt vmcnt(7)
    ds_write_b128 v25, v[88:91] offset:2048
    v_max3_u32 v30, v30, v88, v89
    v_max3_u32 v30, v30, v90, v91
    buffer_load_dwordx4 v[140:143], v101, s[12:15], 0 offen offset:1024 sc1
    s_waitcnt vmcnt(7)
    ds_write_b128 v26, v[92:95] offset:0
    v_max3_u32 v30, v30, v92, v93
    v_max3_u32 v30, v30, v94, v95
    buffer_load_dwordx4 v[144:147], v101, s[12:15], 0 offen offset:2048 sc1
    s_waitcnt vmcnt(7)
    ds_write_b128 v26, v[96:99] offset:1024
    v_max3_u32 v30, v30, v96, v97
    v_max3_u32 v30, v30, v98, v99
    buffer_load_dwordx4 v[148:151], v102, s[12:15], 0 offen offset:0 sc1
    s_waitcnt vmcnt(7)
    ds_write_b128 v26, v[108:111] offset:2048
    v_max3_u32 v30, v30, v108, v109
    v_max3_u32 v30, v30, v110, v111
    buffer_load_dwordx4 v[152:155], v102, s[12:15], 0 offen offset:1024 sc1
    v_cmp_eq_u32 vcc, -1, v30
    s_nop 1
    s_cbranch_vccz L_mok
    s_waitcnt vmcnt(0) lgkmcnt(0)
    s_add_u32 s19, s19, 1
    s_cmp_lt_u32 s19, 0x4000
    s_cbranch_scc1 L_ldm
    s_branch L_mok
L_nlate:
    s_waitcnt vmcnt(7)
    ds_write_b128 v24, v[72:75] offset:1024
    v_max3_u32 v30, v30, v72, v73
    v_max3_u32 v30, v30, v74, v75
    s_waitcnt vmcnt(6)
    ds_write_b128 v24, v[76:79] offset:2048
    v_max3_u32 v30, v30, v76, v77
    v_max3_u32 v30, v30, v78, v79
    s_waitcnt vmcnt(5)
    ds_write_b128 v25, v[80:83] offset:0
    v_max3_u32 v30, v30, v80, v81
    v_max3_u32 v30, v30, v82, v83
    s_waitcnt vmcnt(4)
    ds_write_b128 v25, v[84:87] offset:1024
    v_max3_u32 v30, v30, v84, v85
    v_max3_u32 v30, v30, v86, v87
    s_waitcnt vmcnt(3)
    ds_write_b128 v25, v[88:91] offset:2048
    v_max3_u32 v30, v30, v88, v89
    v_max3_u32 v30, v30, v90, v91
    s_waitcnt vmcnt(2)
    ds_write_b128 v26, v[92:95] offset:0
    v_max3_u32 v30, v30, v92, v93
    v_max3_u32 v30, v30, v94, v95
    s_waitcnt vmcnt(1)
    ds_write_b128 v26, v[96:99] offset:1024
    v_max3_u32 v30, v30, v96, v97
    v_max3_u32 v30, v30, v98, v99
    s_waitcnt vmcnt(0)
    ds_write_b128 v26, v[108:111] offset:2048
    v_max3_u32 v30, v30, v108, v109
    v_max3_u32 v30, v30, v110, v111
    v_cmp_eq_u32 vcc, -1, v30
    s_nop 1
    s_cbranch_vccz L_mok2
    s_waitcnt vmcnt(0) lgkmcnt(0)
    s_add_u32 s19, s19, 1
    s_cmp_lt_u32 s19, 0x4000
    s_cbranch_scc1 L_ldm
L_mok2:
    buffer_load_dword v28, v27, s[80:83], s3 offen sc1
L_pn:
    buffer_load_dword v31, v27, s[80:83], s3 offen sc1
    s_waitcnt vmcnt(1)
    v_cmp_gt_u32 vcc, v29, v28
    s_nop 0
    s_and_b32 s27, vcc_lo, 224
    s_cbranch_scc0 L_pn_x
    s_sub_u32 s37, s37, 1
    s_cbranch_scc1 L_alone
    buffer_load_dword v28, v27, s[80:83], s3 offen sc1
    s_waitcnt vmcnt(1)
    v_cmp_gt_u32 vcc, v29, v31
    s_nop 0
    s_and_b32 s27, vcc_lo, 224
    s_cbranch_scc1 L_pn
L_pn_x:
    buffer_load_dwordx4 v[124:127], v100, s[12:15], 0 offen offset:0 sc1
    buffer_load_dwordx4 v[128:131], v100, s[12:15], 0 offen offset:1024 sc1
    buffer_load_dwordx4 v[132:135], v100, s[12:15], 0 offen offset:2048 sc1
    buffer_load_dwordx4 v[136:139], v101, s[12:15], 0 offen offset:0 sc1
    buffer_load_dwordx4 v[140:143], v101, s[12:15], 0 offen offset:1024 sc1
    buffer_load_dwordx4 v[144:147], v101, s[12:15], 0 offen offset:2048 sc1
    buffer_load_dwordx4 v[148:151], v102, s[12:15], 0 offen offset:0 sc1
    buffer_load_dwordx4 v[152:155], v102, s[12:15], 0 offen offset:1024 sc1
L_mok:
    s_mov_b32 s19, 0
    s_mov_b32 s66, 0xaaaaaaaa
    s_mov_b32 s67, 0xaaaaaaaa
    s_mov_b32 s70, 0x8000800
    s_mov_b32 s71, 0x8000800
    s_mov_b32 s56, 0x3330333
    s_mov_b32 s57, 0x3330333
    s_mov_b32 s58, 0x330033
    s_mov_b32 s59, 0x330033
    s_mov_b32 s60, 0xccc0ccc
    s_mov_b32 s61, 0xccc0ccc
    s_mov_b32 s62, 0xcc00cc
    s_mov_b32 s63, 0xcc00cc
    s_cmp_eq_u32 s38, 0
    s_cbranch_scc1 L_sh0
    s_cmp_eq_u32 s38, 1
    s_cbranch_scc1 L_sh1
    s_cmp_eq_u32 s38, 2
    s_cbranch_scc1 L_sh2
    s_waitcnt vmcnt(8) lgkmcnt(0)
    s_barrier
    v_accvgpr_read_b32 v96, a246
    v_accvgpr_read_b32 v97, a248
    v_accvgpr_read_b32 v94, a242
    v_accvgpr_read_b32 v95, a243
    v_accvgpr_read_b32 v92, a241
    v_mov_b32 v246, 0
    v_add_u32 v93, 0x10000, v92
    v_mov_b32 v203, 0
    v_mov_b32 v211, 0
    v_mov_b32 v219, 0
    v_accvgpr_read_b32 v227, a245
    v_accvgpr_read_b32 v226, a244
    v_cndmask_b32 v240, v244, v232, s[40:41]
    s_mov_b32 s18, s17
    ds_read_b128 a[192:195], v220 offset:18432
    ds_read_b128 a[196:199], v220 offset:6144
    ds_read_b128 a[200:203], v220 offset:19456
    ds_read_b128 a[204:207], v220 offset:7168
    ds_read_b128 a[208:211], v220 offset:20480
    buffer_load_dwordx4 v[156:159], v102, s[12:15], 0 offen offset:2048 sc1
    ds_read_b128 a[212:215], v220 offset:8192
    ds_read_b128 a[216:219], v220 offset:21504
    buffer_load_dwordx4 v[160:163], v103, s[12:15], 0 offen offset:0 sc1
    s_waitcnt vmcnt(9)
    ds_write_b128 v100, v[124:127] offset:0
    ds_read_b128 a[220:223], v220 offset:9216
    ds_read_b128 a[224:227], v220 offset:22528
    buffer_load_dwordx4 v[164:167], v103, s[12:15], 0 offen offset:1024 sc1
    s_waitcnt vmcnt(9)
    ds_write_b128 v100, v[128:131] offset:1024
    ds_read_b128 a[228:231], v220 offset:10240
    ds_read_b128 a[232:235], v220 offset:23552
    s_waitcnt lgkmcnt(12)
    v_mfma_f32_16x16x32_bf16 v[64:67], a[192:195], a[72:75], 0
    ds_read_b128 a[236:239], v220 offset:11264
    v_mfma_f32_16x16x32_bf16 v[68:71], a[192:195], a[96:99], 0
    v_mfma_f32_16x16x32_bf16 v[72:75], a[192:195], a[120:123], 0
    v_mfma_f32_16x16x32_bf16 v[0:3], a[192:195], a[144:147], 0
    ds_read_b128 a[192:195], v220 offset:43008
    s_waitcnt lgkmcnt(10)
    v_mfma_f32_16x16x32_bf16 v[4:7], a[196:199], a[144:147], 0
    ds_read_b128 a[196:199], v220 offset:30720
    v_mfma_f32_16x16x32_bf16 v[64:67], a[200:203], a[76:79], v[64:67]
    v_mfma_f32_16x16x32_bf16 v[68:71], a[200:203], a[100:103], v[68:71]
    v_max3_u32 v246, v246, v124, v125
    v_max3_u32 v246, v246, v126, v127
    v_mfma_f32_16x16x32_bf16 v[72:75], a[200:203], a[124:127], v[72:75]
    v_mfma_f32_16x16x32_bf16 v[0:3], a[200:203], a[148:151], v[0:3]
    ds_read_b128 a[200:203], v220 offset:44032
    v_mfma_f32_16x16x32_bf16 v[4:7], a[204:207], a[148:151], v[4:7]
    ds_read_b128 a[204:207], v220 offset:31744
    v_mfma_f32_16x16x32_bf16 v[64:67], a[208:211], a[80:83], v[64:67]
    v_max3_u32 v246, v246, v128, v129
    v_max3_u32 v246, v246, v130, v131
    v_mfma_f32_16x16x32_bf16 v[68:71], a[208:211], a[104:107], v[68:71]
    v_mov_b32 v131, 0
    v_mfma_f32_16x16x32_bf16 v[72:75], a[208:211], a[128:131], v[72:75]
    v_mfma_f32_16x16x32_bf16 v[0:3], a[208:211], a[152:155], v[0:3]
    ds_read_b128 a[208:211], v220 offset:45056
    s_waitcnt lgkmcnt(6)
    v_mfma_f32_16x16x32_bf16 v[4:7], a[212:215], a[152:155], v[4:7]
    s_waitcnt vmcnt(8)
    ds_write_b128 v100, v[132:135] offset:2048
    v_mfma_f32_16x16x32_bf16 v[64:67], a[216:219], a[84:87], v[64:67]
    v_max3_u32 v246, v246, v132, v133
    v_max3_u32 v246, v246, v134, v135
    v_mfma_f32_16x16x32_bf16 v[68:71], a[216:219], a[108:111], v[68:71]
    buffer_load_dwordx4 v[168:171], v103, s[12:15], 0 offen offset:2048 sc1
    v_mfma_f32_16x16x32_bf16 v[72:75], a[216:219], a[132:135], v[72:75]
    ds_read_b128 a[212:215], v220 offset:32768
    v_mfma_f32_16x16x32_bf16 v[0:3], a[216:219], a[156:159], v[0:3]
    s_waitcnt vmcnt(8)
    ds_write_b128 v101, v[136:139] offset:0
    v_mfma_f32_16x16x32_bf16 v[4:7], a[220:223], a[156:159], v[4:7]
    v_max3_u32 v246, v246, v136, v137
    v_max3_u32 v246, v246, v138, v139
    v_mfma_f32_16x16x32_bf16 v[64:67], a[224:227], a[88:91], v[64:67]
    buffer_load_dwordx4 v[172:175], v104, s[12:15], 0 offen offset:0 sc1
    v_mfma_f32_16x16x32_bf16 v[68:71], a[224:227], a[112:115], v[68:71]
    ds_read_b128 a[216:219], v220 offset:46080
    ds_read_b128 a[220:223], v220 offset:33792
    v_mfma_f32_16x16x32_bf16 v[72:75], a[224:227], a[136:139], v[72:75]
    s_waitcnt vmcnt(8)
    ds_write_b128 v101, v[140:143] offset:1024
    v_mfma_f32_16x16x32_bf16 v[0:3], a[224:227], a[160:163], v[0:3]
    v_max3_u32 v246, v246, v140, v141
    v_max3_u32 v246, v246, v142, v143
    v_mfma_f32_16x16x32_bf16 v[4:7], a[228:231], a[160:163], v[4:7]
    buffer_load_dwordx4 v[176:179], v104, s[12:15], 0 offen offset:1024 sc1
    v_mfma_f32_16x16x32_bf16 v[64:67], a[232:235], a[92:95], v[64:67]
    ds_read_b128 a[224:227], v220 offset:47104
    ds_read_b128 a[228:231], v220 offset:34816
    v_mfma_f32_16x16x32_bf16 v[68:71], a[232:235], a[116:119], v[68:71]
    s_waitcnt vmcnt(8)
    ds_write_b128 v101, v[144:147] offset:2048
    v_mfma_f32_16x16x32_bf16 v[72:75], a[232:235], a[140:143], v[72:75]
    v_max3_u32 v246, v246, v144, v145
    v_max3_u32 v246, v246, v146, v147
    v_mfma_f32_16x16x32_bf16 v[0:3], a[232:235], a[164:167], v[0:3]
    buffer_load_dwordx4 v[180:183], v104, s[12:15], 0 offen offset:2048 sc1
    s_waitcnt lgkmcnt(8)
    v_mfma_f32_16x16x32_bf16 v[4:7], a[236:239], a[164:167], v[4:7]
    ds_read_b128 a[232:235], v220 offset:48128
    v_cvt_pk_bf16_f32 v64, v64, v65
    v_mfma_f32_16x16x32_bf16 v[76:79], a[192:195], a[72:75], 0
    s_waitcnt vmcnt(8)
    ds_write_b128 v102, v[148:151] offset:0
    v_mfma_f32_16x16x32_bf16 v[80:83], a[192:195], a[96:99], 0
    v_cvt_pk_bf16_f32 v68, v68, v69
    v_cvt_pk_bf16_f32 v72, v72, v73
    v_mfma_f32_16x16x32_bf16 v[84:87], a[192:195], a[120:123], 0
    buffer_load_dwordx4 v[184:187], v105, s[12:15], 0 offen offset:0 sc1
    v_mfma_f32_16x16x32_bf16 v[8:11], a[192:195], a[144:147], 0
    ds_read_b128 a[236:239], v220 offset:35840
    v_cvt_pk_bf16_f32 v0, v0, v1
    v_mfma_f32_16x16x32_bf16 v[12:15], a[196:199], a[144:147], 0
    s_waitcnt vmcnt(8)
    ds_write_b128 v102, v[152:155] offset:1024
    v_mfma_f32_16x16x32_bf16 v[76:79], a[200:203], a[76:79], v[76:79]
    v_cvt_pk_bf16_f32 v4, v4, v5
    v_cvt_pk_bf16_f32 v65, v66, v67
    v_mfma_f32_16x16x32_bf16 v[80:83], a[200:203], a[100:103], v[80:83]
    ds_write_b64 v222, v[64:65] offset:16392
    v_mfma_f32_16x16x32_bf16 v[84:87], a[200:203], a[124:127], v[84:87]
    buffer_load_dwordx4 v[188:191], v105, s[12:15], 0 offen offset:1024 sc1
    v_mfma_f32_16x16x32_bf16 v[8:11], a[200:203], a[148:151], v[8:11]
    s_waitcnt vmcnt(8)
    ds_write_b128 v102, v[156:159] offset:2048
    v_mfma_f32_16x16x32_bf16 v[12:15], a[204:207], a[148:151], v[12:15]
    buffer_load_dwordx4 a[0:3], v223, s[4:7], s17 offen offset:0
    v_mfma_f32_16x16x32_bf16 v[76:79], a[208:211], a[80:83], v[76:79]
    buffer_load_dwordx4 v[192:195], v105, s[12:15], 0 offen offset:2048 sc1
    v_mfma_f32_16x16x32_bf16 v[80:83], a[208:211], a[104:107], v[80:83]
    buffer_load_dwordx4 a[4:7], v223, s[4:7], s17 offen offset:64
    v_mfma_f32_16x16x32_bf16 v[84:87], a[208:211], a[128:131], v[84:87]
    s_waitcnt vmcnt(10)
    ds_write_b128 v103, v[160:163] offset:0
    v_mfma_f32_16x16x32_bf16 v[8:11], a[208:211], a[152:155], v[8:11]
    v_cvt_pk_bf16_f32 v69, v70, v71
    v_cvt_pk_bf16_f32 v73, v74, v75
    s_waitcnt lgkmcnt(5)
    v_mfma_f32_16x16x32_bf16 v[12:15], a[212:215], a[152:155], v[12:15]
    ds_write_b64 v222, v[68:69] offset:17928
    v_mfma_f32_16x16x32_bf16 v[76:79], a[216:219], a[84:87], v[76:79]
    ds_write_b64 v229, v[72:73] offset:20480
    v_mfma_f32_16x16x32_bf16 v[80:83], a[216:219], a[108:111], v[80:83]
    s_waitcnt vmcnt(9)
    ds_write_b128 v103, v[164:167] offset:1024
    v_mfma_f32_16x16x32_bf16 v[84:87], a[216:219], a[132:135], v[84:87]
    v_cvt_pk_bf16_f32 v1, v2, v3
    v_cvt_pk_bf16_f32 v5, v6, v7
    v_mfma_f32_16x16x32_bf16 v[8:11], a[216:219], a[156:159], v[8:11]
    ds_write2_b32 v228, v0, v1 offset0:16 offset1:20
    v_mfma_f32_16x16x32_bf16 v[12:15], a[220:223], a[156:159], v[12:15]
    ds_write2_b32 v228, v4, v5 offset0:0 offset1:4
    v_mfma_f32_16x16x32_bf16 v[76:79], a[224:227], a[88:91], v[76:79]
    ds_read_b128 a[192:195], v221 offset:2048
    v_xor_b32 v228, 0x2000, v228
    v_mfma_f32_16x16x32_bf16 v[80:83], a[224:227], a[112:115], v[80:83]
    s_waitcnt vmcnt(8)
    ds_write_b128 v103, v[168:171] offset:2048
    v_mfma_f32_16x16x32_bf16 v[84:87], a[224:227], a[136:139], v[84:87]
    buffer_load_dwordx4 a[24:27], v224, s[4:7], s17 offen offset:0
    v_mfma_f32_16x16x32_bf16 v[8:11], a[224:227], a[160:163], v[8:11]
    ds_read_b128 a[196:199], v220 offset:55296
    ds_read_b128 a[200:203], v221 offset:3072
    v_mfma_f32_16x16x32_bf16 v[12:15], a[228:231], a[160:163], v[12:15]
    buffer_load_dwordx4 a[28:31], v224, s[4:7], s17 offen offset:64
    v_mfma_f32_16x16x32_bf16 v[76:79], a[232:235], a[92:95], v[76:79]
    s_waitcnt vmcnt(9)
    ds_write_b128 v104, v[172:175] offset:0
    v_mfma_f32_16x16x32_bf16 v[80:83], a[232:235], a[116:119], v[80:83]
    s_waitcnt lgkmcnt(5)
    s_barrier
    v_max3_u32 v246, v246, v148, v149
    v_mfma_f32_16x16x32_bf16 v[84:87], a[232:235], a[140:143], v[84:87]
    ds_read2_b32 v[16:17], v96 offset0:0 offset1:4
    ds_read2_b32 v[18:19], v96 offset0:1 offset1:5
    v_mfma_f32_16x16x32_bf16 v[8:11], a[232:235], a[164:167], v[8:11]
L_pad4:
    s_cbranch_execz L_pad5
    ds_read2_b32 v[20:21], v96 offset0:16 offset1:20
    v_cvt_pk_bf16_f32 v76, v76, v77
    v_mfma_f32_16x16x32_bf16 v[12:15], a[236:239], a[164:167], v[12:15]
    ds_read2_b32 v[22:23], v96 offset0:17 offset1:21
    v_cvt_pk_bf16_f32 v80, v80, v81
    v_cvt_pk_bf16_f32 v84, v84, v85
    s_waitcnt lgkmcnt(8)
    v_mfma_f32_16x16x32_bf16 v[64:67], a[192:195], a[72:75], 0
    s_mov_b64 exec, s[60:61]
    ds_read_b128 a[168:171], v97 offset:20992
    s_mov_b64 exec, -1
    v_cvt_pk_bf16_f32 v8, v8, v9
    v_mfma_f32_16x16x32_bf16 v[68:71], a[192:195], a[96:99], 0
    s_mov_b64 exec, s[62:63]
    ds_read_b128 a[180:183], v97 offset:21136
    s_mov_b64 exec, -1
    v_cvt_pk_bf16_f32 v12, v12, v13
    v_mfma_f32_16x16x32_bf16 v[72:75], a[192:195], a[120:123], 0
    ds_read_b128 a[204:207], v220 offset:56320
    v_cvt_pk_bf16_f32 v77, v78, v79
    v_mfma_f32_16x16x32_bf16 v[0:3], a[192:195], a[144:147], 0
    ds_write_b64 v222, v[76:77] offset:24584
    s_waitcnt lgkmcnt(10)
    v_mfma_f32_16x16x32_bf16 v[4:7], a[196:199], a[144:147], 0
    s_waitcnt vmcnt(8)
    ds_write_b128 v104, v[176:179] offset:1024
    s_waitcnt lgkmcnt(10)
    v_mfma_f32_16x16x32_bf16 v[64:67], a[200:203], a[76:79], v[64:67]
    buffer_load_dwordx4 a[48:51], v225, s[4:7], s17 offen offset:0
    v_mfma_f32_16x16x32_bf16 v[68:71], a[200:203], a[100:103], v[68:71]
    ds_read_b128 a[208:211], v221 offset:4096
    v_cvt_pk_bf16_f32 v81, v82, v83
    v_mfma_f32_16x16x32_bf16 v[72:75], a[200:203], a[124:127], v[72:75]
    ds_write_b64 v222, v[80:81] offset:26120
    v_mfma_f32_16x16x32_bf16 v[0:3], a[200:203], a[148:151], v[0:3]
    s_waitcnt vmcnt(8)
    ds_write_b128 v104, v[180:183] offset:2048
    v_cvt_pk_bf16_f32 v85, v86, v87
    v_cvt_pk_bf16_f32 v9, v10, v11
    v_cvt_pk_bf16_f32 v13, v14, v15
    ds_write_b64 v229, v[84:85] offset:28672
    ds_write2_b32 v228, v8, v9 offset0:16 offset1:20
    v_xor_b32 v96, 0x2000, v96
    s_waitcnt lgkmcnt(7)
    v_mfma_f32_16x16x32_bf16 v[4:7], a[204:207], a[148:151], v[4:7]
    ds_write2_b32 v228, v12, v13 offset0:0 offset1:4
    v_mfma_f32_16x16x32_bf16 v[48:51], a[72:75], v[16:19], 0
    ds_read_b128 a[212:215], v220 offset:57344
    v_xor_b32 v228, 0x2000, v228
    v_mfma_f32_16x16x32_bf16 v[52:55], a[96:99], v[16:19], 0
    s_waitcnt vmcnt(7)
    ds_write_b128 v105, v[184:187] offset:0
    v_mfma_f32_16x16x32_bf16 v[56:59], a[120:123], v[16:19], 0
    buffer_load_dwordx4 a[52:55], v225, s[4:7], s17 offen offset:64
    v_mfma_f32_16x16x32_bf16 v[60:63], a[144:147], v[16:19], 0
    s_waitcnt vmcnt(7)
    ds_write_b128 v105, v[188:191] offset:1024
    s_waitcnt lgkmcnt(8)
    v_mfma_f32_16x16x32_bf16 v[64:67], a[208:211], a[80:83], v[64:67]
    v_max3_u32 v246, v246, v150, v151
    v_max3_u32 v246, v246, v152, v153
    v_mfma_f32_16x16x32_bf16 v[68:71], a[208:211], a[104:107], v[68:71]
    s_waitcnt lgkmcnt(3)
    ds_read_b128 a[216:219], v221 offset:5120
    s_barrier
    v_mfma_f32_16x16x32_bf16 v[72:75], a[208:211], a[128:131], v[72:75]
    ds_read2_b32 v[24:25], v96 offset0:0 offset1:4
    ds_read2_b32 v[26:27], v96 offset0:1 offset1:5
    v_mfma_f32_16x16x32_bf16 v[0:3], a[208:211], a[152:155], v[0:3]
    ds_read2_b32 v[28:29], v96 offset0:16 offset1:20
    ds_read2_b32 v[30:31], v96 offset0:17 offset1:21
    s_mov_b64 exec, s[60:61]
    ds_read_b128 a[172:175], v97 offset:29184
    s_mov_b64 exec, -1
    s_mov_b64 exec, s[62:63]
    ds_read_b128 a[184:187], v97 offset:29328
    s_mov_b64 exec, -1
    v_xor_b32 v96, 0x2000, v96
    s_waitcnt vmcnt(5)
    ds_write_b128 v105, v[192:195] offset:2048
    v_max3_u32 v246, v246, v154, v155
    s_waitcnt lgkmcnt(10)
    v_mfma_f32_16x16x32_bf16 v[4:7], a[212:215], a[152:155], v[4:7]
    buffer_load_dwordx4 a[8:11], v223, s[4:7], s17 offen offset:128
    v_mfma_f32_16x16x32_bf16 v[48:51], a[76:79], v[20:23], v[48:51]
    ds_read_b128 a[220:223], v220 offset:58368
    ds_read_b128 a[224:227], v221 offset:6144
    v_mfma_f32_16x16x32_bf16 v[52:55], a[100:103], v[20:23], v[52:55]
    buffer_load_dwordx4 a[12:15], v223, s[4:7], s17 offen offset:192
    v_mfma_f32_16x16x32_bf16 v[56:59], a[124:127], v[20:23], v[56:59]
    ds_read_b128 a[228:231], v220 offset:59392
    ds_read_b128 a[232:235], v221 offset:7168
    v_mfma_f32_16x16x32_bf16 v[60:63], a[148:151], v[20:23], v[60:63]
    ds_read_b128 a[236:239], v220 offset:60416
    ds_read_b64_tr_b16 a[192:193], v92 offset:0
    ds_read_b64_tr_b16 a[194:195], v92 offset:6144
    ds_read_b64_tr_b16 a[196:197], v92 offset:12288
    ds_read_b64_tr_b16 a[198:199], v92 offset:18432
    ds_read_b64_tr_b16 a[200:201], v92 offset:24576
    ds_read_b64_tr_b16 a[202:203], v92 offset:30720
    ds_read_b64_tr_b16 a[204:205], v92 offset:36864
    s_waitcnt lgkmcnt(15)
    v_mfma_f32_16x16x32_bf16 v[64:67], a[216:219], a[84:87], v[64:67]
    ds_read_b64_tr_b16 a[206:207], v92 offset:43008
    ds_read_b64_tr_b16 a[208:209], v92 offset:49152
    v_mfma_f32_16x16x32_bf16 v[68:71], a[216:219], a[108:111], v[68:71]
    ds_read_b64_tr_b16 a[210:211], v92 offset:55296
    ds_read_b64_tr_b16 a[212:213], v92 offset:61440
    v_mfma_f32_16x16x32_bf16 v[72:75], a[216:219], a[132:135], v[72:75]
    ds_read_b64_tr_b16 a[214:215], v93 offset:2048
    v_max3_u32 v246, v246, v156, v157
    v_mfma_f32_16x16x32_bf16 v[0:3], a[216:219], a[156:159], v[0:3]
    buffer_load_dwordx4 a[32:35], v224, s[4:7], s17 offen offset:128
    buffer_load_dwordx4 a[36:39], v224, s[4:7], s17 offen offset:192
    ds_read_b64_tr_b16 a[216:217], v92 offset:1024
    ds_read_b64_tr_b16 a[218:219], v92 offset:7168
    s_waitcnt lgkmcnt(15)
    v_mfma_f32_16x16x32_bf16 v[4:7], a[220:223], a[156:159], v[4:7]
    ds_read_b64_tr_b16 a[220:221], v92 offset:13312
    ds_read_b64_tr_b16 a[222:223], v92 offset:19456
    v_mfma_f32_16x16x32_bf16 v[64:67], a[224:227], a[88:91], v[64:67]
    v_max3_u32 v246, v246, v158, v159
    v_max3_u32 v246, v246, v160, v161
    v_mfma_f32_16x16x32_bf16 v[68:71], a[224:227], a[112:115], v[68:71]
    v_max3_u32 v246, v246, v162, v163
    v_max3_u32 v246, v246, v164, v165
    v_mfma_f32_16x16x32_bf16 v[72:75], a[224:227], a[136:139], v[72:75]
    v_max3_u32 v246, v246, v166, v167
    v_max3_u32 v246, v246, v168, v169
    v_mfma_f32_16x16x32_bf16 v[0:3], a[224:227], a[160:163], v[0:3]
    ds_read_b64_tr_b16 a[224:225], v92 offset:25600
    ds_read_b64_tr_b16 a[226:227], v92 offset:31744
    v_mfma_f32_16x16x32_bf16 v[4:7], a[228:231], a[160:163], v[4:7]
    ds_read_b64_tr_b16 a[228:229], v92 offset:37888
    ds_read_b64_tr_b16 a[230:231], v92 offset:44032
    v_mfma_f32_16x16x32_bf16 v[64:67], a[232:235], a[92:95], v[64:67]
    v_max3_u32 v246, v246, v170, v171
    v_max3_u32 v246, v246, v172, v173
    v_mfma_f32_16x16x32_bf16 v[68:71], a[232:235], a[116:119], v[68:71]
    v_max3_u32 v246, v246, v174, v175
    v_max3_u32 v246, v246, v176, v177
    v_mfma_f32_16x16x32_bf16 v[72:75], a[232:235], a[140:143], v[72:75]
    v_max3_u32 v246, v246, v178, v179
    v_max3_u32 v246, v246, v180, v181
    v_mfma_f32_16x16x32_bf16 v[0:3], a[232:235], a[164:167], v[0:3]
    ds_read_b64_tr_b16 a[232:233], v92 offset:50176
    v_cvt_pk_bf16_f32 v64, v64, v65
    s_waitcnt lgkmcnt(9)
    v_mfma_f32_16x16x32_bf16 v[4:7], a[236:239], a[164:167], v[4:7]
    ds_read_b64_tr_b16 a[234:235], v92 offset:56320
    v_cvt_pk_bf16_f32 v68, v68, v69
    v_cvt_pk_bf16_f32 v65, v66, v67
    v_cvt_pk_bf16_f32 v69, v70, v71
    v_cvt_pk_bf16_f32 v72, v72, v73
    v_cvt_pk_bf16_f32 v73, v74, v75
    v_max3_u32 v246, v246, v182, v183
    v_max3_u32 v246, v246, v184, v185
    v_cvt_pk_bf16_f32 v0, v0, v1
    v_cvt_pk_bf16_f32 v1, v2, v3
    v_max3_u32 v246, v246, v186, v187
    v_max3_u32 v246, v246, v188, v189
    v_cvt_pk_bf16_f32 v4, v4, v5
    v_cvt_pk_bf16_f32 v5, v6, v7
    v_max3_u32 v246, v246, v190, v191
    v_max3_u32 v246, v246, v192, v193
    v_max3_u32 v246, v246, v194, v195
    v_cmp_eq_u32 vcc, -1, v246
    s_nop 1
    s_cbranch_vccnz L_again
L_back3:
    buffer_load_dwordx4 a[56:59], v225, s[4:7], s17 offen offset:128
    ds_write_b64 v222, v[64:65] offset:16392
    v_mfma_f32_16x16x32_bf16 v[64:67], a[192:195], a[144:147], 0
    ds_write_b64 v222, v[68:69] offset:17928
    v_mfma_f32_16x16x32_bf16 v[64:67], a[196:199], a[148:151], v[64:67]
    ds_write_b64 v229, v[72:73] offset:20480
    v_mfma_f32_16x16x32_bf16 v[64:67], a[200:203], a[152:155], v[64:67]
    ds_write2_b32 v228, v0, v1 offset0:16 offset1:20
    v_mfma_f32_16x16x32_bf16 v[64:67], a[204:207], a[156:159], v[64:67]
    ds_write2_b32 v228, v4, v5 offset0:0 offset1:4
    v_mfma_f32_16x16x32_bf16 v[64:67], a[208:211], a[160:163], v[64:67]
    ds_read_b64_tr_b16 a[236:237], v92 offset:62464
    ds_read_b64_tr_b16 a[238:239], v93 offset:3072
    v_mfma_f32_16x16x32_bf16 v[64:67], a[212:215], a[164:167], v[64:67]
    ds_read_b64_tr_b16 a[192:193], v92 offset:2048
    ds_read_b64_tr_b16 a[194:195], v92 offset:8192
    s_waitcnt lgkmcnt(11)
    v_mfma_f32_16x16x32_bf16 v[68:71], a[216:219], a[144:147], 0
    ds_read_b64_tr_b16 a[196:197], v92 offset:14336
    ds_read_b64_tr_b16 a[198:199], v92 offset:20480
    v_mfma_f32_16x16x32_bf16 v[68:71], a[220:223], a[148:151], v[68:71]
    ds_read_b64_tr_b16 a[200:201], v92 offset:26624
    ds_read_b64_tr_b16 a[202:203], v92 offset:32768
    v_mfma_f32_16x16x32_bf16 v[68:71], a[224:227], a[152:155], v[68:71]
    buffer_load_dwordx4 a[60:63], v225, s[4:7], s17 offen offset:192
    v_mfma_f32_16x16x32_bf16 v[68:71], a[228:231], a[156:159], v[68:71]
    ds_read_b64_tr_b16 a[204:205], v92 offset:38912
    v_cvt_pk_bf16_f32 v64, v64, v65
    s_waitcnt lgkmcnt(14)
    v_mfma_f32_16x16x32_bf16 v[68:71], a[232:235], a[160:163], v[68:71]
    ds_read_b64_tr_b16 a[206:207], v92 offset:45056
    s_waitcnt lgkmcnt(10)
    s_barrier
    s_mov_b64 exec, s[60:61]
    ds_read_b128 a[176:179], v97 offset:20992
    s_mov_b64 exec, -1
    s_mov_b64 exec, s[62:63]
    ds_read_b128 a[188:191], v97 offset:21136
    s_mov_b64 exec, -1
    v_cvt_pk_bf16_f32 v65, v66, v67
    ds_write2_b32 v94, v64, v65 offset0:0 offset1:4
    ds_read2_b32 v[16:17], v96 offset0:0 offset1:4
    ds_read2_b32 v[18:19], v96 offset0:1 offset1:5
    ds_read2_b32 v[20:21], v96 offset0:16 offset1:20
    ds_read2_b32 v[22:23], v96 offset0:17 offset1:21
    ds_read_b64_tr_b16 a[208:209], v92 offset:51200
    ds_read_b64_tr_b16 a[210:211], v92 offset:57344
    ds_read_b64_tr_b16 a[212:213], v92 offset:63488
    ds_read_b64_tr_b16 a[214:215], v93 offset:4096
    ds_read_b64_tr_b16 a[216:217], v92 offset:3072
    ds_read_b64_tr_b16 a[218:219], v92 offset:9216
    ds_read_b64_tr_b16 a[220:221], v92 offset:15360
    ds_read_b64_tr_b16 a[222:223], v92 offset:21504
    s_waitcnt lgkmcnt(15)
    v_mfma_f32_16x16x32_bf16 v[68:71], a[236:239], a[164:167], v[68:71]
    ds_read_b64_tr_b16 a[224:225], v92 offset:27648
    ds_read_b64_tr_b16 a[226:227], v92 offset:33792
    v_mfma_f32_16x16x32_bf16 v[48:51], a[80:83], v[24:27], v[48:51]
    ds_read_b64_tr_b16 a[228:229], v92 offset:39936
    ds_read_b64_tr_b16 a[230:231], v92 offset:46080
    v_mfma_f32_16x16x32_bf16 v[52:55], a[104:107], v[24:27], v[52:55]
    ds_read_b64_tr_b16 a[232:233], v92 offset:52224
    ds_read_b64_tr_b16 a[234:235], v92 offset:58368
    v_mfma_f32_16x16x32_bf16 v[56:59], a[128:131], v[24:27], v[56:59]
    ds_read_b64_tr_b16 a[236:237], v92 offset:64512
    v_cvt_pk_bf16_f32 v68, v68, v69
    v_mfma_f32_16x16x32_bf16 v[60:63], a[152:155], v[24:27], v[60:63]
    buffer_load_dwordx4 a[16:19], v223, s[4:7], s17 offen offset:256
    v_mfma_f32_16x16x32_bf16 v[72:75], a[192:195], a[144:147], 0
    buffer_load_dwordx4 a[20:23], v223, s[4:7], s17 offen offset:320
    v_mfma_f32_16x16x32_bf16 v[72:75], a[196:199], a[148:151], v[72:75]
    ds_read_b64_tr_b16 a[238:239], v93 offset:5120
    v_cvt_pk_bf16_f32 v69, v70, v71
    v_mfma_f32_16x16x32_bf16 v[72:75], a[200:203], a[152:155], v[72:75]
    ds_write2_b32 v94, v68, v69 offset0:16 offset1:20
    v_mfma_f32_16x16x32_bf16 v[72:75], a[204:207], a[156:159], v[72:75]
    ds_read_b64_tr_b16 a[192:193], v92 offset:4096
    ds_read_b64_tr_b16 a[194:195], v92 offset:10240
    ds_read_b64_tr_b16 a[196:197], v92 offset:16384
    ds_read_b64_tr_b16 a[198:199], v92 offset:22528
    ds_read_b64_tr_b16 a[200:201], v92 offset:28672
    s_waitcnt lgkmcnt(15)
    v_mfma_f32_16x16x32_bf16 v[72:75], a[208:211], a[160:163], v[72:75]
    ds_read_b64_tr_b16 a[202:203], v92 offset:34816
    ds_read_b64_tr_b16 a[204:205], v92 offset:40960
    v_mfma_f32_16x16x32_bf16 v[72:75], a[212:215], a[164:167], v[72:75]
    ds_read_b64_tr_b16 a[206:207], v92 offset:47104
    ds_read_b64_tr_b16 a[208:209], v92 offset:53248
    v_mfma_f32_16x16x32_bf16 v[48:51], a[84:87], v[28:31], v[48:51]
    ds_read_b64_tr_b16 a[210:211], v92 offset:59392
    ds_read_b64_tr_b16 a[212:213], v93 offset:0
    v_mfma_f32_16x16x32_bf16 v[52:55], a[108:111], v[28:31], v[52:55]
    ds_read_b64_tr_b16 a[214:215], v93 offset:6144
    v_mov_b32 v139, 0
    v_mfma_f32_16x16x32_bf16 v[56:59], a[132:135], v[28:31], v[56:59]
    v_cvt_pk_bf16_f32 v72, v72, v73
    v_cvt_pk_bf16_f32 v73, v74, v75
    v_mfma_f32_16x16x32_bf16 v[60:63], a[156:159], v[28:31], v[60:63]
    ds_write2_b32 v94, v72, v73 offset0:32 offset1:36
    v_mfma_f32_16x16x32_bf16 v[76:79], a[216:219], a[144:147], 0
    ds_read_b64_tr_b16 a[216:217], v92 offset:5120
    ds_read_b64_tr_b16 a[218:219], v92 offset:11264
    s_waitcnt lgkmcnt(15)
    v_mfma_f32_16x16x32_bf16 v[76:79], a[220:223], a[148:151], v[76:79]
    buffer_load_dwordx4 a[40:43], v224, s[4:7], s17 offen offset:256
    v_mfma_f32_16x16x32_bf16 v[76:79], a[224:227], a[152:155], v[76:79]
    buffer_load_dwordx4 a[44:47], v224, s[4:7], s17 offen offset:320
    v_mfma_f32_16x16x32_bf16 v[76:79], a[228:231], a[156:159], v[76:79]
    ds_read_b64_tr_b16 a[220:221], v92 offset:17408
    ds_read_b64_tr_b16 a[222:223], v92 offset:23552
    v_mfma_f32_16x16x32_bf16 v[76:79], a[232:235], a[160:163], v[76:79]
    ds_read_b64_tr_b16 a[224:225], v92 offset:29696
    ds_read_b64_tr_b16 a[226:227], v92 offset:35840
    v_mfma_f32_16x16x32_bf16 v[76:79], a[236:239], a[164:167], v[76:79]
    ds_read_b64_tr_b16 a[228:229], v92 offset:41984
    ds_read_b64_tr_b16 a[230:231], v92 offset:48128
    s_waitcnt lgkmcnt(15)
    v_mfma_f32_16x16x32_bf16 v[80:83], a[192:195], a[144:147], 0
    ds_read_b64_tr_b16 a[232:233], v92 offset:54272
    ds_read_b64_tr_b16 a[234:235], v92 offset:60416
    v_mfma_f32_16x16x32_bf16 v[80:83], a[196:199], a[148:151], v[80:83]
    ds_read_b64_tr_b16 a[236:237], v93 offset:1024
    ds_read_b64_tr_b16 a[238:239], v93 offset:7168
    v_mfma_f32_16x16x32_bf16 v[80:83], a[200:203], a[152:155], v[80:83]
    ds_read_b128 a[192:195], v221 offset:26624
    v_cvt_pk_bf16_f32 v76, v76, v77
    s_waitcnt lgkmcnt(15)
    v_mfma_f32_16x16x32_bf16 v[80:83], a[204:207], a[156:159], v[80:83]
    ds_read_b128 a[196:199], v221 offset:14336
    v_cvt_pk_bf16_f32 v77, v78, v79
    v_mfma_f32_16x16x32_bf16 v[80:83], a[208:211], a[160:163], v[80:83]
    ds_write2_b32 v94, v76, v77 offset0:48 offset1:52
    s_waitcnt lgkmcnt(15)
    v_mfma_f32_16x16x32_bf16 v[80:83], a[212:215], a[164:167], v[80:83]
    ds_read_b128 a[200:203], v221 offset:27648
    ds_read_b128 a[204:207], v221 offset:15360
    v_mfma_f32_16x16x32_bf16 v[48:51], a[88:91], v[16:19], v[48:51]
    ds_read_b128 a[208:211], v221 offset:28672
    ds_read_b128 a[212:215], v221 offset:16384
    v_mfma_f32_16x16x32_bf16 v[52:55], a[112:115], v[16:19], v[52:55]
    v_mov_b32 v147, 0
    v_mov_b32 v155, 0
    v_mfma_f32_16x16x32_bf16 v[56:59], a[136:139], v[16:19], v[56:59]
    buffer_load_dwordx4 a[64:67], v225, s[4:7], s17 offen offset:256
    v_mfma_f32_16x16x32_bf16 v[60:63], a[160:163], v[16:19], v[60:63]
    buffer_load_dwordx4 a[68:71], v225, s[4:7], s17 offen offset:320
    v_mfma_f32_16x16x32_bf16 v[48:51], a[92:95], v[20:23], v[48:51]
    v_cvt_pk_bf16_f32 v80, v80, v81
    v_cvt_pk_bf16_f32 v81, v82, v83
    v_mfma_f32_16x16x32_bf16 v[52:55], a[116:119], v[20:23], v[52:55]
    ds_write2_b32 v94, v80, v81 offset0:64 offset1:68
    v_mfma_f32_16x16x32_bf16 v[56:59], a[140:143], v[20:23], v[56:59]
    v_mov_b32 v228, 0x4444
    v_mov_b32 v96, 0xeeee
    v_mfma_f32_16x16x32_bf16 v[60:63], a[164:167], v[20:23], v[60:63]
    v_max3_f32 v250, v48, v49, v50
    v_cndmask_b32 v228, v228, v96, s[66:67]
    s_waitcnt lgkmcnt(12)
    v_mfma_f32_16x16x32_bf16 v[84:87], a[216:219], a[144:147], 0
    ds_read_b128 a[216:219], v221 offset:29696
    v_max3_f32 v251, v51, v52, v53
    v_mfma_f32_16x16x32_bf16 v[84:87], a[220:223], a[148:151], v[84:87]
    ds_read_b128 a[220:223], v221 offset:17408
    v_max3_f32 v250, v250, v54, v55
    v_mfma_f32_16x16x32_bf16 v[84:87], a[224:227], a[152:155], v[84:87]
    ds_read_b128 a[224:227], v221 offset:30720
    v_cndmask_b32 v60, v244, v60, s[48:49]
    v_mfma_f32_16x16x32_bf16 v[84:87], a[228:231], a[156:159], v[84:87]
    ds_read_b128 a[228:231], v221 offset:18432
    v_cndmask_b32 v60, v60, v61, s[50:51]
    s_waitcnt lgkmcnt(10)
    v_mfma_f32_16x16x32_bf16 v[84:87], a[232:235], a[160:163], v[84:87]
    ds_read_b128 a[232:235], v221 offset:31744
    v_max3_f32 v251, v251, v56, v57
    v_mfma_f32_16x16x32_bf16 v[84:87], a[236:239], a[164:167], v[84:87]
    ds_read_b128 a[236:239], v221 offset:19456
    v_max3_f32 v250, v250, v58, v59
    v_mfma_f32_16x16x32_bf16 v[64:67], a[72:75], a[192:195], 0
    v_max3_f32 v250, v250, v251, v60
    v_mov_b32 v251, v250
    v_mfma_f32_16x16x32_bf16 v[68:71], a[96:99], a[192:195], 0
    v_mov_b32 v163, 0
    v_mov_b32 v171, 0
    v_mfma_f32_16x16x32_bf16 v[72:75], a[120:123], a[192:195], 0
    v_cvt_pk_bf16_f32 v84, v84, v85
    v_cvt_pk_bf16_f32 v85, v86, v87
    v_mfma_f32_16x16x32_bf16 v[0:3], a[144:147], a[192:195], 0
    ds_write2_b32 v94, v84, v85 offset0:80 offset1:84
    v_mfma_f32_16x16x32_bf16 v[4:7], a[144:147], a[196:199], 0
    ds_read_b128 a[192:195], v221 offset:51200
    ds_read_b128 a[196:199], v221 offset:38912
    s_waitcnt lgkmcnt(10)
    v_mfma_f32_16x16x32_bf16 v[64:67], a[76:79], a[200:203], v[64:67]
    v_permlane32_swap_b32 v250, v251
    v_mfma_f32_16x16x32_bf16 v[68:71], a[100:103], a[200:203], v[68:71]
    v_max_f32 v250, v250, v251
    v_mov_b32 v251, v250
    v_mfma_f32_16x16x32_bf16 v[72:75], a[124:127], a[200:203], v[72:75]
    v_mov_b32 v179, 0
    v_mov_b32 v187, 0
    v_mfma_f32_16x16x32_bf16 v[0:3], a[148:151], a[200:203], v[0:3]
    ds_read_b128 a[200:203], v221 offset:52224
    v_mov_b32 v195, 0
    v_mfma_f32_16x16x32_bf16 v[4:7], a[148:151], a[204:207], v[4:7]
    ds_read_b128 a[204:207], v221 offset:39936
    v_mov_b32 v92, 0
    v_mfma_f32_16x16x32_bf16 v[64:67], a[80:83], a[208:211], v[64:67]
    s_waitcnt lgkmcnt(4)
    v_mfma_f32_16x16x32_bf16 v[68:71], a[104:107], a[208:211], v[68:71]
    s_barrier
    s_mov_b64 exec, s[56:57]
    ds_read_b128 a[168:171], v95 offset:24576
    s_mov_b64 exec, -1
    s_mov_b64 exec, s[58:59]
    ds_read_b128 a[180:183], v95 offset:24976
    s_mov_b64 exec, -1
    v_mfma_f32_16x16x32_bf16 v[72:75], a[128:131], a[208:211], v[72:75]
    s_mov_b64 exec, s[56:57]
    ds_read_b128 a[172:175], v95 offset:24704
    s_mov_b64 exec, -1
    s_mov_b64 exec, s[58:59]
    ds_read_b128 a[184:187], v95 offset:25104
    s_mov_b64 exec, -1
    v_mfma_f32_16x16x32_bf16 v[0:3], a[152:155], a[208:211], v[0:3]
    s_mov_b64 exec, s[56:57]
    ds_read_b128 a[176:179], v95 offset:24832
    s_mov_b64 exec, -1
    s_mov_b64 exec, s[58:59]
    ds_read_b128 a[188:191], v95 offset:25232
    s_mov_b64 exec, -1
    v_mfma_f32_16x16x32_bf16 v[4:7], a[152:155], a[212:215], v[4:7]
    ds_read_b128 a[208:211], v221 offset:53248
    ds_read_b128 a[212:215], v221 offset:40960
    v_mfma_f32_16x16x32_bf16 v[64:67], a[84:87], a[216:219], v[64:67]
    v_permlane16_swap_b32 v250, v251
    v_mfma_f32_16x16x32_bf16 v[68:71], a[108:111], a[216:219], v[68:71]
    v_max_f32 v250, v250, v251
    v_sub_f32 v48, v48, v250
    v_mfma_f32_16x16x32_bf16 v[72:75], a[132:135], a[216:219], v[72:75]
    v_sub_f32 v49, v49, v250
    v_sub_f32 v50, v50, v250
    v_mfma_f32_16x16x32_bf16 v[0:3], a[156:159], a[216:219], v[0:3]
    ds_read_b128 a[216:219], v221 offset:54272
    v_sub_f32 v51, v51, v250
    v_mfma_f32_16x16x32_bf16 v[4:7], a[156:159], a[220:223], v[4:7]
    ds_read_b128 a[220:223], v221 offset:41984
    v_sub_f32 v52, v52, v250
    v_mfma_f32_16x16x32_bf16 v[64:67], a[88:91], a[224:227], v[64:67]
    v_exp_f32 v48, v48
    v_mfma_f32_16x16x32_bf16 v[68:71], a[112:115], a[224:227], v[68:71]
    v_exp_f32 v49, v49
    v_mfma_f32_16x16x32_bf16 v[72:75], a[136:139], a[224:227], v[72:75]
    v_exp_f32 v50, v50
    v_mfma_f32_16x16x32_bf16 v[0:3], a[160:163], a[224:227], v[0:3]
    ds_read_b128 a[224:227], v221 offset:55296
    v_sub_f32 v53, v53, v250
    v_mfma_f32_16x16x32_bf16 v[4:7], a[160:163], a[228:231], v[4:7]
    ds_read_b128 a[228:231], v221 offset:43008
    v_sub_f32 v54, v54, v250
    v_mfma_f32_16x16x32_bf16 v[64:67], a[92:95], a[232:235], v[64:67]
    v_exp_f32 v51, v51
    v_mfma_f32_16x16x32_bf16 v[68:71], a[116:119], a[232:235], v[68:71]
    v_exp_f32 v52, v52
    v_mfma_f32_16x16x32_bf16 v[72:75], a[140:143], a[232:235], v[72:75]
    v_exp_f32 v53, v53
    v_mfma_f32_16x16x32_bf16 v[0:3], a[164:167], a[232:235], v[0:3]
    ds_read_b128 a[232:235], v221 offset:56320
    v_sub_f32 v55, v55, v250
    v_mfma_f32_16x16x32_bf16 v[4:7], a[164:167], a[236:239], v[4:7]
    ds_read_b128 a[236:239], v221 offset:44032
    v_cvt_pk_bf16_f32 v148, v64, v65
    s_waitcnt lgkmcnt(6)
    v_mfma_f32_16x16x32_bf16 v[76:79], a[72:75], a[192:195], 0
    v_cvt_pk_bf16_f32 v149, v66, v67
    v_cvt_pk_bf16_f32 v150, v68, v69
    v_mfma_f32_16x16x32_bf16 v[80:83], a[96:99], a[192:195], 0
    v_cvt_pk_bf16_f32 v151, v70, v71
    v_cvt_pk_bf16_f32 v152, v72, v73
    v_mfma_f32_16x16x32_bf16 v[84:87], a[120:123], a[192:195], 0
    ds_write_b128 v222, v[148:151] offset:19456
    v_mfma_f32_16x16x32_bf16 v[8:11], a[144:147], a[192:195], 0
    ds_read_b128 a[192:195], v222 offset:10240
    v_cvt_pk_bf16_f32 v153, v74, v75
    v_mfma_f32_16x16x32_bf16 v[12:15], a[144:147], a[196:199], 0
    ds_write_b64 v229, v[152:153] offset:22016
    v_mfma_f32_16x16x32_bf16 v[76:79], a[76:79], a[200:203], v[76:79]
    ds_read_b128 a[196:199], v221 offset:63488
    v_cvt_pk_bf16_f32 v2, v2, v3
    v_mfma_f32_16x16x32_bf16 v[80:83], a[100:103], a[200:203], v[80:83]
    ds_write_b32 v230, v2 offset:24064
    v_mfma_f32_16x16x32_bf16 v[84:87], a[124:127], a[200:203], v[84:87]
    v_cvt_pk_bf16_f32 v6, v6, v7
    v_cvt_pk_bf16_f32 v154, v0, v1
    v_mfma_f32_16x16x32_bf16 v[8:11], a[148:151], a[200:203], v[8:11]
    ds_write_b32 v230, v6 offset:24320
    v_mfma_f32_16x16x32_bf16 v[12:15], a[148:151], a[204:207], v[12:15]
    ds_read_b128 a[200:203], v222 offset:11264
    ds_read_b128 a[204:207], v221 offset:64512
    v_mfma_f32_16x16x32_bf16 v[76:79], a[80:83], a[208:211], v[76:79]
    v_exp_f32 v54, v54
    v_mfma_f32_16x16x32_bf16 v[80:83], a[104:107], a[208:211], v[80:83]
    v_sub_f32 v56, v56, v250
    v_add_f32 v252, v48, v49
    v_mfma_f32_16x16x32_bf16 v[84:87], a[128:131], a[208:211], v[84:87]
    v_cvt_pk_bf16_f32 v138, v4, v5
    v_sub_f32 v57, v57, v250
    v_mfma_f32_16x16x32_bf16 v[8:11], a[152:155], a[208:211], v[8:11]
    ds_read_b128 a[208:211], v222 offset:12288
    v_sub_f32 v58, v58, v250
    v_mfma_f32_16x16x32_bf16 v[12:15], a[152:155], a[212:215], v[12:15]
    ds_read_b128 a[212:215], v222 offset:0
    v_add_f32 v253, v50, v51
    s_waitcnt lgkmcnt(10)
    v_mfma_f32_16x16x32_bf16 v[76:79], a[84:87], a[216:219], v[76:79]
    s_waitcnt lgkmcnt(4)
    v_mfma_f32_16x16x32_bf16 v[80:83], a[108:111], a[216:219], v[80:83]
    s_barrier
    ds_read_b128 v[124:127], v222 offset:16384
    ds_read_b64 v[128:129], v229 offset:20480
    v_mfma_f32_16x16x32_bf16 v[84:87], a[132:135], a[216:219], v[84:87]
    ds_read_b32 v130, v230 offset:23808
    ds_read_b128 v[132:135], v222 offset:17408
    v_mfma_f32_16x16x32_bf16 v[8:11], a[156:159], a[216:219], v[8:11]
    ds_read_b64 v[136:137], v229 offset:20992
    v_add_f32 v252, v252, v52
    v_mfma_f32_16x16x32_bf16 v[12:15], a[156:159], a[220:223], v[12:15]
    ds_read_b128 v[140:143], v222 offset:18432
    v_sub_f32 v59, v59, v250
    v_mfma_f32_16x16x32_bf16 v[76:79], a[88:91], a[224:227], v[76:79]
    ds_read_b64 v[144:145], v229 offset:21504
    v_sub_f32 v60, v60, v250
    v_mfma_f32_16x16x32_bf16 v[80:83], a[112:115], a[224:227], v[80:83]
    ds_read_b32 v146, v230 offset:23552
    v_add_f32 v253, v253, v53
    v_mfma_f32_16x16x32_bf16 v[84:87], a[136:139], a[224:227], v[84:87]
    ds_read_b128 a[216:219], v222 offset:13312
    v_add_f32 v252, v252, v54
    v_mfma_f32_16x16x32_bf16 v[8:11], a[160:163], a[224:227], v[8:11]
    ds_read_b128 a[220:223], v222 offset:1024
    ds_read_b128 a[224:227], v222 offset:14336
    v_mfma_f32_16x16x32_bf16 v[12:15], a[160:163], a[228:231], v[12:15]
    ds_read_b128 a[228:231], v222 offset:2048
    v_mov_b32 v93, 0
    v_mfma_f32_16x16x32_bf16 v[76:79], a[92:95], a[232:235], v[76:79]
    v_exp_f32 v55, v55
    v_mfma_f32_16x16x32_bf16 v[80:83], a[116:119], a[232:235], v[80:83]
    v_exp_f32 v56, v56
    v_mfma_f32_16x16x32_bf16 v[84:87], a[140:143], a[232:235], v[84:87]
    v_exp_f32 v57, v57
    v_mfma_f32_16x16x32_bf16 v[8:11], a[164:167], a[232:235], v[8:11]
    ds_read_b128 a[232:235], v222 offset:15360
    v_add_f32 v253, v253, v55
    v_mfma_f32_16x16x32_bf16 v[12:15], a[164:167], a[236:239], v[12:15]
    ds_read_b128 a[236:239], v222 offset:3072
    v_add_f32 v252, v252, v56
    v_mfma_f32_16x16x32_bf16 v[64:67], a[72:75], a[192:195], 0
    v_exp_f32 v58, v58
    v_mfma_f32_16x16x32_bf16 v[68:71], a[96:99], a[192:195], 0
    v_exp_f32 v59, v59
    v_mfma_f32_16x16x32_bf16 v[72:75], a[120:123], a[192:195], 0
    v_exp_f32 v60, v60
    v_mfma_f32_16x16x32_bf16 v[0:3], a[144:147], a[192:195], 0
    ds_read_b128 a[192:195], v220 offset:0
    v_add_f32 v253, v253, v57
    v_mfma_f32_16x16x32_bf16 v[4:7], a[144:147], a[196:199], 0
    ds_read_b128 a[196:199], v220 offset:1024
    v_add_f32 v252, v252, v58
    s_waitcnt lgkmcnt(9)
    v_mfma_f32_16x16x32_bf16 v[64:67], a[76:79], a[200:203], v[64:67]
    v_add_f32 v253, v253, v59
    v_add_f32 v252, v252, v60
    v_mfma_f32_16x16x32_bf16 v[68:71], a[100:103], a[200:203], v[68:71]
    v_add_f32 v252, v252, v253
    v_mov_b32 v253, v252
    v_mfma_f32_16x16x32_bf16 v[72:75], a[124:127], a[200:203], v[72:75]
    v_cvt_pk_bf16_f32 v180, v76, v77
    v_cvt_pk_bf16_f32 v181, v78, v79
    v_mfma_f32_16x16x32_bf16 v[0:3], a[148:151], a[200:203], v[0:3]
    ds_read_b128 a[200:203], v220 offset:2048
    v_cvt_pk_bf16_f32 v182, v80, v81
    v_mfma_f32_16x16x32_bf16 v[4:7], a[148:151], a[204:207], v[4:7]
    ds_read_b128 a[204:207], v220 offset:3072
    v_permlane32_swap_b32 v252, v253
    v_add_f32 v252, v252, v253
    v_mov_b32 v253, v252
    v_cvt_pk_bf16_f32 v183, v82, v83
    v_cvt_pk_bf16_f32 v184, v84, v85
    v_permlane16_swap_b32 v252, v253
    v_add_f32 v252, v252, v253
    v_rcp_f32 v254, v252
    v_cvt_pk_bf16_f32 v185, v86, v87
    v_cndmask_b32 v254, 0, v254, s[70:71]
    v_mul_f32 v48, v48, v254
    v_mul_f32 v49, v49, v254
    v_cvt_pk_bf16_f32 v48, v48, v49
    v_mul_f32 v50, v50, v254
    v_mul_f32 v51, v51, v254
    v_cvt_pk_bf16_f32 v49, v50, v51
    v_mul_f32 v52, v52, v254
    v_mul_f32 v53, v53, v254
    v_mul_f32 v54, v54, v254
    v_mul_f32 v55, v55, v254
    v_cvt_pk_bf16_f32 v50, v52, v53
    v_cvt_pk_bf16_f32 v51, v54, v55
    v_mul_f32 v60, v60, v254
    v_mul_f32 v56, v56, v254
    v_mfma_f32_16x16x32_bf16 v[32:35], v[48:51], v[124:127], 0
    ds_write_b128 v222, v[180:183] offset:27648
    v_mul_f32 v57, v57, v254
    v_mul_f32 v58, v58, v254
    v_mul_f32 v59, v59, v254
L_pad5:
    s_cbranch_execz L_pad11
    v_cvt_pk_bf16_f32 v54, v60, 0
    v_cvt_pk_bf16_f32 v52, v56, v57
    v_cvt_pk_bf16_f32 v53, v58, v59
    v_lshlrev_b32 v54, s54, v54
    v_mov_b32 v55, 0
    s_nop 0
    s_nop 0
    v_mfma_f32_16x16x32_bf16 v[32:35], v[52:55], v[128:131], v[32:35]
    ds_write_b64 v229, v[184:185] offset:30208
    v_mfma_f32_16x16x32_bf16 v[36:39], v[48:51], v[132:135], 0
    v_cvt_pk_bf16_f32 v10, v10, v11
    v_cvt_pk_bf16_f32 v14, v14, v15
    v_mfma_f32_16x16x32_bf16 v[36:39], v[52:55], v[136:139], v[36:39]
    ds_write_b32 v230, v10 offset:32256
    v_mfma_f32_16x16x32_bf16 v[64:67], a[80:83], a[208:211], v[64:67]
    ds_write_b32 v230, v14 offset:32512
    v_mfma_f32_16x16x32_bf16 v[68:71], a[104:107], a[208:211], v[68:71]
    v_mov_b32 v10, 0
    v_mov_b32 v11, 0
    v_mfma_f32_16x16x32_bf16 v[72:75], a[128:131], a[208:211], v[72:75]
    v_cvt_pk_bf16_f32 v186, v8, v9
    v_mov_b32 v14, 0
    v_mfma_f32_16x16x32_bf16 v[0:3], a[152:155], a[208:211], v[0:3]
    ds_read_b128 a[208:211], v220 offset:4096
    v_mov_b32 v15, 0
    v_mfma_f32_16x16x32_bf16 v[4:7], a[152:155], a[212:215], v[4:7]
    ds_read_b128 a[212:215], v220 offset:5120
    v_cvt_pk_bf16_f32 v170, v12, v13
    v_mfma_f32_16x16x32_bf16 v[40:43], v[48:51], v[140:143], 0
    v_cvt_pk_bf16_f32 v88, v35, v39
    s_waitcnt lgkmcnt(6)
    v_mfma_f32_16x16x32_bf16 v[40:43], v[52:55], v[144:147], v[40:43]
    v_mfma_f32_16x16x32_bf16 v[44:47], v[48:51], v[148:151], 0
    s_waitcnt lgkmcnt(2)
    v_mfma_f32_16x16x32_bf16 v[44:47], v[52:55], v[152:155], v[44:47]
    s_barrier
    ds_read_b128 v[156:159], v222 offset:24576
    ds_read_b64 v[160:161], v229 offset:28672
    v_mfma_f32_16x16x32_bf16 v[64:67], a[84:87], a[216:219], v[64:67]
    ds_read_b32 v162, v230 offset:32000
    ds_read_b128 v[164:167], v222 offset:25600
    v_mfma_f32_16x16x32_bf16 v[68:71], a[108:111], a[216:219], v[68:71]
    ds_read_b64 v[168:169], v229 offset:29184
    ds_read_b128 v[172:175], v222 offset:26624
    v_mfma_f32_16x16x32_bf16 v[72:75], a[132:135], a[216:219], v[72:75]
    ds_read_b64 v[176:177], v229 offset:29696
    ds_read_b32 v178, v230 offset:31744
    v_mfma_f32_16x16x32_bf16 v[0:3], a[156:159], a[216:219], v[0:3]
    ds_read_b128 a[216:219], v220 offset:6144
    v_cvt_pk_bf16_f32 v89, v43, v47
    v_mfma_f32_16x16x32_bf16 v[4:7], a[156:159], a[220:223], v[4:7]
    ds_read_b128 a[220:223], v220 offset:7168
    v_mfma_f32_16x16x32_bf16 v[64:67], a[88:91], a[224:227], v[64:67]
    buffer_store_dwordx2 v[88:89], v241, s[8:11], s26 offen offset:2304 sc0 sc1
    v_mfma_f32_16x16x32_bf16 v[68:71], a[112:115], a[224:227], v[68:71]
    v_mfma_f32_16x16x32_bf16 v[72:75], a[136:139], a[224:227], v[72:75]
    v_mfma_f32_16x16x32_bf16 v[0:3], a[160:163], a[224:227], v[0:3]
    ds_read_b128 a[224:227], v220 offset:8192
    v_mfma_f32_16x16x32_bf16 v[4:7], a[160:163], a[228:231], v[4:7]
    ds_read_b128 a[228:231], v220 offset:9216
    v_mfma_f32_16x16x32_bf16 v[64:67], a[92:95], a[232:235], v[64:67]
    v_mfma_f32_16x16x32_bf16 v[68:71], a[116:119], a[232:235], v[68:71]
    v_mfma_f32_16x16x32_bf16 v[72:75], a[140:143], a[232:235], v[72:75]
    v_mfma_f32_16x16x32_bf16 v[0:3], a[164:167], a[232:235], v[0:3]
    ds_read_b128 a[232:235], v220 offset:10240
    v_mfma_f32_16x16x32_bf16 v[4:7], a[164:167], a[236:239], v[4:7]
    ds_read_b128 a[236:239], v220 offset:11264
    v_smfmac_f32_16x16x64_bf16 v[8:11], a[168:171], a[144:151], v228
    v_smfmac_f32_16x16x64_bf16 v[8:11], a[172:175], a[152:159], v228
    v_cvt_pk_bf16_f32 v212, v64, v65
    v_cvt_pk_bf16_f32 v213, v66, v67
    v_smfmac_f32_16x16x64_bf16 v[8:11], a[176:179], a[160:167], v228
    v_cvt_pk_bf16_f32 v214, v68, v69
    v_cvt_pk_bf16_f32 v215, v70, v71
    v_smfmac_f32_16x16x64_bf16 v[12:15], a[180:183], a[144:151], v228
    ds_write_b128 v222, v[212:215] offset:19456
    v_smfmac_f32_16x16x64_bf16 v[12:15], a[184:187], a[152:159], v228
    v_cvt_pk_bf16_f32 v216, v72, v73
    v_cvt_pk_bf16_f32 v217, v74, v75
    v_smfmac_f32_16x16x64_bf16 v[12:15], a[188:191], a[160:167], v228
    ds_write_b64 v229, v[216:217] offset:22016
    s_waitcnt lgkmcnt(6)
    v_mfma_f32_16x16x32_bf16 v[32:35], v[48:51], v[156:159], 0
    v_cvt_pk_bf16_f32 v2, v2, v3
    v_cvt_pk_bf16_f32 v6, v6, v7
    v_mfma_f32_16x16x32_bf16 v[32:35], v[52:55], v[160:163], v[32:35]
    ds_write_b32 v230, v2 offset:24064
    v_mfma_f32_16x16x32_bf16 v[36:39], v[48:51], v[164:167], 0
    ds_write_b32 v230, v6 offset:24320
    v_mfma_f32_16x16x32_bf16 v[36:39], v[52:55], v[168:171], v[36:39]
    v_cvt_pk_bf16_f32 v202, v4, v5
    v_cvt_pk_bf16_f32 v218, v0, v1
    v_mfma_f32_16x16x32_bf16 v[40:43], v[48:51], v[172:175], 0
    v_add_f32 v10, v10, v11
    v_add_f32 v14, v14, v15
    v_mfma_f32_16x16x32_bf16 v[40:43], v[52:55], v[176:179], v[40:43]
    v_cndmask_b32 v231, v10, v14, s[66:67]
    v_mfma_f32_16x16x32_bf16 v[44:47], v[48:51], v[180:183], 0
    v_cvt_pk_bf16_f32 v90, v35, v39
    v_mfma_f32_16x16x32_bf16 v[44:47], v[52:55], v[184:187], v[44:47]
    s_waitcnt lgkmcnt(0)
    s_barrier
    ds_read_b128 v[188:191], v222 offset:16384
    ds_read_b64 v[192:193], v229 offset:20480
    ds_read_b32 v194, v230 offset:23808
    ds_read_b128 v[196:199], v222 offset:17408
    ds_read_b64 v[200:201], v229 offset:20992
    ds_read_b128 v[204:207], v222 offset:18432
    ds_read_b64 v[208:209], v229 offset:21504
    ds_read_b32 v210, v230 offset:23552
    v_cvt_pk_bf16_f32 v91, v43, v47
    buffer_store_dwordx2 v[90:91], v241, s[8:11], s26 offen offset:2432 sc0 sc1
    ds_write_b64 v227, v[92:93] offset:0
    ds_write_b64 v227, v[92:93] offset:8
    s_waitcnt lgkmcnt(9)
    v_mfma_f32_16x16x32_bf16 v[32:35], v[48:51], v[188:191], 0
    s_waitcnt lgkmcnt(7)
    v_mfma_f32_16x16x32_bf16 v[32:35], v[52:55], v[192:195], v[32:35]
    s_waitcnt lgkmcnt(6)
    v_mfma_f32_16x16x32_bf16 v[36:39], v[48:51], v[196:199], 0
    s_waitcnt lgkmcnt(5)
    v_mfma_f32_16x16x32_bf16 v[36:39], v[52:55], v[200:203], v[36:39]
    s_waitcnt lgkmcnt(3)
    v_mfma_f32_16x16x32_bf16 v[40:43], v[48:51], v[204:207], 0
    s_waitcnt lgkmcnt(2)
    v_mfma_f32_16x16x32_bf16 v[40:43], v[52:55], v[208:211], v[40:43]
    v_mfma_f32_16x16x32_bf16 v[44:47], v[48:51], v[212:215], 0
    v_mfma_f32_16x16x32_bf16 v[44:47], v[52:55], v[216:219], v[44:47]
    s_nop 0
    s_nop 0
    s_nop 0
    s_nop 0
    v_cvt_pk_bf16_f32 v250, v35, v39
    s_nop 0
    s_nop 0
    s_nop 0
    v_cvt_pk_bf16_f32 v251, v43, v47
    buffer_store_dwordx2 v[250:251], v241, s[8:11], s26 offen offset:2560 sc0 sc1
    s_mov_b32 s10, 0
    v_cndmask_b32 v241, v244, v233, s[40:41]
    s_waitcnt vmcnt(3) lgkmcnt(0)
    s_branch L_b0
.p2align 6
L_sh0:
L_pad0:
    s_cbranch_execz L_pad6
    s_waitcnt vmcnt(8) lgkmcnt(0)
    s_barrier
    v_accvgpr_read_b32 v97, a248
    v_accvgpr_read_b32 v94, a242
    v_accvgpr_read_b32 v95, a243
    v_accvgpr_read_b32 v92, a241
    v_mov_b32 v251, 0
    v_add_u32 v93, 0x10000, v92
    v_accvgpr_read_b32 v96, a246
    v_mov_b32 v96, 0xeeee
    v_mov_b32 v203, 0
    v_mov_b32 v211, 0
    v_mov_b32 v219, 0
    v_accvgpr_read_b32 v227, a245
    v_accvgpr_read_b32 v226, a244
    v_cndmask_b32 v240, v244, v232, s[40:41]
    v_cndmask_b32 v241, v244, v233, s[40:41]
    s_mov_b32 s18, s17
    buffer_load_dwordx4 v[156:159], v102, s[12:15], 0 offen offset:2048 sc1
    ds_read_b128 a[192:195], v220 offset:0
    ds_read_b128 a[196:199], v220 offset:12288
    ds_read_b128 a[200:203], v220 offset:1024
    ds_read_b128 a[204:207], v220 offset:13312
    ds_read_b128 a[208:211], v220 offset:2048
    ds_read_b128 a[212:215], v220 offset:14336
    ds_read_b128 a[216:219], v220 offset:3072
    buffer_load_dwordx4 v[160:163], v103, s[12:15], 0 offen offset:0 sc1
    s_waitcnt vmcnt(9)
    ds_write_b128 v100, v[124:127] offset:0
    ds_read_b128 a[220:223], v220 offset:15360
    ds_read_b128 a[224:227], v220 offset:4096
    buffer_load_dwordx4 v[164:167], v103, s[12:15], 0 offen offset:1024 sc1
    s_waitcnt vmcnt(9)
    ds_write_b128 v100, v[128:131] offset:1024
    ds_read_b128 a[228:231], v220 offset:16384
    buffer_load_dwordx4 v[168:171], v103, s[12:15], 0 offen offset:2048 sc1
    s_waitcnt lgkmcnt(11)
    v_mfma_f32_16x16x32_bf16 v[64:67], a[192:195], a[72:75], 0
    ds_read_b128 a[232:235], v220 offset:5120
    ds_read_b128 a[236:239], v220 offset:17408
    v_mfma_f32_16x16x32_bf16 v[68:71], a[192:195], a[96:99], 0
    v_mfma_f32_16x16x32_bf16 v[72:75], a[192:195], a[120:123], 0
    v_mfma_f32_16x16x32_bf16 v[16:19], a[192:195], a[144:147], 0
    ds_read_b128 a[192:195], v220 offset:24576
    s_waitcnt lgkmcnt(8)
    v_mfma_f32_16x16x32_bf16 v[20:23], a[196:199], a[144:147], 0
    ds_read_b128 a[196:199], v220 offset:36864
    v_mfma_f32_16x16x32_bf16 v[64:67], a[200:203], a[76:79], v[64:67]
    v_mfma_f32_16x16x32_bf16 v[68:71], a[200:203], a[100:103], v[68:71]
    v_max3_u32 v251, v251, v124, v125
    v_max3_u32 v251, v251, v126, v127
    v_mfma_f32_16x16x32_bf16 v[72:75], a[200:203], a[124:127], v[72:75]
    v_mfma_f32_16x16x32_bf16 v[16:19], a[200:203], a[148:151], v[16:19]
    ds_read_b128 a[200:203], v220 offset:25600
    v_mfma_f32_16x16x32_bf16 v[20:23], a[204:207], a[148:151], v[20:23]
    ds_read_b128 a[204:207], v220 offset:37888
    v_mfma_f32_16x16x32_bf16 v[64:67], a[208:211], a[80:83], v[64:67]
    v_max3_u32 v251, v251, v128, v129
    v_max3_u32 v251, v251, v130, v131
    v_mfma_f32_16x16x32_bf16 v[68:71], a[208:211], a[104:107], v[68:71]
    v_mov_b32 v131, 0
    v_mfma_f32_16x16x32_bf16 v[72:75], a[208:211], a[128:131], v[72:75]
    v_mfma_f32_16x16x32_bf16 v[16:19], a[208:211], a[152:155], v[16:19]
    ds_read_b128 a[208:211], v220 offset:26624
    v_mfma_f32_16x16x32_bf16 v[20:23], a[212:215], a[152:155], v[20:23]
    s_waitcnt vmcnt(9)
    ds_write_b128 v100, v[132:135] offset:2048
    v_mfma_f32_16x16x32_bf16 v[64:67], a[216:219], a[84:87], v[64:67]
    v_max3_u32 v251, v251, v132, v133
    v_max3_u32 v251, v251, v134, v135
    v_mfma_f32_16x16x32_bf16 v[68:71], a[216:219], a[108:111], v[68:71]
    ds_read_b128 a[212:215], v220 offset:38912
    v_mfma_f32_16x16x32_bf16 v[72:75], a[216:219], a[132:135], v[72:75]
    v_mfma_f32_16x16x32_bf16 v[16:19], a[216:219], a[156:159], v[16:19]
    s_waitcnt vmcnt(8)
    ds_write_b128 v101, v[136:139] offset:0
    s_waitcnt lgkmcnt(6)
    v_mfma_f32_16x16x32_bf16 v[20:23], a[220:223], a[156:159], v[20:23]
    v_max3_u32 v251, v251, v136, v137
    v_max3_u32 v251, v251, v138, v139
    v_mfma_f32_16x16x32_bf16 v[64:67], a[224:227], a[88:91], v[64:67]
    buffer_load_dwordx4 v[172:175], v104, s[12:15], 0 offen offset:0 sc1
    v_mfma_f32_16x16x32_bf16 v[68:71], a[224:227], a[112:115], v[68:71]
    ds_read_b128 a[216:219], v220 offset:27648
    ds_read_b128 a[220:223], v220 offset:39936
    v_mfma_f32_16x16x32_bf16 v[72:75], a[224:227], a[136:139], v[72:75]
    s_waitcnt vmcnt(8)
    ds_write_b128 v101, v[140:143] offset:1024
    v_mfma_f32_16x16x32_bf16 v[16:19], a[224:227], a[160:163], v[16:19]
    v_max3_u32 v251, v251, v140, v141
    v_max3_u32 v251, v251, v142, v143
    v_mfma_f32_16x16x32_bf16 v[20:23], a[228:231], a[160:163], v[20:23]
    buffer_load_dwordx4 v[176:179], v104, s[12:15], 0 offen offset:1024 sc1
    v_mfma_f32_16x16x32_bf16 v[64:67], a[232:235], a[92:95], v[64:67]
    ds_read_b128 a[224:227], v220 offset:28672
    ds_read_b128 a[228:231], v220 offset:40960
    v_mfma_f32_16x16x32_bf16 v[68:71], a[232:235], a[116:119], v[68:71]
    s_waitcnt vmcnt(8)
    ds_write_b128 v101, v[144:147] offset:2048
    v_mfma_f32_16x16x32_bf16 v[72:75], a[232:235], a[140:143], v[72:75]
    v_max3_u32 v251, v251, v144, v145
    v_max3_u32 v251, v251, v146, v147
    v_mfma_f32_16x16x32_bf16 v[16:19], a[232:235], a[164:167], v[16:19]
    buffer_load_dwordx4 v[180:183], v104, s[12:15], 0 offen offset:2048 sc1
    v_mfma_f32_16x16x32_bf16 v[20:23], a[236:239], a[164:167], v[20:23]
    ds_read_b128 a[232:235], v220 offset:29696
    v_cvt_pk_bf16_f32 v68, v68, v69
    v_mfma_f32_16x16x32_bf16 v[76:79], a[192:195], a[72:75], 0
    s_waitcnt vmcnt(8)
    ds_write_b128 v102, v[148:151] offset:0
    v_mfma_f32_16x16x32_bf16 v[80:83], a[192:195], a[96:99], 0
    v_cvt_pk_bf16_f32 v72, v72, v73
    v_cvt_pk_bf16_f32 v16, v16, v17
    v_mfma_f32_16x16x32_bf16 v[84:87], a[192:195], a[120:123], 0
    buffer_load_dwordx4 v[184:187], v105, s[12:15], 0 offen offset:0 sc1
    v_mfma_f32_16x16x32_bf16 v[24:27], a[192:195], a[144:147], 0
    ds_read_b128 a[236:239], v220 offset:41984
    v_cvt_pk_bf16_f32 v20, v20, v21
    v_mfma_f32_16x16x32_bf16 v[28:31], a[196:199], a[144:147], 0
    s_waitcnt vmcnt(8)
    ds_write_b128 v102, v[152:155] offset:1024
    s_waitcnt lgkmcnt(7)
    v_mfma_f32_16x16x32_bf16 v[76:79], a[200:203], a[76:79], v[76:79]
    v_cvt_pk_bf16_f32 v69, v70, v71
    v_cvt_pk_bf16_f32 v73, v74, v75
    v_mfma_f32_16x16x32_bf16 v[80:83], a[200:203], a[100:103], v[80:83]
    ds_write_b64 v229, v[68:69] offset:18944
    v_mfma_f32_16x16x32_bf16 v[84:87], a[200:203], a[124:127], v[84:87]
    ds_write_b64 v222, v[72:73] offset:19456
    v_mfma_f32_16x16x32_bf16 v[24:27], a[200:203], a[148:151], v[24:27]
    buffer_load_dwordx4 v[188:191], v105, s[12:15], 0 offen offset:1024 sc1
    v_mfma_f32_16x16x32_bf16 v[28:31], a[204:207], a[148:151], v[28:31]
    s_waitcnt vmcnt(8)
    ds_write_b128 v102, v[156:159] offset:2048
    v_mfma_f32_16x16x32_bf16 v[76:79], a[208:211], a[80:83], v[76:79]
    buffer_load_dwordx4 v[192:195], v105, s[12:15], 0 offen offset:2048 sc1
    v_mfma_f32_16x16x32_bf16 v[80:83], a[208:211], a[104:107], v[80:83]
    buffer_load_dwordx4 a[0:3], v223, s[4:7], s17 offen offset:0
    v_mfma_f32_16x16x32_bf16 v[84:87], a[208:211], a[128:131], v[84:87]
    buffer_load_dwordx4 a[4:7], v223, s[4:7], s17 offen offset:64
    v_mfma_f32_16x16x32_bf16 v[24:27], a[208:211], a[152:155], v[24:27]
    s_waitcnt vmcnt(10)
    ds_write_b128 v103, v[160:163] offset:0
    v_mfma_f32_16x16x32_bf16 v[28:31], a[212:215], a[152:155], v[28:31]
    v_cvt_pk_bf16_f32 v17, v18, v19
    v_cvt_pk_bf16_f32 v21, v22, v23
    v_mfma_f32_16x16x32_bf16 v[76:79], a[216:219], a[84:87], v[76:79]
    ds_write2_b32 v228, v16, v17 offset0:0 offset1:4
    v_mfma_f32_16x16x32_bf16 v[80:83], a[216:219], a[108:111], v[80:83]
    ds_write2_b32 v228, v20, v21 offset0:16 offset1:20
    v_mfma_f32_16x16x32_bf16 v[84:87], a[216:219], a[132:135], v[84:87]
    s_waitcnt vmcnt(9)
    ds_write_b128 v103, v[164:167] offset:1024
    v_mfma_f32_16x16x32_bf16 v[24:27], a[216:219], a[156:159], v[24:27]
    v_xor_b32 v228, 0x2000, v228
    v_cvt_pk_bf16_f32 v32, v64, v65
    v_mfma_f32_16x16x32_bf16 v[28:31], a[220:223], a[156:159], v[28:31]
    ds_read_b128 a[192:195], v220 offset:49152
    ds_read_b128 a[196:199], v220 offset:61440
    s_waitcnt lgkmcnt(7)
    v_mfma_f32_16x16x32_bf16 v[76:79], a[224:227], a[88:91], v[76:79]
    s_waitcnt vmcnt(8)
    ds_write_b128 v103, v[168:171] offset:2048
    v_mfma_f32_16x16x32_bf16 v[80:83], a[224:227], a[112:115], v[80:83]
    buffer_load_dwordx4 a[24:27], v224, s[4:7], s17 offen offset:0
    v_mfma_f32_16x16x32_bf16 v[84:87], a[224:227], a[136:139], v[84:87]
    s_waitcnt lgkmcnt(4)
    ds_read_b128 a[200:203], v220 offset:50176
    s_barrier
    v_mfma_f32_16x16x32_bf16 v[24:27], a[224:227], a[160:163], v[24:27]
    ds_read_b64 v[34:35], v229 offset:17408
    ds_read_b128 v[36:39], v222 offset:16384
    v_mfma_f32_16x16x32_bf16 v[28:31], a[228:231], a[160:163], v[28:31]
    s_mov_b64 exec, s[60:61]
    ds_read_b128 a[168:171], v97 offset:20992
    s_mov_b64 exec, -1
    s_mov_b64 exec, s[62:63]
    ds_read_b128 a[180:183], v97 offset:21136
    s_mov_b64 exec, -1
    v_mfma_f32_16x16x32_bf16 v[76:79], a[232:235], a[92:95], v[76:79]
    buffer_load_dwordx4 a[28:31], v224, s[4:7], s17 offen offset:64
    v_mfma_f32_16x16x32_bf16 v[80:83], a[232:235], a[116:119], v[80:83]
    s_waitcnt vmcnt(9)
    ds_write_b128 v104, v[172:175] offset:0
    v_mfma_f32_16x16x32_bf16 v[84:87], a[232:235], a[140:143], v[84:87]
    v_cvt_pk_bf16_f32 v33, v66, v67
    v_max3_u32 v251, v251, v148, v149
    v_mfma_f32_16x16x32_bf16 v[24:27], a[232:235], a[164:167], v[24:27]
    ds_read_b128 a[204:207], v220 offset:62464
    ds_read_b128 a[208:211], v220 offset:51200
    v_mfma_f32_16x16x32_bf16 v[28:31], a[236:239], a[164:167], v[28:31]
    s_waitcnt vmcnt(8)
    ds_write_b128 v104, v[176:179] offset:1024
    s_waitcnt lgkmcnt(11)
    v_mfma_f32_16x16x32_bf16 v[64:67], a[192:195], a[72:75], 0
    v_cvt_pk_bf16_f32 v80, v80, v81
    v_cvt_pk_bf16_f32 v84, v84, v85
    v_mfma_f32_16x16x32_bf16 v[68:71], a[192:195], a[96:99], 0
    ds_read_b128 a[212:215], v220 offset:63488
    v_cvt_pk_bf16_f32 v24, v24, v25
    v_mfma_f32_16x16x32_bf16 v[72:75], a[192:195], a[120:123], 0
    s_waitcnt vmcnt(7)
    ds_write_b128 v104, v[180:183] offset:2048
    v_mfma_f32_16x16x32_bf16 v[16:19], a[192:195], a[144:147], 0
    buffer_load_dwordx4 a[48:51], v225, s[4:7], s17 offen offset:0
    s_waitcnt lgkmcnt(11)
    v_mfma_f32_16x16x32_bf16 v[20:23], a[196:199], a[144:147], 0
    buffer_load_dwordx4 a[52:55], v225, s[4:7], s17 offen offset:64
    s_waitcnt lgkmcnt(10)
    v_mfma_f32_16x16x32_bf16 v[64:67], a[200:203], a[76:79], v[64:67]
    ds_read_b128 a[216:219], v220 offset:52224
    v_cvt_pk_bf16_f32 v28, v28, v29
    v_mfma_f32_16x16x32_bf16 v[68:71], a[200:203], a[100:103], v[68:71]
    s_waitcnt vmcnt(8)
    ds_write_b128 v105, v[184:187] offset:0
    v_mfma_f32_16x16x32_bf16 v[72:75], a[200:203], a[124:127], v[72:75]
    v_cvt_pk_bf16_f32 v81, v82, v83
    v_cvt_pk_bf16_f32 v85, v86, v87
    v_mfma_f32_16x16x32_bf16 v[16:19], a[200:203], a[148:151], v[16:19]
    ds_write_b64 v229, v[80:81] offset:27136
    s_waitcnt lgkmcnt(7)
    v_mfma_f32_16x16x32_bf16 v[20:23], a[204:207], a[148:151], v[20:23]
    ds_write_b64 v222, v[84:85] offset:27648
    v_mfma_f32_16x16x32_bf16 v[0:3], a[72:75], v[32:35], 0
    s_waitcnt vmcnt(7)
    ds_write_b128 v105, v[188:191] offset:1024
    v_mfma_f32_16x16x32_bf16 v[4:7], a[96:99], v[32:35], 0
    v_cvt_pk_bf16_f32 v25, v26, v27
    v_cvt_pk_bf16_f32 v29, v30, v31
    v_mfma_f32_16x16x32_bf16 v[8:11], a[120:123], v[32:35], 0
    ds_write2_b32 v228, v24, v25 offset0:0 offset1:4
    v_mfma_f32_16x16x32_bf16 v[12:15], a[144:147], v[32:35], 0
    ds_write2_b32 v228, v28, v29 offset0:16 offset1:20
    s_waitcnt lgkmcnt(7)
    v_mfma_f32_16x16x32_bf16 v[64:67], a[208:211], a[80:83], v[64:67]
    s_waitcnt vmcnt(6)
    ds_write_b128 v105, v[192:195] offset:2048
    v_mfma_f32_16x16x32_bf16 v[68:71], a[208:211], a[104:107], v[68:71]
    buffer_load_dwordx4 a[8:11], v223, s[4:7], s17 offen offset:128
    v_mfma_f32_16x16x32_bf16 v[72:75], a[208:211], a[128:131], v[72:75]
    ds_read_b128 a[220:223], v220 offset:64512
    v_xor_b32 v228, 0x2000, v228
    v_mfma_f32_16x16x32_bf16 v[16:19], a[208:211], a[152:155], v[16:19]
    ds_read_b128 a[224:227], v220 offset:53248
    ds_read_b128 a[228:231], v221 offset:0
    v_mfma_f32_16x16x32_bf16 v[20:23], a[212:215], a[152:155], v[20:23]
    buffer_load_dwordx4 a[12:15], v223, s[4:7], s17 offen offset:192
    v_mfma_f32_16x16x32_bf16 v[0:3], a[76:79], v[36:39], v[0:3]
    ds_read_b128 a[232:235], v220 offset:54272
    ds_read_b128 a[236:239], v221 offset:1024
    v_mfma_f32_16x16x32_bf16 v[4:7], a[100:103], v[36:39], v[4:7]
    s_waitcnt lgkmcnt(6)
    ds_read_b64_tr_b16 a[192:193], v92 offset:0
    s_barrier
    v_mfma_f32_16x16x32_bf16 v[8:11], a[124:127], v[36:39], v[8:11]
    ds_read_b64 v[42:43], v229 offset:25600
    ds_read_b128 v[44:47], v222 offset:24576
    v_mfma_f32_16x16x32_bf16 v[12:15], a[148:151], v[36:39], v[12:15]
    s_mov_b64 exec, s[60:61]
    ds_read_b128 a[172:175], v97 offset:29184
    s_mov_b64 exec, -1
    s_mov_b64 exec, s[62:63]
    ds_read_b128 a[184:187], v97 offset:29328
    s_mov_b64 exec, -1
    v_mfma_f32_16x16x32_bf16 v[64:67], a[216:219], a[84:87], v[64:67]
    ds_read_b64_tr_b16 a[194:195], v92 offset:6144
    ds_read_b64_tr_b16 a[196:197], v92 offset:12288
    v_mfma_f32_16x16x32_bf16 v[68:71], a[216:219], a[108:111], v[68:71]
    ds_read_b64_tr_b16 a[198:199], v92 offset:18432
    ds_read_b64_tr_b16 a[200:201], v92 offset:24576
    v_mfma_f32_16x16x32_bf16 v[72:75], a[216:219], a[132:135], v[72:75]
    ds_read_b64_tr_b16 a[202:203], v92 offset:30720
    ds_read_b64_tr_b16 a[204:205], v92 offset:36864
    v_mfma_f32_16x16x32_bf16 v[16:19], a[216:219], a[156:159], v[16:19]
    ds_read_b64_tr_b16 a[206:207], v92 offset:43008
    ds_read_b64_tr_b16 a[208:209], v92 offset:49152
    ds_read_b64_tr_b16 a[210:211], v92 offset:55296
    buffer_load_dwordx4 a[32:35], v224, s[4:7], s17 offen offset:128
    s_waitcnt lgkmcnt(15)
    v_mfma_f32_16x16x32_bf16 v[20:23], a[220:223], a[156:159], v[20:23]
    ds_read_b64_tr_b16 a[212:213], v92 offset:61440
    ds_read_b64_tr_b16 a[214:215], v93 offset:2048
    v_mfma_f32_16x16x32_bf16 v[64:67], a[224:227], a[88:91], v[64:67]
    ds_read_b64_tr_b16 a[216:217], v92 offset:1024
    ds_read_b64_tr_b16 a[218:219], v92 offset:7168
    v_mfma_f32_16x16x32_bf16 v[68:71], a[224:227], a[112:115], v[68:71]
    buffer_load_dwordx4 a[36:39], v224, s[4:7], s17 offen offset:192
    v_mfma_f32_16x16x32_bf16 v[72:75], a[224:227], a[136:139], v[72:75]
    ds_read_b64_tr_b16 a[220:221], v92 offset:13312
    ds_read_b64_tr_b16 a[222:223], v92 offset:19456
    v_mfma_f32_16x16x32_bf16 v[16:19], a[224:227], a[160:163], v[16:19]
    ds_read_b64_tr_b16 a[224:225], v92 offset:25600
    v_max3_u32 v251, v251, v150, v151
    v_mfma_f32_16x16x32_bf16 v[20:23], a[228:231], a[160:163], v[20:23]
    ds_read_b64_tr_b16 a[226:227], v92 offset:31744
    v_max3_u32 v251, v251, v152, v153
    v_mfma_f32_16x16x32_bf16 v[64:67], a[232:235], a[92:95], v[64:67]
    ds_read_b64_tr_b16 a[228:229], v92 offset:37888
    v_max3_u32 v251, v251, v154, v155
    v_mfma_f32_16x16x32_bf16 v[68:71], a[232:235], a[116:119], v[68:71]
    ds_read_b64_tr_b16 a[230:231], v92 offset:44032
    v_max3_u32 v251, v251, v156, v157
    v_mfma_f32_16x16x32_bf16 v[72:75], a[232:235], a[140:143], v[72:75]
    v_max3_u32 v251, v251, v158, v159
    v_max3_u32 v251, v251, v160, v161
    v_mfma_f32_16x16x32_bf16 v[16:19], a[232:235], a[164:167], v[16:19]
    ds_read_b64_tr_b16 a[232:233], v92 offset:50176
    v_max3_u32 v251, v251, v162, v163
    s_waitcnt lgkmcnt(15)
    v_mfma_f32_16x16x32_bf16 v[20:23], a[236:239], a[164:167], v[20:23]
    ds_read_b64_tr_b16 a[234:235], v92 offset:56320
    v_cvt_pk_bf16_f32 v68, v68, v69
    v_cvt_pk_bf16_f32 v69, v70, v71
    v_max3_u32 v251, v251, v164, v165
    v_cvt_pk_bf16_f32 v72, v72, v73
    v_cvt_pk_bf16_f32 v73, v74, v75
    v_max3_u32 v251, v251, v166, v167
    v_max3_u32 v251, v251, v168, v169
    v_cvt_pk_bf16_f32 v16, v16, v17
    v_cvt_pk_bf16_f32 v17, v18, v19
    v_max3_u32 v251, v251, v170, v171
    v_max3_u32 v251, v251, v172, v173
    v_cvt_pk_bf16_f32 v20, v20, v21
    v_cvt_pk_bf16_f32 v21, v22, v23
    v_max3_u32 v251, v251, v174, v175
    v_max3_u32 v251, v251, v176, v177
    v_max3_u32 v251, v251, v178, v179
    v_max3_u32 v251, v251, v180, v181
    v_cvt_pk_bf16_f32 v32, v64, v65
    v_cvt_pk_bf16_f32 v33, v66, v67
    v_mfma_f32_16x16x32_bf16 v[64:67], a[192:195], a[144:147], 0
    ds_write_b64 v229, v[68:69] offset:18944
    v_mfma_f32_16x16x32_bf16 v[64:67], a[196:199], a[148:151], v[64:67]
    ds_write_b64 v222, v[72:73] offset:19456
    v_mfma_f32_16x16x32_bf16 v[64:67], a[200:203], a[152:155], v[64:67]
    ds_write2_b32 v228, v16, v17 offset0:0 offset1:4
    s_waitcnt lgkmcnt(8)
    v_mfma_f32_16x16x32_bf16 v[64:67], a[204:207], a[156:159], v[64:67]
    ds_write2_b32 v228, v20, v21 offset0:16 offset1:20
    v_mfma_f32_16x16x32_bf16 v[64:67], a[208:211], a[160:163], v[64:67]
    ds_read_b64_tr_b16 a[236:237], v92 offset:62464
    ds_read_b64_tr_b16 a[238:239], v93 offset:3072
    v_mfma_f32_16x16x32_bf16 v[64:67], a[212:215], a[164:167], v[64:67]
    ds_read_b64_tr_b16 a[192:193], v92 offset:2048
    v_max3_u32 v251, v251, v182, v183
    v_mfma_f32_16x16x32_bf16 v[68:71], a[216:219], a[144:147], 0
    ds_read_b64_tr_b16 a[194:195], v92 offset:8192
    v_max3_u32 v251, v251, v184, v185
    v_mfma_f32_16x16x32_bf16 v[68:71], a[220:223], a[148:151], v[68:71]
    ds_read_b64_tr_b16 a[196:197], v92 offset:14336
    v_max3_u32 v251, v251, v186, v187
    s_waitcnt lgkmcnt(10)
    v_mfma_f32_16x16x32_bf16 v[68:71], a[224:227], a[152:155], v[68:71]
    buffer_load_dwordx4 a[56:59], v225, s[4:7], s17 offen offset:128
    v_mfma_f32_16x16x32_bf16 v[68:71], a[228:231], a[156:159], v[68:71]
    ds_read_b64_tr_b16 a[198:199], v92 offset:20480
    v_cvt_pk_bf16_f32 v64, v64, v65
    s_waitcnt lgkmcnt(10)
    v_mfma_f32_16x16x32_bf16 v[68:71], a[232:235], a[160:163], v[68:71]
    ds_read_b64_tr_b16 a[200:201], v92 offset:26624
    v_cvt_pk_bf16_f32 v65, v66, v67
    v_max3_u32 v251, v251, v188, v189
    v_max3_u32 v251, v251, v190, v191
    v_max3_u32 v251, v251, v192, v193
    v_max3_u32 v251, v251, v194, v195
    v_cmp_eq_u32 vcc, -1, v251
    s_nop 1
    s_cbranch_vccnz L_again
L_back0:
    s_waitcnt lgkmcnt(7)
    s_barrier
    s_mov_b64 exec, s[60:61]
    ds_read_b128 a[176:179], v97 offset:20992
    s_mov_b64 exec, -1
    s_mov_b64 exec, s[62:63]
    ds_read_b128 a[188:191], v97 offset:21136
    s_mov_b64 exec, -1
    ds_write2_b32 v94, v64, v65 offset0:0 offset1:4
    ds_read_b64 v[34:35], v229 offset:17408
    ds_read_b128 v[36:39], v222 offset:16384
    buffer_load_dwordx4 a[60:63], v225, s[4:7], s17 offen offset:192
    ds_read_b64_tr_b16 a[202:203], v92 offset:32768
    ds_read_b64_tr_b16 a[204:205], v92 offset:38912
    ds_read_b64_tr_b16 a[206:207], v92 offset:45056
    s_waitcnt lgkmcnt(13)
    v_mfma_f32_16x16x32_bf16 v[68:71], a[236:239], a[164:167], v[68:71]
    ds_read_b64_tr_b16 a[208:209], v92 offset:51200
    ds_read_b64_tr_b16 a[210:211], v92 offset:57344
    ds_read_b64_tr_b16 a[212:213], v92 offset:63488
    ds_read_b64_tr_b16 a[214:215], v93 offset:4096
    v_cvt_pk_bf16_f32 v40, v76, v77
    v_cvt_pk_bf16_f32 v41, v78, v79
    s_nop 0
    s_nop 0
    v_mfma_f32_16x16x32_bf16 v[0:3], a[80:83], v[40:43], v[0:3]
    ds_read_b64_tr_b16 a[216:217], v92 offset:3072
    ds_read_b64_tr_b16 a[218:219], v92 offset:9216
    v_mfma_f32_16x16x32_bf16 v[4:7], a[104:107], v[40:43], v[4:7]
    ds_read_b64_tr_b16 a[220:221], v92 offset:15360
    v_cvt_pk_bf16_f32 v68, v68, v69
    v_mfma_f32_16x16x32_bf16 v[8:11], a[128:131], v[40:43], v[8:11]
    ds_read_b64_tr_b16 a[222:223], v92 offset:21504
    v_cvt_pk_bf16_f32 v69, v70, v71
    v_mfma_f32_16x16x32_bf16 v[12:15], a[152:155], v[40:43], v[12:15]
    ds_write2_b32 v94, v68, v69 offset0:16 offset1:20
    s_waitcnt lgkmcnt(15)
    v_mfma_f32_16x16x32_bf16 v[72:75], a[192:195], a[144:147], 0
    ds_read_b64_tr_b16 a[224:225], v92 offset:27648
    ds_read_b64_tr_b16 a[226:227], v92 offset:33792
    v_mfma_f32_16x16x32_bf16 v[72:75], a[196:199], a[148:151], v[72:75]
    ds_read_b64_tr_b16 a[228:229], v92 offset:39936
    ds_read_b64_tr_b16 a[230:231], v92 offset:46080
    buffer_load_dwordx4 a[16:19], v223, s[4:7], s17 offen offset:256
    ds_read_b64_tr_b16 a[232:233], v92 offset:52224
    ds_read_b64_tr_b16 a[234:235], v92 offset:58368
    buffer_load_dwordx4 a[20:23], v223, s[4:7], s17 offen offset:320
    ds_read_b64_tr_b16 a[236:237], v92 offset:64512
    s_waitcnt lgkmcnt(15)
L_pad6:
    s_cbranch_execz L_pad3
    v_mfma_f32_16x16x32_bf16 v[72:75], a[200:203], a[152:155], v[72:75]
    ds_read_b64_tr_b16 a[238:239], v93 offset:5120
    ds_read_b64_tr_b16 a[192:193], v92 offset:4096
    v_mfma_f32_16x16x32_bf16 v[72:75], a[204:207], a[156:159], v[72:75]
    ds_read_b64_tr_b16 a[194:195], v92 offset:10240
    ds_read_b64_tr_b16 a[196:197], v92 offset:16384
    s_waitcnt lgkmcnt(15)
    v_mfma_f32_16x16x32_bf16 v[72:75], a[208:211], a[160:163], v[72:75]
    ds_read_b64_tr_b16 a[198:199], v92 offset:22528
    ds_read_b64_tr_b16 a[200:201], v92 offset:28672
    v_mfma_f32_16x16x32_bf16 v[72:75], a[212:215], a[164:167], v[72:75]
    ds_read_b64_tr_b16 a[202:203], v92 offset:34816
    ds_read_b64_tr_b16 a[204:205], v92 offset:40960
    v_mfma_f32_16x16x32_bf16 v[0:3], a[84:87], v[44:47], v[0:3]
    ds_read_b64_tr_b16 a[206:207], v92 offset:47104
    ds_read_b64_tr_b16 a[208:209], v92 offset:53248
    v_mfma_f32_16x16x32_bf16 v[4:7], a[108:111], v[44:47], v[4:7]
    ds_read_b64_tr_b16 a[210:211], v92 offset:59392
    ds_read_b64_tr_b16 a[212:213], v93 offset:0
    v_mfma_f32_16x16x32_bf16 v[8:11], a[132:135], v[44:47], v[8:11]
    ds_read_b64_tr_b16 a[214:215], v93 offset:6144
    v_cvt_pk_bf16_f32 v72, v72, v73
    v_mfma_f32_16x16x32_bf16 v[12:15], a[156:159], v[44:47], v[12:15]
    v_cvt_pk_bf16_f32 v73, v74, v75
    v_mov_b32 v139, 0
    s_waitcnt lgkmcnt(15)
    v_mfma_f32_16x16x32_bf16 v[76:79], a[216:219], a[144:147], 0
    ds_write2_b32 v94, v72, v73 offset0:32 offset1:36
    v_mfma_f32_16x16x32_bf16 v[76:79], a[220:223], a[148:151], v[76:79]
    buffer_load_dwordx4 a[40:43], v224, s[4:7], s17 offen offset:256
    v_mfma_f32_16x16x32_bf16 v[76:79], a[224:227], a[152:155], v[76:79]
    buffer_load_dwordx4 a[44:47], v224, s[4:7], s17 offen offset:320
    v_mfma_f32_16x16x32_bf16 v[76:79], a[228:231], a[156:159], v[76:79]
    ds_read_b64_tr_b16 a[216:217], v92 offset:5120
    ds_read_b64_tr_b16 a[218:219], v92 offset:11264
    s_waitcnt lgkmcnt(15)
    v_mfma_f32_16x16x32_bf16 v[76:79], a[232:235], a[160:163], v[76:79]
    ds_read_b64_tr_b16 a[220:221], v92 offset:17408
    ds_read_b64_tr_b16 a[222:223], v92 offset:23552
    v_mfma_f32_16x16x32_bf16 v[76:79], a[236:239], a[164:167], v[76:79]
    ds_read_b64_tr_b16 a[224:225], v92 offset:29696
    ds_read_b64_tr_b16 a[226:227], v92 offset:35840
    s_waitcnt lgkmcnt(15)
    v_mfma_f32_16x16x32_bf16 v[80:83], a[192:195], a[144:147], 0
    ds_read_b64_tr_b16 a[228:229], v92 offset:41984
    ds_read_b64_tr_b16 a[230:231], v92 offset:48128
    v_mfma_f32_16x16x32_bf16 v[80:83], a[196:199], a[148:151], v[80:83]
    ds_read_b64_tr_b16 a[232:233], v92 offset:54272
    ds_read_b64_tr_b16 a[234:235], v92 offset:60416
    s_waitcnt lgkmcnt(15)
    v_mfma_f32_16x16x32_bf16 v[80:83], a[200:203], a[152:155], v[80:83]
    ds_read_b64_tr_b16 a[236:237], v93 offset:1024
    v_cvt_pk_bf16_f32 v76, v76, v77
    v_mfma_f32_16x16x32_bf16 v[80:83], a[204:207], a[156:159], v[80:83]
    ds_read_b64_tr_b16 a[238:239], v93 offset:7168
    v_cvt_pk_bf16_f32 v77, v78, v79
    s_waitcnt lgkmcnt(15)
    v_mfma_f32_16x16x32_bf16 v[80:83], a[208:211], a[160:163], v[80:83]
    ds_write2_b32 v94, v76, v77 offset0:48 offset1:52
    s_waitcnt lgkmcnt(14)
    v_mfma_f32_16x16x32_bf16 v[80:83], a[212:215], a[164:167], v[80:83]
    ds_read_b128 a[192:195], v221 offset:8192
    ds_read_b128 a[196:199], v221 offset:20480
    v_mfma_f32_16x16x32_bf16 v[0:3], a[88:91], v[32:35], v[0:3]
    ds_read_b128 a[200:203], v221 offset:9216
    ds_read_b128 a[204:207], v221 offset:21504
    v_mfma_f32_16x16x32_bf16 v[4:7], a[112:115], v[32:35], v[4:7]
    ds_read_b128 a[208:211], v221 offset:10240
    ds_read_b128 a[212:215], v221 offset:22528
    v_mfma_f32_16x16x32_bf16 v[8:11], a[136:139], v[32:35], v[8:11]
    buffer_load_dwordx4 a[64:67], v225, s[4:7], s17 offen offset:256
    v_mfma_f32_16x16x32_bf16 v[12:15], a[160:163], v[32:35], v[12:15]
    buffer_load_dwordx4 a[68:71], v225, s[4:7], s17 offen offset:320
    v_mfma_f32_16x16x32_bf16 v[0:3], a[92:95], v[36:39], v[0:3]
    v_cvt_pk_bf16_f32 v80, v80, v81
    v_cvt_pk_bf16_f32 v81, v82, v83
    v_mfma_f32_16x16x32_bf16 v[4:7], a[116:119], v[36:39], v[4:7]
    ds_write2_b32 v94, v80, v81 offset0:64 offset1:68
    v_mfma_f32_16x16x32_bf16 v[8:11], a[140:143], v[36:39], v[8:11]
    v_mov_b32 v147, 0
    v_mov_b32 v155, 0
    v_mfma_f32_16x16x32_bf16 v[12:15], a[164:167], v[36:39], v[12:15]
    v_max3_f32 v245, v0, v1, v2
    v_mov_b32 v228, 0x4444
    s_waitcnt lgkmcnt(14)
    v_mfma_f32_16x16x32_bf16 v[84:87], a[216:219], a[144:147], 0
    ds_read_b128 a[216:219], v221 offset:11264
    v_max3_f32 v246, v3, v4, v5
    v_mfma_f32_16x16x32_bf16 v[84:87], a[220:223], a[148:151], v[84:87]
    ds_read_b128 a[220:223], v221 offset:23552
    v_max3_f32 v245, v245, v6, v7
    v_mfma_f32_16x16x32_bf16 v[84:87], a[224:227], a[152:155], v[84:87]
    ds_read_b128 a[224:227], v221 offset:12288
    v_cndmask_b32 v12, v244, v12, s[48:49]
    s_waitcnt lgkmcnt(12)
    v_mfma_f32_16x16x32_bf16 v[84:87], a[228:231], a[156:159], v[84:87]
    ds_read_b128 a[228:231], v221 offset:24576
    v_cndmask_b32 v12, v12, v13, s[50:51]
    v_mfma_f32_16x16x32_bf16 v[84:87], a[232:235], a[160:163], v[84:87]
    ds_read_b128 a[232:235], v221 offset:13312
    v_max3_f32 v246, v246, v8, v9
    s_waitcnt lgkmcnt(12)
    v_mfma_f32_16x16x32_bf16 v[84:87], a[236:239], a[164:167], v[84:87]
    ds_read_b128 a[236:239], v221 offset:25600
    v_max3_f32 v245, v245, v10, v11
    s_waitcnt lgkmcnt(11)
    v_mfma_f32_16x16x32_bf16 v[64:67], a[72:75], a[192:195], 0
    v_max3_f32 v245, v245, v246, v12
    v_mov_b32 v246, v245
    v_mfma_f32_16x16x32_bf16 v[68:71], a[96:99], a[192:195], 0
    v_cndmask_b32 v228, v228, v96, s[66:67]
    v_mov_b32 v163, 0
    v_mfma_f32_16x16x32_bf16 v[72:75], a[120:123], a[192:195], 0
    v_cvt_pk_bf16_f32 v84, v84, v85
    v_cvt_pk_bf16_f32 v85, v86, v87
    v_mfma_f32_16x16x32_bf16 v[16:19], a[144:147], a[192:195], 0
    ds_write2_b32 v94, v84, v85 offset0:80 offset1:84
    v_mfma_f32_16x16x32_bf16 v[20:23], a[144:147], a[196:199], 0
    ds_read_b128 a[192:195], v221 offset:32768
    ds_read_b128 a[196:199], v221 offset:45056
    s_waitcnt lgkmcnt(10)
    v_mfma_f32_16x16x32_bf16 v[64:67], a[76:79], a[200:203], v[64:67]
    v_permlane32_swap_b32 v245, v246
    v_mfma_f32_16x16x32_bf16 v[68:71], a[100:103], a[200:203], v[68:71]
    v_max_f32 v245, v245, v246
    v_mov_b32 v246, v245
    v_mfma_f32_16x16x32_bf16 v[72:75], a[124:127], a[200:203], v[72:75]
    v_mov_b32 v171, 0
    v_mov_b32 v179, 0
    v_mfma_f32_16x16x32_bf16 v[16:19], a[148:151], a[200:203], v[16:19]
    ds_read_b128 a[200:203], v221 offset:33792
    v_mov_b32 v187, 0
    v_mfma_f32_16x16x32_bf16 v[20:23], a[148:151], a[204:207], v[20:23]
    ds_read_b128 a[204:207], v221 offset:46080
    v_mov_b32 v195, 0
    v_mfma_f32_16x16x32_bf16 v[64:67], a[80:83], a[208:211], v[64:67]
    s_waitcnt lgkmcnt(4)
    v_mfma_f32_16x16x32_bf16 v[68:71], a[104:107], a[208:211], v[68:71]
    s_barrier
    s_mov_b64 exec, s[56:57]
    ds_read_b128 a[168:171], v95 offset:24576
    s_mov_b64 exec, -1
    s_mov_b64 exec, s[58:59]
    ds_read_b128 a[180:183], v95 offset:24976
    s_mov_b64 exec, -1
    v_mfma_f32_16x16x32_bf16 v[72:75], a[128:131], a[208:211], v[72:75]
    s_mov_b64 exec, s[56:57]
    ds_read_b128 a[172:175], v95 offset:24704
    s_mov_b64 exec, -1
    s_mov_b64 exec, s[58:59]
    ds_read_b128 a[184:187], v95 offset:25104
    s_mov_b64 exec, -1
    v_mfma_f32_16x16x32_bf16 v[16:19], a[152:155], a[208:211], v[16:19]
    s_mov_b64 exec, s[56:57]
    ds_read_b128 a[176:179], v95 offset:24832
    s_mov_b64 exec, -1
    s_mov_b64 exec, s[58:59]
    ds_read_b128 a[188:191], v95 offset:25232
    s_mov_b64 exec, -1
    v_mfma_f32_16x16x32_bf16 v[20:23], a[152:155], a[212:215], v[20:23]
    ds_read_b128 a[208:211], v221 offset:34816
    ds_read_b128 a[212:215], v221 offset:47104
    v_mfma_f32_16x16x32_bf16 v[64:67], a[84:87], a[216:219], v[64:67]
    v_permlane16_swap_b32 v245, v246
    v_mfma_f32_16x16x32_bf16 v[68:71], a[108:111], a[216:219], v[68:71]
    v_max_f32 v245, v245, v246
    v_sub_f32 v0, v0, v245
    v_mfma_f32_16x16x32_bf16 v[72:75], a[132:135], a[216:219], v[72:75]
    v_sub_f32 v1, v1, v245
    v_sub_f32 v2, v2, v245
    v_mfma_f32_16x16x32_bf16 v[16:19], a[156:159], a[216:219], v[16:19]
    ds_read_b128 a[216:219], v221 offset:35840
    v_sub_f32 v3, v3, v245
    v_mfma_f32_16x16x32_bf16 v[20:23], a[156:159], a[220:223], v[20:23]
    ds_read_b128 a[220:223], v221 offset:48128
    v_sub_f32 v4, v4, v245
    v_mfma_f32_16x16x32_bf16 v[64:67], a[88:91], a[224:227], v[64:67]
    v_exp_f32 v0, v0
    v_mfma_f32_16x16x32_bf16 v[68:71], a[112:115], a[224:227], v[68:71]
    v_exp_f32 v1, v1
    v_mfma_f32_16x16x32_bf16 v[72:75], a[136:139], a[224:227], v[72:75]
    v_exp_f32 v2, v2
    v_mfma_f32_16x16x32_bf16 v[16:19], a[160:163], a[224:227], v[16:19]
    ds_read_b128 a[224:227], v221 offset:36864
    v_sub_f32 v5, v5, v245
    v_mfma_f32_16x16x32_bf16 v[20:23], a[160:163], a[228:231], v[20:23]
    ds_read_b128 a[228:231], v221 offset:49152
    v_sub_f32 v6, v6, v245
    v_mfma_f32_16x16x32_bf16 v[64:67], a[92:95], a[232:235], v[64:67]
    v_exp_f32 v3, v3
    v_mfma_f32_16x16x32_bf16 v[68:71], a[116:119], a[232:235], v[68:71]
    v_exp_f32 v4, v4
    v_mfma_f32_16x16x32_bf16 v[72:75], a[140:143], a[232:235], v[72:75]
    v_exp_f32 v5, v5
    v_mfma_f32_16x16x32_bf16 v[16:19], a[164:167], a[232:235], v[16:19]
    ds_read_b128 a[232:235], v221 offset:37888
    v_sub_f32 v7, v7, v245
    v_mfma_f32_16x16x32_bf16 v[20:23], a[164:167], a[236:239], v[20:23]
    ds_read_b128 a[236:239], v221 offset:50176
    v_cvt_pk_bf16_f32 v124, v64, v65
    s_waitcnt lgkmcnt(6)
    v_mfma_f32_16x16x32_bf16 v[76:79], a[72:75], a[192:195], 0
    v_cvt_pk_bf16_f32 v125, v66, v67
    v_cvt_pk_bf16_f32 v126, v68, v69
    v_mfma_f32_16x16x32_bf16 v[80:83], a[96:99], a[192:195], 0
    v_cvt_pk_bf16_f32 v127, v70, v71
    v_cvt_pk_bf16_f32 v128, v72, v73
    v_mfma_f32_16x16x32_bf16 v[84:87], a[120:123], a[192:195], 0
    ds_write_b128 v222, v[124:127] offset:16384
    v_mfma_f32_16x16x32_bf16 v[24:27], a[144:147], a[192:195], 0
    ds_read_b128 a[192:195], v221 offset:57344
    v_cvt_pk_bf16_f32 v129, v74, v75
    v_mfma_f32_16x16x32_bf16 v[28:31], a[144:147], a[196:199], 0
    ds_write_b64 v229, v[128:129] offset:20480
    v_mfma_f32_16x16x32_bf16 v[76:79], a[76:79], a[200:203], v[76:79]
    ds_read_b128 a[196:199], v222 offset:4096
    v_cvt_pk_bf16_f32 v18, v18, v19
    v_mfma_f32_16x16x32_bf16 v[80:83], a[100:103], a[200:203], v[80:83]
    ds_write_b32 v230, v18 offset:22528
    v_mfma_f32_16x16x32_bf16 v[84:87], a[124:127], a[200:203], v[84:87]
    v_cvt_pk_bf16_f32 v22, v22, v23
    v_cvt_pk_bf16_f32 v130, v16, v17
    v_mfma_f32_16x16x32_bf16 v[24:27], a[148:151], a[200:203], v[24:27]
    ds_write_b32 v230, v22 offset:22784
    v_mfma_f32_16x16x32_bf16 v[28:31], a[148:151], a[204:207], v[28:31]
    ds_read_b128 a[200:203], v221 offset:58368
    ds_read_b128 a[204:207], v222 offset:5120
    v_mfma_f32_16x16x32_bf16 v[76:79], a[80:83], a[208:211], v[76:79]
    v_cvt_pk_bf16_f32 v146, v20, v21
    v_sub_f32 v8, v8, v245
    v_mfma_f32_16x16x32_bf16 v[80:83], a[104:107], a[208:211], v[80:83]
    v_exp_f32 v6, v6
    v_mfma_f32_16x16x32_bf16 v[84:87], a[128:131], a[208:211], v[84:87]
    v_add_f32 v247, v0, v1
    v_sub_f32 v9, v9, v245
    v_mfma_f32_16x16x32_bf16 v[24:27], a[152:155], a[208:211], v[24:27]
    ds_read_b128 a[208:211], v221 offset:59392
    v_sub_f32 v10, v10, v245
    v_mfma_f32_16x16x32_bf16 v[28:31], a[152:155], a[212:215], v[28:31]
    ds_read_b128 a[212:215], v222 offset:6144
    v_add_f32 v248, v2, v3
    s_waitcnt lgkmcnt(10)
    v_mfma_f32_16x16x32_bf16 v[76:79], a[84:87], a[216:219], v[76:79]
    s_waitcnt lgkmcnt(4)
    v_mfma_f32_16x16x32_bf16 v[80:83], a[108:111], a[216:219], v[80:83]
    s_barrier
    ds_read_b128 v[132:135], v222 offset:17408
    ds_read_b64 v[136:137], v229 offset:20992
    v_mfma_f32_16x16x32_bf16 v[84:87], a[132:135], a[216:219], v[84:87]
    ds_read_b32 v138, v230 offset:23040
    v_add_f32 v247, v247, v4
    v_mfma_f32_16x16x32_bf16 v[24:27], a[156:159], a[216:219], v[24:27]
    ds_read_b128 v[140:143], v222 offset:18432
    v_sub_f32 v11, v11, v245
    v_mfma_f32_16x16x32_bf16 v[28:31], a[156:159], a[220:223], v[28:31]
    ds_read_b64 v[144:145], v229 offset:21504
    v_sub_f32 v12, v12, v245
    v_mfma_f32_16x16x32_bf16 v[76:79], a[88:91], a[224:227], v[76:79]
    ds_read_b128 v[148:151], v222 offset:19456
    v_add_f32 v248, v248, v5
    v_mfma_f32_16x16x32_bf16 v[80:83], a[112:115], a[224:227], v[80:83]
    ds_read_b64 v[152:153], v229 offset:22016
    v_add_f32 v247, v247, v6
    v_mfma_f32_16x16x32_bf16 v[84:87], a[136:139], a[224:227], v[84:87]
    ds_read_b32 v154, v230 offset:23296
    ds_read_b128 a[216:219], v221 offset:60416
    v_mfma_f32_16x16x32_bf16 v[24:27], a[160:163], a[224:227], v[24:27]
    ds_read_b128 a[220:223], v222 offset:7168
    ds_read_b128 a[224:227], v221 offset:61440
    v_mfma_f32_16x16x32_bf16 v[28:31], a[160:163], a[228:231], v[28:31]
    ds_read_b128 a[228:231], v222 offset:8192
    v_mov_b32 v92, 0
    v_mfma_f32_16x16x32_bf16 v[76:79], a[92:95], a[232:235], v[76:79]
    v_exp_f32 v7, v7
    v_mfma_f32_16x16x32_bf16 v[80:83], a[116:119], a[232:235], v[80:83]
    v_exp_f32 v8, v8
    v_mfma_f32_16x16x32_bf16 v[84:87], a[140:143], a[232:235], v[84:87]
    v_exp_f32 v9, v9
    v_mfma_f32_16x16x32_bf16 v[24:27], a[164:167], a[232:235], v[24:27]
    ds_read_b128 a[232:235], v221 offset:62464
    v_add_f32 v248, v248, v7
    v_mfma_f32_16x16x32_bf16 v[28:31], a[164:167], a[236:239], v[28:31]
    ds_read_b128 a[236:239], v222 offset:9216
    v_add_f32 v247, v247, v8
    v_mfma_f32_16x16x32_bf16 v[64:67], a[72:75], a[192:195], 0
    v_exp_f32 v10, v10
    v_mfma_f32_16x16x32_bf16 v[68:71], a[96:99], a[192:195], 0
    v_exp_f32 v11, v11
    v_mfma_f32_16x16x32_bf16 v[72:75], a[120:123], a[192:195], 0
    v_exp_f32 v12, v12
    v_mfma_f32_16x16x32_bf16 v[16:19], a[144:147], a[192:195], 0
    ds_read_b128 a[192:195], v220 offset:0
    v_add_f32 v248, v248, v9
    v_mfma_f32_16x16x32_bf16 v[20:23], a[144:147], a[196:199], 0
    ds_read_b128 a[196:199], v220 offset:1024
    v_add_f32 v247, v247, v10
    s_waitcnt lgkmcnt(10)
    v_mfma_f32_16x16x32_bf16 v[64:67], a[76:79], a[200:203], v[64:67]
    v_add_f32 v248, v248, v11
    v_add_f32 v247, v247, v12
    v_mfma_f32_16x16x32_bf16 v[68:71], a[100:103], a[200:203], v[68:71]
    v_add_f32 v247, v247, v248
    v_mov_b32 v248, v247
    v_mfma_f32_16x16x32_bf16 v[72:75], a[124:127], a[200:203], v[72:75]
    v_cvt_pk_bf16_f32 v156, v76, v77
    v_cvt_pk_bf16_f32 v157, v78, v79
    v_mfma_f32_16x16x32_bf16 v[16:19], a[148:151], a[200:203], v[16:19]
    ds_read_b128 a[200:203], v220 offset:2048
    v_cvt_pk_bf16_f32 v158, v80, v81
    v_mfma_f32_16x16x32_bf16 v[20:23], a[148:151], a[204:207], v[20:23]
    ds_read_b128 a[204:207], v220 offset:3072
    v_permlane32_swap_b32 v247, v248
    v_add_f32 v247, v247, v248
    v_mov_b32 v248, v247
    v_cvt_pk_bf16_f32 v159, v82, v83
    v_cvt_pk_bf16_f32 v160, v84, v85
    v_permlane16_swap_b32 v247, v248
    v_add_f32 v247, v247, v248
    v_rcp_f32 v249, v247
    v_cvt_pk_bf16_f32 v161, v86, v87
    v_mul_f32 v0, v0, v249
    v_mul_f32 v1, v1, v249
    v_cvt_pk_bf16_f32 v0, v0, v1
    v_mul_f32 v2, v2, v249
    v_mul_f32 v3, v3, v249
    v_cvt_pk_bf16_f32 v1, v2, v3
    v_mul_f32 v4, v4, v249
    v_mul_f32 v5, v5, v249
    v_mul_f32 v6, v6, v249
    v_mul_f32 v7, v7, v249
    v_cvt_pk_bf16_f32 v2, v4, v5
    v_cvt_pk_bf16_f32 v3, v6, v7
    v_mul_f32 v12, v12, v249
    v_mul_f32 v8, v8, v249
    v_mfma_f32_16x16x32_bf16 v[48:51], v[0:3], v[124:127], 0
    ds_write_b128 v222, v[156:159] offset:24576
    v_mul_f32 v9, v9, v249
    v_mul_f32 v10, v10, v249
    v_mul_f32 v11, v11, v249
    v_cvt_pk_bf16_f32 v6, v12, 0
    v_cvt_pk_bf16_f32 v4, v8, v9
    v_cvt_pk_bf16_f32 v5, v10, v11
    v_lshlrev_b32 v6, s54, v6
    v_mov_b32 v7, 0
    s_nop 0
    s_nop 0
    v_mfma_f32_16x16x32_bf16 v[48:51], v[4:7], v[128:131], v[48:51]
    ds_write_b64 v229, v[160:161] offset:28672
    v_mfma_f32_16x16x32_bf16 v[52:55], v[0:3], v[132:135], 0
    v_cvt_pk_bf16_f32 v26, v26, v27
    v_cvt_pk_bf16_f32 v30, v30, v31
    v_mfma_f32_16x16x32_bf16 v[52:55], v[4:7], v[136:139], v[52:55]
    ds_write_b32 v230, v26 offset:30720
    v_mfma_f32_16x16x32_bf16 v[64:67], a[80:83], a[208:211], v[64:67]
    ds_write_b32 v230, v30 offset:30976
    v_mfma_f32_16x16x32_bf16 v[68:71], a[104:107], a[208:211], v[68:71]
    v_mov_b32 v26, 0
    v_mov_b32 v27, 0
    v_mfma_f32_16x16x32_bf16 v[72:75], a[128:131], a[208:211], v[72:75]
    v_cvt_pk_bf16_f32 v162, v24, v25
    v_mov_b32 v30, 0
    v_mfma_f32_16x16x32_bf16 v[16:19], a[152:155], a[208:211], v[16:19]
    ds_read_b128 a[208:211], v220 offset:4096
    v_mov_b32 v31, 0
    v_mfma_f32_16x16x32_bf16 v[20:23], a[152:155], a[212:215], v[20:23]
    ds_read_b128 a[212:215], v220 offset:5120
    v_cvt_pk_bf16_f32 v178, v28, v29
    v_mfma_f32_16x16x32_bf16 v[56:59], v[0:3], v[140:143], 0
    v_cvt_pk_bf16_f32 v100, v48, v52
    v_cvt_pk_bf16_f32 v102, v49, v53
    v_mfma_f32_16x16x32_bf16 v[56:59], v[4:7], v[144:147], v[56:59]
    v_cvt_pk_bf16_f32 v104, v50, v54
    v_cvt_pk_bf16_f32 v106, v51, v55
    v_mfma_f32_16x16x32_bf16 v[60:63], v[0:3], v[148:151], 0
    s_waitcnt lgkmcnt(2)
    v_mfma_f32_16x16x32_bf16 v[60:63], v[4:7], v[152:155], v[60:63]
    s_barrier
    ds_read_b128 v[164:167], v222 offset:25600
    ds_read_b64 v[168:169], v229 offset:29184
    v_mfma_f32_16x16x32_bf16 v[64:67], a[84:87], a[216:219], v[64:67]
    ds_read_b32 v170, v230 offset:31232
    ds_read_b128 v[172:175], v222 offset:26624
    v_mfma_f32_16x16x32_bf16 v[68:71], a[108:111], a[216:219], v[68:71]
    ds_read_b64 v[176:177], v229 offset:29696
    ds_read_b128 v[180:183], v222 offset:27648
    v_mfma_f32_16x16x32_bf16 v[72:75], a[132:135], a[216:219], v[72:75]
    ds_read_b64 v[184:185], v229 offset:30208
    ds_read_b32 v186, v230 offset:31488
    v_mfma_f32_16x16x32_bf16 v[16:19], a[156:159], a[216:219], v[16:19]
    ds_read_b128 a[216:219], v220 offset:6144
    v_cvt_pk_bf16_f32 v101, v56, v60
    v_mfma_f32_16x16x32_bf16 v[20:23], a[156:159], a[220:223], v[20:23]
    ds_read_b128 a[220:223], v220 offset:7168
    v_cvt_pk_bf16_f32 v103, v57, v61
    v_mfma_f32_16x16x32_bf16 v[64:67], a[88:91], a[224:227], v[64:67]
    buffer_store_dwordx2 v[100:101], v233, s[8:11], s20 offen offset:0 sc0 sc1
    v_cvt_pk_bf16_f32 v105, v58, v62
    v_mfma_f32_16x16x32_bf16 v[68:71], a[112:115], a[224:227], v[68:71]
    v_cvt_pk_bf16_f32 v107, v59, v63
    v_mov_b32 v93, 0
    v_mfma_f32_16x16x32_bf16 v[72:75], a[136:139], a[224:227], v[72:75]
    v_mfma_f32_16x16x32_bf16 v[16:19], a[160:163], a[224:227], v[16:19]
    buffer_store_dwordx2 v[102:103], v233, s[8:11], s21 offen offset:0 sc0 sc1
    ds_read_b128 a[224:227], v220 offset:8192
    v_mfma_f32_16x16x32_bf16 v[20:23], a[160:163], a[228:231], v[20:23]
    ds_read_b128 a[228:231], v220 offset:9216
    v_mfma_f32_16x16x32_bf16 v[64:67], a[92:95], a[232:235], v[64:67]
    v_mfma_f32_16x16x32_bf16 v[68:71], a[116:119], a[232:235], v[68:71]
    buffer_store_dwordx2 v[104:105], v233, s[8:11], s22 offen offset:0 sc0 sc1
    v_mfma_f32_16x16x32_bf16 v[72:75], a[140:143], a[232:235], v[72:75]
    v_mfma_f32_16x16x32_bf16 v[16:19], a[164:167], a[232:235], v[16:19]
    ds_read_b128 a[232:235], v220 offset:10240
    v_mfma_f32_16x16x32_bf16 v[20:23], a[164:167], a[236:239], v[20:23]
    buffer_store_dwordx2 v[106:107], v233, s[8:11], s23 offen offset:0 sc0 sc1
    ds_read_b128 a[236:239], v220 offset:11264
    v_smfmac_f32_16x16x64_bf16 v[24:27], a[168:171], a[144:151], v228
    v_cvt_pk_bf16_f32 v188, v64, v65
    v_cvt_pk_bf16_f32 v189, v66, v67
    v_smfmac_f32_16x16x64_bf16 v[24:27], a[172:175], a[152:159], v228
    v_cvt_pk_bf16_f32 v190, v68, v69
    v_cvt_pk_bf16_f32 v191, v70, v71
    v_smfmac_f32_16x16x64_bf16 v[24:27], a[176:179], a[160:167], v228
    ds_write_b128 v222, v[188:191] offset:16384
    v_smfmac_f32_16x16x64_bf16 v[28:31], a[180:183], a[144:151], v228
    v_cvt_pk_bf16_f32 v192, v72, v73
    v_cvt_pk_bf16_f32 v193, v74, v75
    v_smfmac_f32_16x16x64_bf16 v[28:31], a[184:187], a[152:159], v228
    ds_write_b64 v229, v[192:193] offset:20480
    v_smfmac_f32_16x16x64_bf16 v[28:31], a[188:191], a[160:167], v228
    v_cvt_pk_bf16_f32 v18, v18, v19
    v_cvt_pk_bf16_f32 v22, v22, v23
    v_mfma_f32_16x16x32_bf16 v[48:51], v[0:3], v[156:159], 0
    ds_write_b32 v230, v18 offset:22528
    v_mfma_f32_16x16x32_bf16 v[48:51], v[4:7], v[160:163], v[48:51]
    ds_write_b32 v230, v22 offset:22784
    s_waitcnt lgkmcnt(6)
    v_mfma_f32_16x16x32_bf16 v[52:55], v[0:3], v[164:167], 0
    v_cvt_pk_bf16_f32 v194, v16, v17
    v_cvt_pk_bf16_f32 v210, v20, v21
    v_mfma_f32_16x16x32_bf16 v[52:55], v[4:7], v[168:171], v[52:55]
    v_add_f32 v26, v26, v27
    v_add_f32 v30, v30, v31
    v_mfma_f32_16x16x32_bf16 v[56:59], v[0:3], v[172:175], 0
    v_cndmask_b32 v231, v26, v30, s[66:67]
    v_mfma_f32_16x16x32_bf16 v[56:59], v[4:7], v[176:179], v[56:59]
    v_mfma_f32_16x16x32_bf16 v[60:63], v[0:3], v[180:183], 0
    v_mfma_f32_16x16x32_bf16 v[60:63], v[4:7], v[184:187], v[60:63]
    s_waitcnt lgkmcnt(0)
    s_barrier
    ds_read_b128 v[196:199], v222 offset:17408
    ds_read_b64 v[200:201], v229 offset:20992
    ds_read_b32 v202, v230 offset:23040
    ds_read_b128 v[204:207], v222 offset:18432
    ds_read_b64 v[208:209], v229 offset:21504
    ds_read_b128 v[212:215], v222 offset:19456
    ds_read_b64 v[216:217], v229 offset:22016
    ds_read_b32 v218, v230 offset:23296
    v_cvt_pk_bf16_f32 v108, v48, v52
    v_cvt_pk_bf16_f32 v110, v49, v53
    v_cvt_pk_bf16_f32 v112, v50, v54
    v_cvt_pk_bf16_f32 v114, v51, v55
    v_mfma_f32_16x16x32_bf16 v[48:51], v[0:3], v[188:191], 0
    ds_write_b64 v227, v[92:93] offset:0
    v_mfma_f32_16x16x32_bf16 v[48:51], v[4:7], v[192:195], v[48:51]
    ds_write_b64 v227, v[92:93] offset:8
    v_cvt_pk_bf16_f32 v109, v56, v60
    v_cvt_pk_bf16_f32 v111, v57, v61
    v_cvt_pk_bf16_f32 v113, v58, v62
    v_cvt_pk_bf16_f32 v115, v59, v63
    buffer_store_dwordx2 v[108:109], v233, s[8:11], s20 offen offset:128 sc0 sc1
    buffer_store_dwordx2 v[110:111], v233, s[8:11], s21 offen offset:128 sc0 sc1
    s_waitcnt lgkmcnt(9)
    v_mfma_f32_16x16x32_bf16 v[52:55], v[0:3], v[196:199], 0
    buffer_store_dwordx2 v[112:113], v233, s[8:11], s22 offen offset:128 sc0 sc1
    s_waitcnt lgkmcnt(7)
    v_mfma_f32_16x16x32_bf16 v[52:55], v[4:7], v[200:203], v[52:55]
    s_waitcnt lgkmcnt(6)
    v_mfma_f32_16x16x32_bf16 v[56:59], v[0:3], v[204:207], 0
    s_waitcnt lgkmcnt(5)
    v_mfma_f32_16x16x32_bf16 v[56:59], v[4:7], v[208:211], v[56:59]
    buffer_store_dwordx2 v[114:115], v233, s[8:11], s23 offen offset:128 sc0 sc1
    s_waitcnt lgkmcnt(2)
    v_mfma_f32_16x16x32_bf16 v[60:63], v[0:3], v[212:215], 0
    v_mfma_f32_16x16x32_bf16 v[60:63], v[4:7], v[216:219], v[60:63]
    s_nop 0
    s_nop 0
    s_nop 0
    v_cvt_pk_bf16_f32 v116, v48, v52
    v_cvt_pk_bf16_f32 v118, v49, v53
    v_cvt_pk_bf16_f32 v120, v50, v54
    v_cvt_pk_bf16_f32 v122, v51, v55
    s_nop 0
    v_cvt_pk_bf16_f32 v117, v56, v60
    v_cvt_pk_bf16_f32 v119, v57, v61
    v_cvt_pk_bf16_f32 v121, v58, v62
    v_cvt_pk_bf16_f32 v123, v59, v63
    buffer_store_dwordx2 v[116:117], v233, s[8:11], s20 offen offset:256 sc0 sc1
    buffer_store_dwordx2 v[118:119], v233, s[8:11], s21 offen offset:256 sc0 sc1
    buffer_store_dwordx2 v[120:121], v233, s[8:11], s22 offen offset:256 sc0 sc1
    buffer_store_dwordx2 v[122:123], v233, s[8:11], s23 offen offset:256 sc0 sc1
    s_mov_b32 s10, 0
    s_waitcnt vmcnt(12) lgkmcnt(0)
    s_branch L_b0
.p2align 6
L_sh1:
L_pad1:
    s_cbranch_execz L_pad7
    s_waitcnt vmcnt(8) lgkmcnt(0)
    s_barrier
    v_accvgpr_read_b32 v97, a248
    v_accvgpr_read_b32 v94, a242
    v_accvgpr_read_b32 v95, a243
    v_accvgpr_read_b32 v92, a241
    v_mov_b32 v246, 0
    v_add_u32 v93, 0x10000, v92
    v_accvgpr_read_b32 v96, a246
    v_mov_b32 v96, 0xeeee
    v_mov_b32 v203, 0
    v_mov_b32 v211, 0
    v_mov_b32 v219, 0
    v_accvgpr_read_b32 v227, a245
    v_accvgpr_read_b32 v226, a244
    v_cndmask_b32 v240, v244, v232, s[40:41]
    v_cndmask_b32 v241, v244, v233, s[40:41]
    s_mov_b32 s18, s17
    buffer_load_dwordx4 v[156:159], v102, s[12:15], 0 offen offset:2048 sc1
    ds_read_b128 a[192:195], v220 offset:6144
    ds_read_b128 a[196:199], v220 offset:18432
    ds_read_b128 a[200:203], v220 offset:7168
    ds_read_b128 a[204:207], v220 offset:19456
    ds_read_b128 a[208:211], v220 offset:8192
    ds_read_b128 a[212:215], v220 offset:20480
    ds_read_b128 a[216:219], v220 offset:9216
    buffer_load_dwordx4 v[160:163], v103, s[12:15], 0 offen offset:0 sc1
    s_waitcnt vmcnt(9)
    ds_write_b128 v100, v[124:127] offset:0
    ds_read_b128 a[220:223], v220 offset:21504
    ds_read_b128 a[224:227], v220 offset:10240
    buffer_load_dwordx4 v[164:167], v103, s[12:15], 0 offen offset:1024 sc1
    s_waitcnt vmcnt(9)
    ds_write_b128 v100, v[128:131] offset:1024
    ds_read_b128 a[228:231], v220 offset:22528
    buffer_load_dwordx4 v[168:171], v103, s[12:15], 0 offen offset:2048 sc1
    s_waitcnt lgkmcnt(11)
    v_mfma_f32_16x16x32_bf16 v[64:67], a[192:195], a[72:75], 0
    ds_read_b128 a[232:235], v220 offset:11264
    ds_read_b128 a[236:239], v220 offset:23552
    v_mfma_f32_16x16x32_bf16 v[68:71], a[192:195], a[96:99], 0
    v_mfma_f32_16x16x32_bf16 v[72:75], a[192:195], a[120:123], 0
    v_mfma_f32_16x16x32_bf16 v[0:3], a[192:195], a[144:147], 0
    ds_read_b128 a[192:195], v220 offset:30720
    s_waitcnt lgkmcnt(8)
    v_mfma_f32_16x16x32_bf16 v[4:7], a[196:199], a[144:147], 0
    ds_read_b128 a[196:199], v220 offset:43008
    v_mfma_f32_16x16x32_bf16 v[64:67], a[200:203], a[76:79], v[64:67]
    v_mfma_f32_16x16x32_bf16 v[68:71], a[200:203], a[100:103], v[68:71]
    v_max3_u32 v246, v246, v124, v125
    v_max3_u32 v246, v246, v126, v127
    v_mfma_f32_16x16x32_bf16 v[72:75], a[200:203], a[124:127], v[72:75]
    v_mfma_f32_16x16x32_bf16 v[0:3], a[200:203], a[148:151], v[0:3]
    ds_read_b128 a[200:203], v220 offset:31744
    v_mfma_f32_16x16x32_bf16 v[4:7], a[204:207], a[148:151], v[4:7]
    ds_read_b128 a[204:207], v220 offset:44032
    v_mfma_f32_16x16x32_bf16 v[64:67], a[208:211], a[80:83], v[64:67]
    v_max3_u32 v246, v246, v128, v129
    v_max3_u32 v246, v246, v130, v131
    v_mfma_f32_16x16x32_bf16 v[68:71], a[208:211], a[104:107], v[68:71]
    v_mov_b32 v131, 0
    v_mfma_f32_16x16x32_bf16 v[72:75], a[208:211], a[128:131], v[72:75]
    v_mfma_f32_16x16x32_bf16 v[0:3], a[208:211], a[152:155], v[0:3]
    ds_read_b128 a[208:211], v220 offset:32768
    v_mfma_f32_16x16x32_bf16 v[4:7], a[212:215], a[152:155], v[4:7]
    s_waitcnt vmcnt(9)
    ds_write_b128 v100, v[132:135] offset:2048
    v_mfma_f32_16x16x32_bf16 v[64:67], a[216:219], a[84:87], v[64:67]
    v_max3_u32 v246, v246, v132, v133
    v_max3_u32 v246, v246, v134, v135
    v_mfma_f32_16x16x32_bf16 v[68:71], a[216:219], a[108:111], v[68:71]
    ds_read_b128 a[212:215], v220 offset:45056
    v_mfma_f32_16x16x32_bf16 v[72:75], a[216:219], a[132:135], v[72:75]
    v_mfma_f32_16x16x32_bf16 v[0:3], a[216:219], a[156:159], v[0:3]
    s_waitcnt vmcnt(8)
    ds_write_b128 v101, v[136:139] offset:0
    s_waitcnt lgkmcnt(6)
    v_mfma_f32_16x16x32_bf16 v[4:7], a[220:223], a[156:159], v[4:7]
    v_max3_u32 v246, v246, v136, v137
L_pad7:
    s_cbranch_execz L_pad8
    v_max3_u32 v246, v246, v138, v139
    v_mfma_f32_16x16x32_bf16 v[64:67], a[224:227], a[88:91], v[64:67]
    buffer_load_dwordx4 v[172:175], v104, s[12:15], 0 offen offset:0 sc1
    v_mfma_f32_16x16x32_bf16 v[68:71], a[224:227], a[112:115], v[68:71]
    ds_read_b128 a[216:219], v220 offset:33792
    ds_read_b128 a[220:223], v220 offset:46080
    v_mfma_f32_16x16x32_bf16 v[72:75], a[224:227], a[136:139], v[72:75]
    s_waitcnt vmcnt(8)
    ds_write_b128 v101, v[140:143] offset:1024
    v_mfma_f32_16x16x32_bf16 v[0:3], a[224:227], a[160:163], v[0:3]
    v_max3_u32 v246, v246, v140, v141
    v_max3_u32 v246, v246, v142, v143
    v_mfma_f32_16x16x32_bf16 v[4:7], a[228:231], a[160:163], v[4:7]
    buffer_load_dwordx4 v[176:179], v104, s[12:15], 0 offen offset:1024 sc1
    v_mfma_f32_16x16x32_bf16 v[64:67], a[232:235], a[92:95], v[64:67]
    ds_read_b128 a[224:227], v220 offset:34816
    ds_read_b128 a[228:231], v220 offset:47104
    v_mfma_f32_16x16x32_bf16 v[68:71], a[232:235], a[116:119], v[68:71]
    s_waitcnt vmcnt(8)
    ds_write_b128 v101, v[144:147] offset:2048
    v_mfma_f32_16x16x32_bf16 v[72:75], a[232:235], a[140:143], v[72:75]
    v_max3_u32 v246, v246, v144, v145
    v_max3_u32 v246, v246, v146, v147
    v_mfma_f32_16x16x32_bf16 v[0:3], a[232:235], a[164:167], v[0:3]
    buffer_load_dwordx4 v[180:183], v104, s[12:15], 0 offen offset:2048 sc1
    v_mfma_f32_16x16x32_bf16 v[4:7], a[236:239], a[164:167], v[4:7]
    ds_read_b128 a[232:235], v220 offset:35840
    v_cvt_pk_bf16_f32 v64, v64, v65
    v_mfma_f32_16x16x32_bf16 v[76:79], a[192:195], a[72:75], 0
    s_waitcnt vmcnt(8)
    ds_write_b128 v102, v[148:151] offset:0
    v_mfma_f32_16x16x32_bf16 v[80:83], a[192:195], a[96:99], 0
    v_cvt_pk_bf16_f32 v72, v72, v73
    v_cvt_pk_bf16_f32 v0, v0, v1
    v_mfma_f32_16x16x32_bf16 v[84:87], a[192:195], a[120:123], 0
    buffer_load_dwordx4 v[184:187], v105, s[12:15], 0 offen offset:0 sc1
    v_mfma_f32_16x16x32_bf16 v[8:11], a[192:195], a[144:147], 0
    ds_read_b128 a[236:239], v220 offset:48128
    v_cvt_pk_bf16_f32 v4, v4, v5
    v_mfma_f32_16x16x32_bf16 v[12:15], a[196:199], a[144:147], 0
    s_waitcnt vmcnt(8)
    ds_write_b128 v102, v[152:155] offset:1024
    s_waitcnt lgkmcnt(7)
    v_mfma_f32_16x16x32_bf16 v[76:79], a[200:203], a[76:79], v[76:79]
    v_cvt_pk_bf16_f32 v65, v66, v67
    v_cvt_pk_bf16_f32 v73, v74, v75
    v_mfma_f32_16x16x32_bf16 v[80:83], a[200:203], a[100:103], v[80:83]
    ds_write_b64 v229, v[64:65] offset:17408
    v_mfma_f32_16x16x32_bf16 v[84:87], a[200:203], a[124:127], v[84:87]
    ds_write_b64 v222, v[72:73] offset:19464
    v_mfma_f32_16x16x32_bf16 v[8:11], a[200:203], a[148:151], v[8:11]
    buffer_load_dwordx4 v[188:191], v105, s[12:15], 0 offen offset:1024 sc1
    v_mfma_f32_16x16x32_bf16 v[12:15], a[204:207], a[148:151], v[12:15]
    s_waitcnt vmcnt(8)
    ds_write_b128 v102, v[156:159] offset:2048
    v_mfma_f32_16x16x32_bf16 v[76:79], a[208:211], a[80:83], v[76:79]
    buffer_load_dwordx4 v[192:195], v105, s[12:15], 0 offen offset:2048 sc1
    v_mfma_f32_16x16x32_bf16 v[80:83], a[208:211], a[104:107], v[80:83]
    buffer_load_dwordx4 a[0:3], v223, s[4:7], s17 offen offset:0
    v_mfma_f32_16x16x32_bf16 v[84:87], a[208:211], a[128:131], v[84:87]
    buffer_load_dwordx4 a[4:7], v223, s[4:7], s17 offen offset:64
    v_mfma_f32_16x16x32_bf16 v[8:11], a[208:211], a[152:155], v[8:11]
    s_waitcnt vmcnt(10)
    ds_write_b128 v103, v[160:163] offset:0
    v_mfma_f32_16x16x32_bf16 v[12:15], a[212:215], a[152:155], v[12:15]
    v_cvt_pk_bf16_f32 v1, v2, v3
    v_cvt_pk_bf16_f32 v5, v6, v7
    v_mfma_f32_16x16x32_bf16 v[76:79], a[216:219], a[84:87], v[76:79]
    ds_write2_b32 v228, v0, v1 offset0:0 offset1:4
    v_mfma_f32_16x16x32_bf16 v[80:83], a[216:219], a[108:111], v[80:83]
    ds_write2_b32 v228, v4, v5 offset0:16 offset1:20
    v_mfma_f32_16x16x32_bf16 v[84:87], a[216:219], a[132:135], v[84:87]
    s_waitcnt vmcnt(9)
    ds_write_b128 v103, v[164:167] offset:1024
    v_mfma_f32_16x16x32_bf16 v[8:11], a[216:219], a[156:159], v[8:11]
    v_xor_b32 v228, 0x2000, v228
    v_cvt_pk_bf16_f32 v34, v68, v69
    v_mfma_f32_16x16x32_bf16 v[12:15], a[220:223], a[156:159], v[12:15]
    ds_read_b128 a[192:195], v220 offset:55296
    ds_read_b128 a[196:199], v221 offset:2048
    s_waitcnt lgkmcnt(7)
    v_mfma_f32_16x16x32_bf16 v[76:79], a[224:227], a[88:91], v[76:79]
    s_waitcnt vmcnt(8)
    ds_write_b128 v103, v[168:171] offset:2048
    v_mfma_f32_16x16x32_bf16 v[80:83], a[224:227], a[112:115], v[80:83]
    buffer_load_dwordx4 a[24:27], v224, s[4:7], s17 offen offset:0
    v_mfma_f32_16x16x32_bf16 v[84:87], a[224:227], a[136:139], v[84:87]
    s_waitcnt lgkmcnt(4)
    ds_read_b128 a[200:203], v220 offset:56320
    s_barrier
    v_mfma_f32_16x16x32_bf16 v[8:11], a[224:227], a[160:163], v[8:11]
    ds_read_b64 v[32:33], v229 offset:18944
    ds_read_b128 v[36:39], v222 offset:17920
    v_mfma_f32_16x16x32_bf16 v[12:15], a[228:231], a[160:163], v[12:15]
    s_mov_b64 exec, s[60:61]
    ds_read_b128 a[168:171], v97 offset:20992
    s_mov_b64 exec, -1
    s_mov_b64 exec, s[62:63]
    ds_read_b128 a[180:183], v97 offset:21136
    s_mov_b64 exec, -1
    v_mfma_f32_16x16x32_bf16 v[76:79], a[232:235], a[92:95], v[76:79]
    buffer_load_dwordx4 a[28:31], v224, s[4:7], s17 offen offset:64
    v_mfma_f32_16x16x32_bf16 v[80:83], a[232:235], a[116:119], v[80:83]
    s_waitcnt vmcnt(9)
    ds_write_b128 v104, v[172:175] offset:0
    v_mfma_f32_16x16x32_bf16 v[84:87], a[232:235], a[140:143], v[84:87]
    v_cvt_pk_bf16_f32 v35, v70, v71
    v_max3_u32 v246, v246, v148, v149
    v_mfma_f32_16x16x32_bf16 v[8:11], a[232:235], a[164:167], v[8:11]
    ds_read_b128 a[204:207], v221 offset:3072
    v_cvt_pk_bf16_f32 v76, v76, v77
    v_mfma_f32_16x16x32_bf16 v[12:15], a[236:239], a[164:167], v[12:15]
    s_waitcnt vmcnt(8)
    ds_write_b128 v104, v[176:179] offset:1024
    s_waitcnt lgkmcnt(10)
    v_mfma_f32_16x16x32_bf16 v[64:67], a[192:195], a[72:75], 0
    v_cvt_pk_bf16_f32 v84, v84, v85
    v_cvt_pk_bf16_f32 v77, v78, v79
    v_mfma_f32_16x16x32_bf16 v[68:71], a[192:195], a[96:99], 0
    ds_write_b64 v229, v[76:77] offset:25600
    v_mfma_f32_16x16x32_bf16 v[72:75], a[192:195], a[120:123], 0
    ds_read_b128 a[208:211], v220 offset:57344
    v_cvt_pk_bf16_f32 v8, v8, v9
    v_mfma_f32_16x16x32_bf16 v[0:3], a[192:195], a[144:147], 0
    s_waitcnt vmcnt(7)
    ds_write_b128 v104, v[180:183] offset:2048
    s_waitcnt lgkmcnt(11)
    v_mfma_f32_16x16x32_bf16 v[4:7], a[196:199], a[144:147], 0
    buffer_load_dwordx4 a[48:51], v225, s[4:7], s17 offen offset:0
    s_waitcnt lgkmcnt(10)
    v_mfma_f32_16x16x32_bf16 v[64:67], a[200:203], a[76:79], v[64:67]
    ds_read_b128 a[212:215], v221 offset:4096
    v_cvt_pk_bf16_f32 v12, v12, v13
    v_mfma_f32_16x16x32_bf16 v[68:71], a[200:203], a[100:103], v[68:71]
    s_waitcnt vmcnt(7)
    ds_write_b128 v105, v[184:187] offset:0
    v_mfma_f32_16x16x32_bf16 v[72:75], a[200:203], a[124:127], v[72:75]
    buffer_load_dwordx4 a[52:55], v225, s[4:7], s17 offen offset:64
    v_mfma_f32_16x16x32_bf16 v[0:3], a[200:203], a[148:151], v[0:3]
    ds_read_b128 a[216:219], v220 offset:58368
    v_cvt_pk_bf16_f32 v85, v86, v87
    s_waitcnt lgkmcnt(7)
    v_mfma_f32_16x16x32_bf16 v[4:7], a[204:207], a[148:151], v[4:7]
    ds_write_b64 v222, v[84:85] offset:27656
    v_mfma_f32_16x16x32_bf16 v[16:19], a[72:75], v[32:35], 0
    s_waitcnt vmcnt(7)
    ds_write_b128 v105, v[188:191] offset:1024
    v_mfma_f32_16x16x32_bf16 v[20:23], a[96:99], v[32:35], 0
    v_cvt_pk_bf16_f32 v9, v10, v11
    v_cvt_pk_bf16_f32 v13, v14, v15
    v_mfma_f32_16x16x32_bf16 v[24:27], a[120:123], v[32:35], 0
    ds_write2_b32 v228, v8, v9 offset0:0 offset1:4
    v_mfma_f32_16x16x32_bf16 v[28:31], a[144:147], v[32:35], 0
    ds_write2_b32 v228, v12, v13 offset0:16 offset1:20
    s_waitcnt lgkmcnt(8)
    v_mfma_f32_16x16x32_bf16 v[64:67], a[208:211], a[80:83], v[64:67]
    s_waitcnt vmcnt(6)
    ds_write_b128 v105, v[192:195] offset:2048
    v_mfma_f32_16x16x32_bf16 v[68:71], a[208:211], a[104:107], v[68:71]
    buffer_load_dwordx4 a[8:11], v223, s[4:7], s17 offen offset:128
    v_mfma_f32_16x16x32_bf16 v[72:75], a[208:211], a[128:131], v[72:75]
    ds_read_b128 a[220:223], v221 offset:5120
    v_xor_b32 v228, 0x2000, v228
    v_mfma_f32_16x16x32_bf16 v[0:3], a[208:211], a[152:155], v[0:3]
    ds_read_b128 a[224:227], v220 offset:59392
    ds_read_b128 a[228:231], v221 offset:6144
    s_waitcnt lgkmcnt(9)
    v_mfma_f32_16x16x32_bf16 v[4:7], a[212:215], a[152:155], v[4:7]
    buffer_load_dwordx4 a[12:15], v223, s[4:7], s17 offen offset:192
    v_mfma_f32_16x16x32_bf16 v[16:19], a[76:79], v[36:39], v[16:19]
    ds_read_b128 a[232:235], v220 offset:60416
    ds_read_b128 a[236:239], v221 offset:7168
    v_mfma_f32_16x16x32_bf16 v[20:23], a[100:103], v[36:39], v[20:23]
    s_waitcnt lgkmcnt(6)
    ds_read_b64_tr_b16 a[192:193], v92 offset:0
    s_barrier
    v_mfma_f32_16x16x32_bf16 v[24:27], a[124:127], v[36:39], v[24:27]
    ds_read_b64 v[40:41], v229 offset:27136
    ds_read_b128 v[44:47], v222 offset:26112
    v_mfma_f32_16x16x32_bf16 v[28:31], a[148:151], v[36:39], v[28:31]
    s_mov_b64 exec, s[60:61]
    ds_read_b128 a[172:175], v97 offset:29184
    s_mov_b64 exec, -1
    s_mov_b64 exec, s[62:63]
    ds_read_b128 a[184:187], v97 offset:29328
    s_mov_b64 exec, -1
    v_mfma_f32_16x16x32_bf16 v[64:67], a[216:219], a[84:87], v[64:67]
    ds_read_b64_tr_b16 a[194:195], v92 offset:6144
    ds_read_b64_tr_b16 a[196:197], v92 offset:12288
    v_mfma_f32_16x16x32_bf16 v[68:71], a[216:219], a[108:111], v[68:71]
    ds_read_b64_tr_b16 a[198:199], v92 offset:18432
    ds_read_b64_tr_b16 a[200:201], v92 offset:24576
    v_mfma_f32_16x16x32_bf16 v[72:75], a[216:219], a[132:135], v[72:75]
    ds_read_b64_tr_b16 a[202:203], v92 offset:30720
    ds_read_b64_tr_b16 a[204:205], v92 offset:36864
    v_mfma_f32_16x16x32_bf16 v[0:3], a[216:219], a[156:159], v[0:3]
    ds_read_b64_tr_b16 a[206:207], v92 offset:43008
    ds_read_b64_tr_b16 a[208:209], v92 offset:49152
    ds_read_b64_tr_b16 a[210:211], v92 offset:55296
    buffer_load_dwordx4 a[32:35], v224, s[4:7], s17 offen offset:128
    s_waitcnt lgkmcnt(15)
    v_mfma_f32_16x16x32_bf16 v[4:7], a[220:223], a[156:159], v[4:7]
    ds_read_b64_tr_b16 a[212:213], v92 offset:61440
    ds_read_b64_tr_b16 a[214:215], v93 offset:2048
    v_mfma_f32_16x16x32_bf16 v[64:67], a[224:227], a[88:91], v[64:67]
    ds_read_b64_tr_b16 a[216:217], v92 offset:1024
    ds_read_b64_tr_b16 a[218:219], v92 offset:7168
    v_mfma_f32_16x16x32_bf16 v[68:71], a[224:227], a[112:115], v[68:71]
    buffer_load_dwordx4 a[36:39], v224, s[4:7], s17 offen offset:192
    v_mfma_f32_16x16x32_bf16 v[72:75], a[224:227], a[136:139], v[72:75]
    ds_read_b64_tr_b16 a[220:221], v92 offset:13312
    ds_read_b64_tr_b16 a[222:223], v92 offset:19456
    v_mfma_f32_16x16x32_bf16 v[0:3], a[224:227], a[160:163], v[0:3]
    ds_read_b64_tr_b16 a[224:225], v92 offset:25600
    v_max3_u32 v246, v246, v150, v151
    v_mfma_f32_16x16x32_bf16 v[4:7], a[228:231], a[160:163], v[4:7]
    ds_read_b64_tr_b16 a[226:227], v92 offset:31744
    v_max3_u32 v246, v246, v152, v153
    v_mfma_f32_16x16x32_bf16 v[64:67], a[232:235], a[92:95], v[64:67]
    ds_read_b64_tr_b16 a[228:229], v92 offset:37888
    v_max3_u32 v246, v246, v154, v155
    v_mfma_f32_16x16x32_bf16 v[68:71], a[232:235], a[116:119], v[68:71]
    ds_read_b64_tr_b16 a[230:231], v92 offset:44032
    v_max3_u32 v246, v246, v156, v157
    v_mfma_f32_16x16x32_bf16 v[72:75], a[232:235], a[140:143], v[72:75]
    v_max3_u32 v246, v246, v158, v159
    v_max3_u32 v246, v246, v160, v161
    v_mfma_f32_16x16x32_bf16 v[0:3], a[232:235], a[164:167], v[0:3]
    ds_read_b64_tr_b16 a[232:233], v92 offset:50176
    v_cvt_pk_bf16_f32 v64, v64, v65
    s_waitcnt lgkmcnt(15)
    v_mfma_f32_16x16x32_bf16 v[4:7], a[236:239], a[164:167], v[4:7]
    ds_read_b64_tr_b16 a[234:235], v92 offset:56320
    v_cvt_pk_bf16_f32 v65, v66, v67
    v_max3_u32 v246, v246, v162, v163
    v_max3_u32 v246, v246, v164, v165
    v_cvt_pk_bf16_f32 v72, v72, v73
    v_cvt_pk_bf16_f32 v73, v74, v75
    v_max3_u32 v246, v246, v166, v167
    v_max3_u32 v246, v246, v168, v169
    v_cvt_pk_bf16_f32 v0, v0, v1
    v_cvt_pk_bf16_f32 v1, v2, v3
    v_max3_u32 v246, v246, v170, v171
    v_max3_u32 v246, v246, v172, v173
    v_cvt_pk_bf16_f32 v4, v4, v5
    v_cvt_pk_bf16_f32 v5, v6, v7
    v_max3_u32 v246, v246, v174, v175
    v_max3_u32 v246, v246, v176, v177
    v_max3_u32 v246, v246, v178, v179
    v_max3_u32 v246, v246, v180, v181
    v_max3_u32 v246, v246, v182, v183
    v_max3_u32 v246, v246, v184, v185
    v_max3_u32 v246, v246, v186, v187
    v_max3_u32 v246, v246, v188, v189
    v_max3_u32 v246, v246, v190, v191
    v_max3_u32 v246, v246, v192, v193
    v_max3_u32 v246, v246, v194, v195
    v_cmp_eq_u32 vcc, -1, v246
    s_nop 1
    s_cbranch_vccnz L_again
L_back1:
    buffer_load_dwordx4 a[56:59], v225, s[4:7], s17 offen offset:128
    ds_write_b64 v229, v[64:65] offset:17408
    v_mfma_f32_16x16x32_bf16 v[64:67], a[192:195], a[144:147], 0
    ds_write_b64 v222, v[72:73] offset:19464
    v_mfma_f32_16x16x32_bf16 v[64:67], a[196:199], a[148:151], v[64:67]
    ds_write2_b32 v228, v0, v1 offset0:0 offset1:4
    v_mfma_f32_16x16x32_bf16 v[64:67], a[200:203], a[152:155], v[64:67]
    ds_write2_b32 v228, v4, v5 offset0:16 offset1:20
    s_waitcnt lgkmcnt(6)
    v_mfma_f32_16x16x32_bf16 v[64:67], a[204:207], a[156:159], v[64:67]
    ds_read_b64_tr_b16 a[236:237], v92 offset:62464
    ds_read_b64_tr_b16 a[238:239], v93 offset:3072
    v_mfma_f32_16x16x32_bf16 v[64:67], a[208:211], a[160:163], v[64:67]
    ds_read_b64_tr_b16 a[192:193], v92 offset:2048
    ds_read_b64_tr_b16 a[194:195], v92 offset:8192
    v_mfma_f32_16x16x32_bf16 v[64:67], a[212:215], a[164:167], v[64:67]
    buffer_load_dwordx4 a[60:63], v225, s[4:7], s17 offen offset:192
    ds_read_b64_tr_b16 a[196:197], v92 offset:14336
    ds_read_b64_tr_b16 a[198:199], v92 offset:20480
    v_cvt_pk_bf16_f32 v34, v68, v69
    v_cvt_pk_bf16_f32 v35, v70, v71
    v_mfma_f32_16x16x32_bf16 v[68:71], a[216:219], a[144:147], 0
    ds_read_b64_tr_b16 a[200:201], v92 offset:26624
    ds_read_b64_tr_b16 a[202:203], v92 offset:32768
    v_mfma_f32_16x16x32_bf16 v[68:71], a[220:223], a[148:151], v[68:71]
    ds_read_b64_tr_b16 a[204:205], v92 offset:38912
    v_cvt_pk_bf16_f32 v64, v64, v65
    v_mfma_f32_16x16x32_bf16 v[68:71], a[224:227], a[152:155], v[68:71]
    ds_read_b64_tr_b16 a[206:207], v92 offset:45056
    s_waitcnt lgkmcnt(10)
    v_mfma_f32_16x16x32_bf16 v[68:71], a[228:231], a[156:159], v[68:71]
    s_barrier
    s_mov_b64 exec, s[60:61]
    ds_read_b128 a[176:179], v97 offset:20992
    s_mov_b64 exec, -1
    s_mov_b64 exec, s[62:63]
    ds_read_b128 a[188:191], v97 offset:21136
    s_mov_b64 exec, -1
    v_mfma_f32_16x16x32_bf16 v[68:71], a[232:235], a[160:163], v[68:71]
    ds_read_b64 v[32:33], v229 offset:18944
    v_cvt_pk_bf16_f32 v65, v66, v67
    ds_write2_b32 v94, v64, v65 offset0:0 offset1:4
    ds_read_b128 v[36:39], v222 offset:17920
    ds_read_b64_tr_b16 a[208:209], v92 offset:51200
    ds_read_b64_tr_b16 a[210:211], v92 offset:57344
    ds_read_b64_tr_b16 a[212:213], v92 offset:63488
    ds_read_b64_tr_b16 a[214:215], v93 offset:4096
    v_cvt_pk_bf16_f32 v42, v80, v81
    v_cvt_pk_bf16_f32 v43, v82, v83
    v_mov_b32 v139, 0
    s_waitcnt lgkmcnt(15)
    v_mfma_f32_16x16x32_bf16 v[68:71], a[236:239], a[164:167], v[68:71]
    ds_read_b64_tr_b16 a[216:217], v92 offset:3072
    ds_read_b64_tr_b16 a[218:219], v92 offset:9216
    v_mfma_f32_16x16x32_bf16 v[16:19], a[80:83], v[40:43], v[16:19]
    ds_read_b64_tr_b16 a[220:221], v92 offset:15360
    ds_read_b64_tr_b16 a[222:223], v92 offset:21504
    v_mfma_f32_16x16x32_bf16 v[20:23], a[104:107], v[40:43], v[20:23]
    ds_read_b64_tr_b16 a[224:225], v92 offset:27648
    ds_read_b64_tr_b16 a[226:227], v92 offset:33792
    v_mfma_f32_16x16x32_bf16 v[24:27], a[128:131], v[40:43], v[24:27]
    ds_read_b64_tr_b16 a[228:229], v92 offset:39936
    v_cvt_pk_bf16_f32 v68, v68, v69
    v_mfma_f32_16x16x32_bf16 v[28:31], a[152:155], v[40:43], v[28:31]
    ds_read_b64_tr_b16 a[230:231], v92 offset:46080
    v_cvt_pk_bf16_f32 v69, v70, v71
    v_mfma_f32_16x16x32_bf16 v[72:75], a[192:195], a[144:147], 0
    ds_write2_b32 v94, v68, v69 offset0:16 offset1:20
    s_waitcnt lgkmcnt(15)
    v_mfma_f32_16x16x32_bf16 v[72:75], a[196:199], a[148:151], v[72:75]
    buffer_load_dwordx4 a[16:19], v223, s[4:7], s17 offen offset:256
    v_mfma_f32_16x16x32_bf16 v[72:75], a[200:203], a[152:155], v[72:75]
    ds_read_b64_tr_b16 a[232:233], v92 offset:52224
    ds_read_b64_tr_b16 a[234:235], v92 offset:58368
    v_mfma_f32_16x16x32_bf16 v[72:75], a[204:207], a[156:159], v[72:75]
    buffer_load_dwordx4 a[20:23], v223, s[4:7], s17 offen offset:320
    ds_read_b64_tr_b16 a[236:237], v92 offset:64512
    ds_read_b64_tr_b16 a[238:239], v93 offset:5120
    ds_read_b64_tr_b16 a[192:193], v92 offset:4096
    ds_read_b64_tr_b16 a[194:195], v92 offset:10240
    s_waitcnt lgkmcnt(15)
    v_mfma_f32_16x16x32_bf16 v[72:75], a[208:211], a[160:163], v[72:75]
    ds_read_b64_tr_b16 a[196:197], v92 offset:16384
    ds_read_b64_tr_b16 a[198:199], v92 offset:22528
    v_mfma_f32_16x16x32_bf16 v[72:75], a[212:215], a[164:167], v[72:75]
    ds_read_b64_tr_b16 a[200:201], v92 offset:28672
    ds_read_b64_tr_b16 a[202:203], v92 offset:34816
    v_mfma_f32_16x16x32_bf16 v[16:19], a[84:87], v[44:47], v[16:19]
    ds_read_b64_tr_b16 a[204:205], v92 offset:40960
    ds_read_b64_tr_b16 a[206:207], v92 offset:47104
    v_mfma_f32_16x16x32_bf16 v[20:23], a[108:111], v[44:47], v[20:23]
    ds_read_b64_tr_b16 a[208:209], v92 offset:53248
    ds_read_b64_tr_b16 a[210:211], v92 offset:59392
    v_mfma_f32_16x16x32_bf16 v[24:27], a[132:135], v[44:47], v[24:27]
    ds_read_b64_tr_b16 a[212:213], v93 offset:0
    v_cvt_pk_bf16_f32 v72, v72, v73
    v_mfma_f32_16x16x32_bf16 v[28:31], a[156:159], v[44:47], v[28:31]
    ds_read_b64_tr_b16 a[214:215], v93 offset:6144
    v_cvt_pk_bf16_f32 v73, v74, v75
    s_waitcnt lgkmcnt(15)
    v_mfma_f32_16x16x32_bf16 v[76:79], a[216:219], a[144:147], 0
    ds_write2_b32 v94, v72, v73 offset0:32 offset1:36
    v_mfma_f32_16x16x32_bf16 v[76:79], a[220:223], a[148:151], v[76:79]
    buffer_load_dwordx4 a[40:43], v224, s[4:7], s17 offen offset:256
    v_mfma_f32_16x16x32_bf16 v[76:79], a[224:227], a[152:155], v[76:79]
    buffer_load_dwordx4 a[44:47], v224, s[4:7], s17 offen offset:320
    v_mfma_f32_16x16x32_bf16 v[76:79], a[228:231], a[156:159], v[76:79]
    ds_read_b64_tr_b16 a[216:217], v92 offset:5120
    ds_read_b64_tr_b16 a[218:219], v92 offset:11264
    s_waitcnt lgkmcnt(15)
    v_mfma_f32_16x16x32_bf16 v[76:79], a[232:235], a[160:163], v[76:79]
    ds_read_b64_tr_b16 a[220:221], v92 offset:17408
    ds_read_b64_tr_b16 a[222:223], v92 offset:23552
    v_mfma_f32_16x16x32_bf16 v[76:79], a[236:239], a[164:167], v[76:79]
    ds_read_b64_tr_b16 a[224:225], v92 offset:29696
    ds_read_b64_tr_b16 a[226:227], v92 offset:35840
    s_waitcnt lgkmcnt(15)
    v_mfma_f32_16x16x32_bf16 v[80:83], a[192:195], a[144:147], 0
    ds_read_b64_tr_b16 a[228:229], v92 offset:41984
    ds_read_b64_tr_b16 a[230:231], v92 offset:48128
    v_mfma_f32_16x16x32_bf16 v[80:83], a[196:199], a[148:151], v[80:83]
    ds_read_b64_tr_b16 a[232:233], v92 offset:54272
    ds_read_b64_tr_b16 a[234:235], v92 offset:60416
    s_waitcnt lgkmcnt(15)
    v_mfma_f32_16x16x32_bf16 v[80:83], a[200:203], a[152:155], v[80:83]
    ds_read_b64_tr_b16 a[236:237], v93 offset:1024
    v_cvt_pk_bf16_f32 v76, v76, v77
    v_mfma_f32_16x16x32_bf16 v[80:83], a[204:207], a[156:159], v[80:83]
    ds_read_b64_tr_b16 a[238:239], v93 offset:7168
    v_cvt_pk_bf16_f32 v77, v78, v79
    s_waitcnt lgkmcnt(15)
    v_mfma_f32_16x16x32_bf16 v[80:83], a[208:211], a[160:163], v[80:83]
    ds_write2_b32 v94, v76, v77 offset0:48 offset1:52
    s_waitcnt lgkmcnt(14)
    v_mfma_f32_16x16x32_bf16 v[80:83], a[212:215], a[164:167], v[80:83]
    ds_read_b128 a[192:195], v221 offset:14336
    ds_read_b128 a[196:199], v221 offset:26624
    v_mfma_f32_16x16x32_bf16 v[16:19], a[88:91], v[32:35], v[16:19]
    ds_read_b128 a[200:203], v221 offset:15360
    ds_read_b128 a[204:207], v221 offset:27648
    v_mfma_f32_16x16x32_bf16 v[20:23], a[112:115], v[32:35], v[20:23]
    ds_read_b128 a[208:211], v221 offset:16384
    ds_read_b128 a[212:215], v221 offset:28672
    v_mfma_f32_16x16x32_bf16 v[24:27], a[136:139], v[32:35], v[24:27]
    buffer_load_dwordx4 a[64:67], v225, s[4:7], s17 offen offset:256
    v_mfma_f32_16x16x32_bf16 v[28:31], a[160:163], v[32:35], v[28:31]
    buffer_load_dwordx4 a[68:71], v225, s[4:7], s17 offen offset:320
    v_mfma_f32_16x16x32_bf16 v[16:19], a[92:95], v[36:39], v[16:19]
    v_cvt_pk_bf16_f32 v80, v80, v81
    v_cvt_pk_bf16_f32 v81, v82, v83
    v_mfma_f32_16x16x32_bf16 v[20:23], a[116:119], v[36:39], v[20:23]
    ds_write2_b32 v94, v80, v81 offset0:64 offset1:68
    v_mfma_f32_16x16x32_bf16 v[24:27], a[140:143], v[36:39], v[24:27]
    v_mov_b32 v147, 0
    v_mov_b32 v155, 0
    v_mfma_f32_16x16x32_bf16 v[28:31], a[164:167], v[36:39], v[28:31]
    v_max3_f32 v250, v16, v17, v18
    v_mov_b32 v228, 0x4444
    s_waitcnt lgkmcnt(14)
    v_mfma_f32_16x16x32_bf16 v[84:87], a[216:219], a[144:147], 0
    ds_read_b128 a[216:219], v221 offset:17408
    v_max3_f32 v251, v19, v20, v21
    v_mfma_f32_16x16x32_bf16 v[84:87], a[220:223], a[148:151], v[84:87]
    ds_read_b128 a[220:223], v221 offset:29696
    v_max3_f32 v250, v250, v22, v23
    v_mfma_f32_16x16x32_bf16 v[84:87], a[224:227], a[152:155], v[84:87]
    ds_read_b128 a[224:227], v221 offset:18432
    v_cndmask_b32 v28, v244, v28, s[48:49]
    s_waitcnt lgkmcnt(12)
    v_mfma_f32_16x16x32_bf16 v[84:87], a[228:231], a[156:159], v[84:87]
    ds_read_b128 a[228:231], v221 offset:30720
    v_cndmask_b32 v28, v28, v29, s[50:51]
    v_mfma_f32_16x16x32_bf16 v[84:87], a[232:235], a[160:163], v[84:87]
    ds_read_b128 a[232:235], v221 offset:19456
    v_max3_f32 v251, v251, v24, v25
    s_waitcnt lgkmcnt(12)
    v_mfma_f32_16x16x32_bf16 v[84:87], a[236:239], a[164:167], v[84:87]
    ds_read_b128 a[236:239], v221 offset:31744
    v_max3_f32 v250, v250, v26, v27
    s_waitcnt lgkmcnt(11)
    v_mfma_f32_16x16x32_bf16 v[64:67], a[72:75], a[192:195], 0
    v_max3_f32 v250, v250, v251, v28
    v_mov_b32 v251, v250
    v_mfma_f32_16x16x32_bf16 v[68:71], a[96:99], a[192:195], 0
    v_cndmask_b32 v228, v228, v96, s[66:67]
    v_mov_b32 v163, 0
    v_mfma_f32_16x16x32_bf16 v[72:75], a[120:123], a[192:195], 0
    v_cvt_pk_bf16_f32 v84, v84, v85
    v_cvt_pk_bf16_f32 v85, v86, v87
    v_mfma_f32_16x16x32_bf16 v[0:3], a[144:147], a[192:195], 0
    ds_write2_b32 v94, v84, v85 offset0:80 offset1:84
    v_mfma_f32_16x16x32_bf16 v[4:7], a[144:147], a[196:199], 0
    ds_read_b128 a[192:195], v221 offset:38912
    ds_read_b128 a[196:199], v221 offset:51200
    s_waitcnt lgkmcnt(10)
    v_mfma_f32_16x16x32_bf16 v[64:67], a[76:79], a[200:203], v[64:67]
    v_permlane32_swap_b32 v250, v251
    v_mfma_f32_16x16x32_bf16 v[68:71], a[100:103], a[200:203], v[68:71]
    v_max_f32 v250, v250, v251
    v_mov_b32 v251, v250
    v_mfma_f32_16x16x32_bf16 v[72:75], a[124:127], a[200:203], v[72:75]
    v_mov_b32 v171, 0
    v_mov_b32 v179, 0
    v_mfma_f32_16x16x32_bf16 v[0:3], a[148:151], a[200:203], v[0:3]
    ds_read_b128 a[200:203], v221 offset:39936
    v_mov_b32 v187, 0
    v_mfma_f32_16x16x32_bf16 v[4:7], a[148:151], a[204:207], v[4:7]
    ds_read_b128 a[204:207], v221 offset:52224
    v_mov_b32 v195, 0
    v_mfma_f32_16x16x32_bf16 v[64:67], a[80:83], a[208:211], v[64:67]
    s_waitcnt lgkmcnt(4)
    v_mfma_f32_16x16x32_bf16 v[68:71], a[104:107], a[208:211], v[68:71]
    s_barrier
    s_mov_b64 exec, s[56:57]
    ds_read_b128 a[168:171], v95 offset:24576
    s_mov_b64 exec, -1
    s_mov_b64 exec, s[58:59]
    ds_read_b128 a[180:183], v95 offset:24976
    s_mov_b64 exec, -1
    v_mfma_f32_16x16x32_bf16 v[72:75], a[128:131], a[208:211], v[72:75]
    s_mov_b64 exec, s[56:57]
    ds_read_b128 a[172:175], v95 offset:24704
    s_mov_b64 exec, -1
    s_mov_b64 exec, s[58:59]
    ds_read_b128 a[184:187], v95 offset:25104
    s_mov_b64 exec, -1
    v_mfma_f32_16x16x32_bf16 v[0:3], a[152:155], a[208:211], v[0:3]
    s_mov_b64 exec, s[56:57]
    ds_read_b128 a[176:179], v95 offset:24832
    s_mov_b64 exec, -1
    s_mov_b64 exec, s[58:59]
    ds_read_b128 a[188:191], v95 offset:25232
    s_mov_b64 exec, -1
    v_mfma_f32_16x16x32_bf16 v[4:7], a[152:155], a[212:215], v[4:7]
    ds_read_b128 a[208:211], v221 offset:40960
    ds_read_b128 a[212:215], v221 offset:53248
    v_mfma_f32_16x16x32_bf16 v[64:67], a[84:87], a[216:219], v[64:67]
    v_permlane16_swap_b32 v250, v251
    v_mfma_f32_16x16x32_bf16 v[68:71], a[108:111], a[216:219], v[68:71]
    v_max_f32 v250, v250, v251
    v_sub_f32 v16, v16, v250
    v_mfma_f32_16x16x32_bf16 v[72:75], a[132:135], a[216:219], v[72:75]
    v_sub_f32 v17, v17, v250
    v_sub_f32 v18, v18, v250
    v_mfma_f32_16x16x32_bf16 v[0:3], a[156:159], a[216:219], v[0:3]
    ds_read_b128 a[216:219], v221 offset:41984
    v_sub_f32 v19, v19, v250
    v_mfma_f32_16x16x32_bf16 v[4:7], a[156:159], a[220:223], v[4:7]
    ds_read_b128 a[220:223], v221 offset:54272
    v_sub_f32 v20, v20, v250
    v_mfma_f32_16x16x32_bf16 v[64:67], a[88:91], a[224:227], v[64:67]
    v_exp_f32 v16, v16
    v_mfma_f32_16x16x32_bf16 v[68:71], a[112:115], a[224:227], v[68:71]
    v_exp_f32 v17, v17
    v_mfma_f32_16x16x32_bf16 v[72:75], a[136:139], a[224:227], v[72:75]
    v_exp_f32 v18, v18
    v_mfma_f32_16x16x32_bf16 v[0:3], a[160:163], a[224:227], v[0:3]
    ds_read_b128 a[224:227], v221 offset:43008
    v_sub_f32 v21, v21, v250
    v_mfma_f32_16x16x32_bf16 v[4:7], a[160:163], a[228:231], v[4:7]
    ds_read_b128 a[228:231], v221 offset:55296
    v_sub_f32 v22, v22, v250
    v_mfma_f32_16x16x32_bf16 v[64:67], a[92:95], a[232:235], v[64:67]
    v_exp_f32 v19, v19
    v_mfma_f32_16x16x32_bf16 v[68:71], a[116:119], a[232:235], v[68:71]
    v_exp_f32 v20, v20
    v_mfma_f32_16x16x32_bf16 v[72:75], a[140:143], a[232:235], v[72:75]
    v_exp_f32 v21, v21
    v_mfma_f32_16x16x32_bf16 v[0:3], a[164:167], a[232:235], v[0:3]
    ds_read_b128 a[232:235], v221 offset:44032
    v_sub_f32 v23, v23, v250
    v_mfma_f32_16x16x32_bf16 v[4:7], a[164:167], a[236:239], v[4:7]
    ds_read_b128 a[236:239], v221 offset:56320
    v_cvt_pk_bf16_f32 v132, v64, v65
    s_waitcnt lgkmcnt(6)
    v_mfma_f32_16x16x32_bf16 v[76:79], a[72:75], a[192:195], 0
    v_cvt_pk_bf16_f32 v133, v66, v67
    v_cvt_pk_bf16_f32 v134, v68, v69
    v_mfma_f32_16x16x32_bf16 v[80:83], a[96:99], a[192:195], 0
    v_cvt_pk_bf16_f32 v135, v70, v71
    v_cvt_pk_bf16_f32 v136, v72, v73
    v_mfma_f32_16x16x32_bf16 v[84:87], a[120:123], a[192:195], 0
    ds_write_b128 v222, v[132:135] offset:17408
    v_mfma_f32_16x16x32_bf16 v[8:11], a[144:147], a[192:195], 0
    ds_read_b128 a[192:195], v221 offset:63488
    v_cvt_pk_bf16_f32 v137, v74, v75
    v_mfma_f32_16x16x32_bf16 v[12:15], a[144:147], a[196:199], 0
    ds_write_b64 v229, v[136:137] offset:20992
    v_mfma_f32_16x16x32_bf16 v[76:79], a[76:79], a[200:203], v[76:79]
    ds_read_b128 a[196:199], v222 offset:10240
    v_cvt_pk_bf16_f32 v2, v2, v3
    v_mfma_f32_16x16x32_bf16 v[80:83], a[100:103], a[200:203], v[80:83]
    ds_write_b32 v230, v2 offset:23040
    v_mfma_f32_16x16x32_bf16 v[84:87], a[124:127], a[200:203], v[84:87]
    v_cvt_pk_bf16_f32 v6, v6, v7
    v_cvt_pk_bf16_f32 v138, v0, v1
    v_mfma_f32_16x16x32_bf16 v[8:11], a[148:151], a[200:203], v[8:11]
    ds_write_b32 v230, v6 offset:23296
    v_mfma_f32_16x16x32_bf16 v[12:15], a[148:151], a[204:207], v[12:15]
    ds_read_b128 a[200:203], v221 offset:64512
    ds_read_b128 a[204:207], v222 offset:11264
    v_mfma_f32_16x16x32_bf16 v[76:79], a[80:83], a[208:211], v[76:79]
    v_cvt_pk_bf16_f32 v154, v4, v5
L_pad8:
    s_cbranch_execz L_pad13
    v_sub_f32 v24, v24, v250
    v_mfma_f32_16x16x32_bf16 v[80:83], a[104:107], a[208:211], v[80:83]
    v_exp_f32 v22, v22
    v_mfma_f32_16x16x32_bf16 v[84:87], a[128:131], a[208:211], v[84:87]
    v_add_f32 v252, v16, v17
    v_sub_f32 v25, v25, v250
    v_mfma_f32_16x16x32_bf16 v[8:11], a[152:155], a[208:211], v[8:11]
    ds_read_b128 a[208:211], v222 offset:0
    v_sub_f32 v26, v26, v250
    v_mfma_f32_16x16x32_bf16 v[12:15], a[152:155], a[212:215], v[12:15]
    ds_read_b128 a[212:215], v222 offset:12288
    v_add_f32 v253, v18, v19
    s_waitcnt lgkmcnt(10)
    v_mfma_f32_16x16x32_bf16 v[76:79], a[84:87], a[216:219], v[76:79]
    s_waitcnt lgkmcnt(4)
    v_mfma_f32_16x16x32_bf16 v[80:83], a[108:111], a[216:219], v[80:83]
    s_barrier
    ds_read_b128 v[124:127], v222 offset:16384
    ds_read_b64 v[128:129], v229 offset:20480
    v_mfma_f32_16x16x32_bf16 v[84:87], a[132:135], a[216:219], v[84:87]
    ds_read_b32 v130, v230 offset:22528
    v_add_f32 v252, v252, v20
    v_mfma_f32_16x16x32_bf16 v[8:11], a[156:159], a[216:219], v[8:11]
    ds_read_b128 v[140:143], v222 offset:18432
    v_sub_f32 v27, v27, v250
    v_mfma_f32_16x16x32_bf16 v[12:15], a[156:159], a[220:223], v[12:15]
    ds_read_b64 v[144:145], v229 offset:21504
    v_sub_f32 v28, v28, v250
    v_mfma_f32_16x16x32_bf16 v[76:79], a[88:91], a[224:227], v[76:79]
    ds_read_b32 v146, v230 offset:22784
    v_add_f32 v253, v253, v21
    v_mfma_f32_16x16x32_bf16 v[80:83], a[112:115], a[224:227], v[80:83]
    ds_read_b128 v[148:151], v222 offset:19456
    v_add_f32 v252, v252, v22
    v_mfma_f32_16x16x32_bf16 v[84:87], a[136:139], a[224:227], v[84:87]
    ds_read_b64 v[152:153], v229 offset:22016
    ds_read_b128 a[216:219], v222 offset:1024
    v_mfma_f32_16x16x32_bf16 v[8:11], a[160:163], a[224:227], v[8:11]
    ds_read_b128 a[220:223], v222 offset:13312
    ds_read_b128 a[224:227], v222 offset:2048
    v_mfma_f32_16x16x32_bf16 v[12:15], a[160:163], a[228:231], v[12:15]
    ds_read_b128 a[228:231], v222 offset:14336
    v_mov_b32 v92, 0
    v_mfma_f32_16x16x32_bf16 v[76:79], a[92:95], a[232:235], v[76:79]
    v_exp_f32 v23, v23
    v_mfma_f32_16x16x32_bf16 v[80:83], a[116:119], a[232:235], v[80:83]
    v_exp_f32 v24, v24
    v_mfma_f32_16x16x32_bf16 v[84:87], a[140:143], a[232:235], v[84:87]
    v_exp_f32 v25, v25
    v_mfma_f32_16x16x32_bf16 v[8:11], a[164:167], a[232:235], v[8:11]
    ds_read_b128 a[232:235], v222 offset:3072
    v_add_f32 v253, v253, v23
    v_mfma_f32_16x16x32_bf16 v[12:15], a[164:167], a[236:239], v[12:15]
    ds_read_b128 a[236:239], v222 offset:15360
    v_add_f32 v252, v252, v24
    v_mfma_f32_16x16x32_bf16 v[64:67], a[72:75], a[192:195], 0
    v_exp_f32 v26, v26
    v_mfma_f32_16x16x32_bf16 v[68:71], a[96:99], a[192:195], 0
    v_exp_f32 v27, v27
    v_mfma_f32_16x16x32_bf16 v[72:75], a[120:123], a[192:195], 0
    v_exp_f32 v28, v28
    v_mfma_f32_16x16x32_bf16 v[0:3], a[144:147], a[192:195], 0
    ds_read_b128 a[192:195], v220 offset:0
    v_add_f32 v253, v253, v25
    v_mfma_f32_16x16x32_bf16 v[4:7], a[144:147], a[196:199], 0
    ds_read_b128 a[196:199], v220 offset:1024
    v_add_f32 v252, v252, v26
    s_waitcnt lgkmcnt(10)
    v_mfma_f32_16x16x32_bf16 v[64:67], a[76:79], a[200:203], v[64:67]
    v_add_f32 v253, v253, v27
    v_add_f32 v252, v252, v28
    v_mfma_f32_16x16x32_bf16 v[68:71], a[100:103], a[200:203], v[68:71]
    v_add_f32 v252, v252, v253
    v_mov_b32 v253, v252
    v_mfma_f32_16x16x32_bf16 v[72:75], a[124:127], a[200:203], v[72:75]
    v_cvt_pk_bf16_f32 v164, v76, v77
    v_cvt_pk_bf16_f32 v165, v78, v79
    v_mfma_f32_16x16x32_bf16 v[0:3], a[148:151], a[200:203], v[0:3]
    ds_read_b128 a[200:203], v220 offset:2048
    v_cvt_pk_bf16_f32 v166, v80, v81
    v_mfma_f32_16x16x32_bf16 v[4:7], a[148:151], a[204:207], v[4:7]
    ds_read_b128 a[204:207], v220 offset:3072
    v_permlane32_swap_b32 v252, v253
    v_add_f32 v252, v252, v253
    v_mov_b32 v253, v252
    v_cvt_pk_bf16_f32 v167, v82, v83
    v_cvt_pk_bf16_f32 v168, v84, v85
    v_permlane16_swap_b32 v252, v253
    v_add_f32 v252, v252, v253
    v_rcp_f32 v254, v252
    v_cvt_pk_bf16_f32 v169, v86, v87
    v_mul_f32 v16, v16, v254
    v_mul_f32 v17, v17, v254
    v_cvt_pk_bf16_f32 v16, v16, v17
    v_mul_f32 v18, v18, v254
    v_mul_f32 v19, v19, v254
    v_cvt_pk_bf16_f32 v17, v18, v19
    v_mul_f32 v20, v20, v254
    v_mul_f32 v21, v21, v254
    v_mul_f32 v22, v22, v254
    v_mul_f32 v23, v23, v254
    v_cvt_pk_bf16_f32 v18, v20, v21
    v_cvt_pk_bf16_f32 v19, v22, v23
    v_mul_f32 v28, v28, v254
    v_mul_f32 v24, v24, v254
    v_mfma_f32_16x16x32_bf16 v[48:51], v[16:19], v[124:127], 0
    ds_write_b128 v222, v[164:167] offset:25600
    v_mul_f32 v25, v25, v254
    v_mul_f32 v26, v26, v254
    v_mul_f32 v27, v27, v254
    v_cvt_pk_bf16_f32 v22, v28, 0
    v_cvt_pk_bf16_f32 v20, v24, v25
    v_cvt_pk_bf16_f32 v21, v26, v27
    v_lshlrev_b32 v22, s54, v22
    v_mov_b32 v23, 0
    s_nop 0
    s_nop 0
    v_mfma_f32_16x16x32_bf16 v[48:51], v[20:23], v[128:131], v[48:51]
    ds_write_b64 v229, v[168:169] offset:29184
    v_mfma_f32_16x16x32_bf16 v[52:55], v[16:19], v[132:135], 0
    v_cvt_pk_bf16_f32 v10, v10, v11
    v_cvt_pk_bf16_f32 v14, v14, v15
    v_mfma_f32_16x16x32_bf16 v[52:55], v[20:23], v[136:139], v[52:55]
    ds_write_b32 v230, v10 offset:31232
    v_mfma_f32_16x16x32_bf16 v[64:67], a[80:83], a[208:211], v[64:67]
    ds_write_b32 v230, v14 offset:31488
    v_mfma_f32_16x16x32_bf16 v[68:71], a[104:107], a[208:211], v[68:71]
    v_mov_b32 v10, 0
    v_mov_b32 v11, 0
    v_mfma_f32_16x16x32_bf16 v[72:75], a[128:131], a[208:211], v[72:75]
    v_cvt_pk_bf16_f32 v170, v8, v9
    v_mov_b32 v14, 0
    v_mfma_f32_16x16x32_bf16 v[0:3], a[152:155], a[208:211], v[0:3]
    ds_read_b128 a[208:211], v220 offset:4096
    v_mov_b32 v15, 0
    v_mfma_f32_16x16x32_bf16 v[4:7], a[152:155], a[212:215], v[4:7]
    ds_read_b128 a[212:215], v220 offset:5120
    v_cvt_pk_bf16_f32 v186, v12, v13
    v_mfma_f32_16x16x32_bf16 v[56:59], v[16:19], v[140:143], 0
    v_cvt_pk_bf16_f32 v100, v48, v52
    v_cvt_pk_bf16_f32 v102, v49, v53
    v_mfma_f32_16x16x32_bf16 v[56:59], v[20:23], v[144:147], v[56:59]
    v_cvt_pk_bf16_f32 v104, v50, v54
    v_cvt_pk_bf16_f32 v106, v51, v55
    s_waitcnt lgkmcnt(5)
    v_mfma_f32_16x16x32_bf16 v[60:63], v[16:19], v[148:151], 0
    s_waitcnt lgkmcnt(2)
    v_mfma_f32_16x16x32_bf16 v[60:63], v[20:23], v[152:155], v[60:63]
    s_barrier
    ds_read_b128 v[156:159], v222 offset:24576
    ds_read_b64 v[160:161], v229 offset:28672
    v_mfma_f32_16x16x32_bf16 v[64:67], a[84:87], a[216:219], v[64:67]
    ds_read_b32 v162, v230 offset:30720
    ds_read_b128 v[172:175], v222 offset:26624
    v_mfma_f32_16x16x32_bf16 v[68:71], a[108:111], a[216:219], v[68:71]
    ds_read_b64 v[176:177], v229 offset:29696
    ds_read_b32 v178, v230 offset:30976
    v_mfma_f32_16x16x32_bf16 v[72:75], a[132:135], a[216:219], v[72:75]
    ds_read_b128 v[180:183], v222 offset:27648
    ds_read_b64 v[184:185], v229 offset:30208
    v_mfma_f32_16x16x32_bf16 v[0:3], a[156:159], a[216:219], v[0:3]
    ds_read_b128 a[216:219], v220 offset:6144
    v_cvt_pk_bf16_f32 v101, v56, v60
    v_mfma_f32_16x16x32_bf16 v[4:7], a[156:159], a[220:223], v[4:7]
    ds_read_b128 a[220:223], v220 offset:7168
    v_cvt_pk_bf16_f32 v103, v57, v61
    v_mfma_f32_16x16x32_bf16 v[64:67], a[88:91], a[224:227], v[64:67]
    buffer_store_dwordx2 v[100:101], v233, s[8:11], s24 offen offset:0 sc0 sc1
    v_cvt_pk_bf16_f32 v105, v58, v62
    v_mfma_f32_16x16x32_bf16 v[68:71], a[112:115], a[224:227], v[68:71]
    v_cvt_pk_bf16_f32 v107, v59, v63
    v_mov_b32 v93, 0
    v_mfma_f32_16x16x32_bf16 v[72:75], a[136:139], a[224:227], v[72:75]
    v_mfma_f32_16x16x32_bf16 v[0:3], a[160:163], a[224:227], v[0:3]
    buffer_store_dwordx2 v[102:103], v233, s[8:11], s25 offen offset:0 sc0 sc1
    ds_read_b128 a[224:227], v220 offset:8192
    v_mfma_f32_16x16x32_bf16 v[4:7], a[160:163], a[228:231], v[4:7]
    ds_read_b128 a[228:231], v220 offset:9216
    v_mfma_f32_16x16x32_bf16 v[64:67], a[92:95], a[232:235], v[64:67]
    v_mfma_f32_16x16x32_bf16 v[68:71], a[116:119], a[232:235], v[68:71]
    buffer_store_dwordx2 v[104:105], v233, s[8:11], s26 offen offset:0 sc0 sc1
    v_mfma_f32_16x16x32_bf16 v[72:75], a[140:143], a[232:235], v[72:75]
    v_mfma_f32_16x16x32_bf16 v[0:3], a[164:167], a[232:235], v[0:3]
    ds_read_b128 a[232:235], v220 offset:10240
    v_mfma_f32_16x16x32_bf16 v[4:7], a[164:167], a[236:239], v[4:7]
    buffer_store_dwordx2 v[106:107], v235, s[8:11], s20 offen offset:1536 sc0 sc1
    ds_read_b128 a[236:239], v220 offset:11264
    v_smfmac_f32_16x16x64_bf16 v[8:11], a[168:171], a[144:151], v228
    v_cvt_pk_bf16_f32 v196, v64, v65
    v_cvt_pk_bf16_f32 v197, v66, v67
    v_smfmac_f32_16x16x64_bf16 v[8:11], a[172:175], a[152:159], v228
    v_cvt_pk_bf16_f32 v198, v68, v69
    v_cvt_pk_bf16_f32 v199, v70, v71
    v_smfmac_f32_16x16x64_bf16 v[8:11], a[176:179], a[160:167], v228
    ds_write_b128 v222, v[196:199] offset:17408
    v_smfmac_f32_16x16x64_bf16 v[12:15], a[180:183], a[144:151], v228
    v_cvt_pk_bf16_f32 v200, v72, v73
    v_cvt_pk_bf16_f32 v201, v74, v75
    v_smfmac_f32_16x16x64_bf16 v[12:15], a[184:187], a[152:159], v228
    ds_write_b64 v229, v[200:201] offset:20992
    v_smfmac_f32_16x16x64_bf16 v[12:15], a[188:191], a[160:167], v228
    v_cvt_pk_bf16_f32 v2, v2, v3
    v_cvt_pk_bf16_f32 v6, v6, v7
    s_waitcnt lgkmcnt(6)
    v_mfma_f32_16x16x32_bf16 v[48:51], v[16:19], v[156:159], 0
    ds_write_b32 v230, v2 offset:23040
    v_mfma_f32_16x16x32_bf16 v[48:51], v[20:23], v[160:163], v[48:51]
    ds_write_b32 v230, v6 offset:23296
    v_mfma_f32_16x16x32_bf16 v[52:55], v[16:19], v[164:167], 0
    v_cvt_pk_bf16_f32 v202, v0, v1
    v_cvt_pk_bf16_f32 v218, v4, v5
    v_mfma_f32_16x16x32_bf16 v[52:55], v[20:23], v[168:171], v[52:55]
    v_add_f32 v10, v10, v11
    v_add_f32 v14, v14, v15
    v_mfma_f32_16x16x32_bf16 v[56:59], v[16:19], v[172:175], 0
    v_cndmask_b32 v231, v10, v14, s[66:67]
    v_mfma_f32_16x16x32_bf16 v[56:59], v[20:23], v[176:179], v[56:59]
    v_mfma_f32_16x16x32_bf16 v[60:63], v[16:19], v[180:183], 0
    v_mfma_f32_16x16x32_bf16 v[60:63], v[20:23], v[184:187], v[60:63]
    s_waitcnt lgkmcnt(0)
    s_barrier
    ds_read_b128 v[188:191], v222 offset:16384
    ds_read_b64 v[192:193], v229 offset:20480
    ds_read_b32 v194, v230 offset:22528
    ds_read_b128 v[204:207], v222 offset:18432
    ds_read_b64 v[208:209], v229 offset:21504
    ds_read_b32 v210, v230 offset:22784
    ds_read_b128 v[212:215], v222 offset:19456
    ds_read_b64 v[216:217], v229 offset:22016
    v_cvt_pk_bf16_f32 v108, v48, v52
    v_cvt_pk_bf16_f32 v110, v49, v53
    v_cvt_pk_bf16_f32 v112, v50, v54
    v_cvt_pk_bf16_f32 v114, v51, v55
    v_cvt_pk_bf16_f32 v109, v56, v60
    v_cvt_pk_bf16_f32 v111, v57, v61
    v_cvt_pk_bf16_f32 v113, v58, v62
    v_cvt_pk_bf16_f32 v115, v59, v63
    buffer_store_dwordx2 v[108:109], v233, s[8:11], s24 offen offset:128 sc0 sc1
    buffer_store_dwordx2 v[110:111], v233, s[8:11], s25 offen offset:128 sc0 sc1
    buffer_store_dwordx2 v[112:113], v233, s[8:11], s26 offen offset:128 sc0 sc1
    ds_write_b64 v227, v[92:93] offset:0
    ds_write_b64 v227, v[92:93] offset:8
    s_waitcnt lgkmcnt(9)
    v_mfma_f32_16x16x32_bf16 v[48:51], v[16:19], v[188:191], 0
    buffer_store_dwordx2 v[114:115], v235, s[8:11], s20 offen offset:1664 sc0 sc1
    s_waitcnt lgkmcnt(7)
    v_mfma_f32_16x16x32_bf16 v[48:51], v[20:23], v[192:195], v[48:51]
    v_mfma_f32_16x16x32_bf16 v[52:55], v[16:19], v[196:199], 0
    v_mfma_f32_16x16x32_bf16 v[52:55], v[20:23], v[200:203], v[52:55]
    s_waitcnt lgkmcnt(2)
    v_mfma_f32_16x16x32_bf16 v[56:59], v[16:19], v[204:207], 0
    v_mfma_f32_16x16x32_bf16 v[56:59], v[20:23], v[208:211], v[56:59]
    v_mfma_f32_16x16x32_bf16 v[60:63], v[16:19], v[212:215], 0
    v_mfma_f32_16x16x32_bf16 v[60:63], v[20:23], v[216:219], v[60:63]
    s_nop 0
    s_nop 0
    s_nop 0
    s_nop 0
    v_cvt_pk_bf16_f32 v116, v48, v52
    v_cvt_pk_bf16_f32 v118, v49, v53
    v_cvt_pk_bf16_f32 v120, v50, v54
    v_cvt_pk_bf16_f32 v122, v51, v55
    v_cvt_pk_bf16_f32 v117, v56, v60
    v_cvt_pk_bf16_f32 v119, v57, v61
    v_cvt_pk_bf16_f32 v121, v58, v62
    v_cvt_pk_bf16_f32 v123, v59, v63
    buffer_store_dwordx2 v[116:117], v233, s[8:11], s24 offen offset:256 sc0 sc1
    buffer_store_dwordx2 v[118:119], v233, s[8:11], s25 offen offset:256 sc0 sc1
    buffer_store_dwordx2 v[120:121], v233, s[8:11], s26 offen offset:256 sc0 sc1
    buffer_store_dwordx2 v[122:123], v235, s[8:11], s20 offen offset:1792 sc0 sc1
    s_mov_b32 s10, 0
    s_waitcnt vmcnt(12) lgkmcnt(0)
    s_branch L_b0
.p2align 6
L_sh2:
L_pad2:
    s_cbranch_execz L_pad9
    s_waitcnt vmcnt(8) lgkmcnt(0)
    s_barrier
    v_accvgpr_read_b32 v97, a248
    v_accvgpr_read_b32 v94, a242
    v_accvgpr_read_b32 v95, a243
    v_accvgpr_read_b32 v92, a241
    v_mov_b32 v251, 0
    v_add_u32 v93, 0x10000, v92
    v_accvgpr_read_b32 v96, a246
    v_mov_b32 v96, 0xeeee
    v_mov_b32 v203, 0
    v_mov_b32 v211, 0
    v_mov_b32 v219, 0
    v_accvgpr_read_b32 v227, a245
    v_accvgpr_read_b32 v226, a244
    v_cndmask_b32 v240, v244, v232, s[40:41]
    v_cndmask_b32 v241, v244, v233, s[40:41]
    s_mov_b32 s18, s17
    buffer_load_dwordx4 v[156:159], v102, s[12:15], 0 offen offset:2048 sc1
    ds_read_b128 a[192:195], v220 offset:12288
    ds_read_b128 a[196:199], v220 offset:0
    ds_read_b128 a[200:203], v220 offset:13312
    ds_read_b128 a[204:207], v220 offset:1024
    ds_read_b128 a[208:211], v220 offset:14336
    ds_read_b128 a[212:215], v220 offset:2048
    ds_read_b128 a[216:219], v220 offset:15360
    buffer_load_dwordx4 v[160:163], v103, s[12:15], 0 offen offset:0 sc1
    s_waitcnt vmcnt(9)
    ds_write_b128 v100, v[124:127] offset:0
    ds_read_b128 a[220:223], v220 offset:3072
    ds_read_b128 a[224:227], v220 offset:16384
    buffer_load_dwordx4 v[164:167], v103, s[12:15], 0 offen offset:1024 sc1
    s_waitcnt vmcnt(9)
    ds_write_b128 v100, v[128:131] offset:1024
    ds_read_b128 a[228:231], v220 offset:4096
    buffer_load_dwordx4 v[168:171], v103, s[12:15], 0 offen offset:2048 sc1
    s_waitcnt lgkmcnt(11)
    v_mfma_f32_16x16x32_bf16 v[64:67], a[192:195], a[72:75], 0
    ds_read_b128 a[232:235], v220 offset:17408
    ds_read_b128 a[236:239], v220 offset:5120
    v_mfma_f32_16x16x32_bf16 v[68:71], a[192:195], a[96:99], 0
    v_mfma_f32_16x16x32_bf16 v[72:75], a[192:195], a[120:123], 0
    v_mfma_f32_16x16x32_bf16 v[0:3], a[192:195], a[144:147], 0
    ds_read_b128 a[192:195], v220 offset:36864
    s_waitcnt lgkmcnt(8)
    v_mfma_f32_16x16x32_bf16 v[4:7], a[196:199], a[144:147], 0
    ds_read_b128 a[196:199], v220 offset:24576
    v_mfma_f32_16x16x32_bf16 v[64:67], a[200:203], a[76:79], v[64:67]
    v_mfma_f32_16x16x32_bf16 v[68:71], a[200:203], a[100:103], v[68:71]
    v_max3_u32 v251, v251, v124, v125
    v_max3_u32 v251, v251, v126, v127
    v_mfma_f32_16x16x32_bf16 v[72:75], a[200:203], a[124:127], v[72:75]
    v_mfma_f32_16x16x32_bf16 v[0:3], a[200:203], a[148:151], v[0:3]
    ds_read_b128 a[200:203], v220 offset:37888
    v_mfma_f32_16x16x32_bf16 v[4:7], a[204:207], a[148:151], v[4:7]
    ds_read_b128 a[204:207], v220 offset:25600
    v_mfma_f32_16x16x32_bf16 v[64:67], a[208:211], a[80:83], v[64:67]
    v_max3_u32 v251, v251, v128, v129
    v_max3_u32 v251, v251, v130, v131
    v_mfma_f32_16x16x32_bf16 v[68:71], a[208:211], a[104:107], v[68:71]
    v_mov_b32 v131, 0
    v_mfma_f32_16x16x32_bf16 v[72:75], a[208:211], a[128:131], v[72:75]
    v_mfma_f32_16x16x32_bf16 v[0:3], a[208:211], a[152:155], v[0:3]
    ds_read_b128 a[208:211], v220 offset:38912
    v_mfma_f32_16x16x32_bf16 v[4:7], a[212:215], a[152:155], v[4:7]
    s_waitcnt vmcnt(9)
    ds_write_b128 v100, v[132:135] offset:2048
    v_mfma_f32_16x16x32_bf16 v[64:67], a[216:219], a[84:87], v[64:67]
    v_max3_u32 v251, v251, v132, v133
    v_max3_u32 v251, v251, v134, v135
    v_mfma_f32_16x16x32_bf16 v[68:71], a[216:219], a[108:111], v[68:71]
    ds_read_b128 a[212:215], v220 offset:26624
    v_mfma_f32_16x16x32_bf16 v[72:75], a[216:219], a[132:135], v[72:75]
    v_mfma_f32_16x16x32_bf16 v[0:3], a[216:219], a[156:159], v[0:3]
    s_waitcnt vmcnt(8)
    ds_write_b128 v101, v[136:139] offset:0
    s_waitcnt lgkmcnt(6)
    v_mfma_f32_16x16x32_bf16 v[4:7], a[220:223], a[156:159], v[4:7]
    v_max3_u32 v251, v251, v136, v137
    v_max3_u32 v251, v251, v138, v139
    v_mfma_f32_16x16x32_bf16 v[64:67], a[224:227], a[88:91], v[64:67]
    buffer_load_dwordx4 v[172:175], v104, s[12:15], 0 offen offset:0 sc1
    v_mfma_f32_16x16x32_bf16 v[68:71], a[224:227], a[112:115], v[68:71]
    ds_read_b128 a[216:219], v220 offset:39936
    ds_read_b128 a[220:223], v220 offset:27648
    v_mfma_f32_16x16x32_bf16 v[72:75], a[224:227], a[136:139], v[72:75]
    s_waitcnt vmcnt(8)
    ds_write_b128 v101, v[140:143] offset:1024
    v_mfma_f32_16x16x32_bf16 v[0:3], a[224:227], a[160:163], v[0:3]
    v_max3_u32 v251, v251, v140, v141
    v_max3_u32 v251, v251, v142, v143
    v_mfma_f32_16x16x32_bf16 v[4:7], a[228:231], a[160:163], v[4:7]
    buffer_load_dwordx4 v[176:179], v104, s[12:15], 0 offen offset:1024 sc1
    v_mfma_f32_16x16x32_bf16 v[64:67], a[232:235], a[92:95], v[64:67]
    ds_read_b128 a[224:227], v220 offset:40960
    ds_read_b128 a[228:231], v220 offset:28672
    v_mfma_f32_16x16x32_bf16 v[68:71], a[232:235], a[116:119], v[68:71]
    s_waitcnt vmcnt(8)
    ds_write_b128 v101, v[144:147] offset:2048
    v_mfma_f32_16x16x32_bf16 v[72:75], a[232:235], a[140:143], v[72:75]
    v_max3_u32 v251, v251, v144, v145
    v_max3_u32 v251, v251, v146, v147
    v_mfma_f32_16x16x32_bf16 v[0:3], a[232:235], a[164:167], v[0:3]
    buffer_load_dwordx4 v[180:183], v104, s[12:15], 0 offen offset:2048 sc1
    v_mfma_f32_16x16x32_bf16 v[4:7], a[236:239], a[164:167], v[4:7]
    ds_read_b128 a[232:235], v220 offset:41984
    v_cvt_pk_bf16_f32 v64, v64, v65
    v_mfma_f32_16x16x32_bf16 v[76:79], a[192:195], a[72:75], 0
    s_waitcnt vmcnt(8)
    ds_write_b128 v102, v[148:151] offset:0
    v_mfma_f32_16x16x32_bf16 v[80:83], a[192:195], a[96:99], 0
    v_cvt_pk_bf16_f32 v68, v68, v69
    v_cvt_pk_bf16_f32 v0, v0, v1
    v_mfma_f32_16x16x32_bf16 v[84:87], a[192:195], a[120:123], 0
    buffer_load_dwordx4 v[184:187], v105, s[12:15], 0 offen offset:0 sc1
    v_mfma_f32_16x16x32_bf16 v[8:11], a[192:195], a[144:147], 0
    ds_read_b128 a[236:239], v220 offset:29696
    v_cvt_pk_bf16_f32 v4, v4, v5
    v_mfma_f32_16x16x32_bf16 v[12:15], a[196:199], a[144:147], 0
    s_waitcnt vmcnt(8)
    ds_write_b128 v102, v[152:155] offset:1024
    s_waitcnt lgkmcnt(7)
    v_mfma_f32_16x16x32_bf16 v[76:79], a[200:203], a[76:79], v[76:79]
    v_cvt_pk_bf16_f32 v65, v66, v67
    v_cvt_pk_bf16_f32 v69, v70, v71
    v_mfma_f32_16x16x32_bf16 v[80:83], a[200:203], a[100:103], v[80:83]
    ds_write_b64 v222, v[64:65] offset:16384
    v_mfma_f32_16x16x32_bf16 v[84:87], a[200:203], a[124:127], v[84:87]
    ds_write_b64 v222, v[68:69] offset:17920
    v_mfma_f32_16x16x32_bf16 v[8:11], a[200:203], a[148:151], v[8:11]
    buffer_load_dwordx4 v[188:191], v105, s[12:15], 0 offen offset:1024 sc1
    v_mfma_f32_16x16x32_bf16 v[12:15], a[204:207], a[148:151], v[12:15]
    s_waitcnt vmcnt(8)
    ds_write_b128 v102, v[156:159] offset:2048
    v_mfma_f32_16x16x32_bf16 v[76:79], a[208:211], a[80:83], v[76:79]
    buffer_load_dwordx4 v[192:195], v105, s[12:15], 0 offen offset:2048 sc1
    v_mfma_f32_16x16x32_bf16 v[80:83], a[208:211], a[104:107], v[80:83]
    buffer_load_dwordx4 a[0:3], v223, s[4:7], s17 offen offset:0
    v_mfma_f32_16x16x32_bf16 v[84:87], a[208:211], a[128:131], v[84:87]
    buffer_load_dwordx4 a[4:7], v223, s[4:7], s17 offen offset:64
    v_mfma_f32_16x16x32_bf16 v[8:11], a[208:211], a[152:155], v[8:11]
    s_waitcnt vmcnt(10)
    ds_write_b128 v103, v[160:163] offset:0
    v_mfma_f32_16x16x32_bf16 v[12:15], a[212:215], a[152:155], v[12:15]
    v_cvt_pk_bf16_f32 v1, v2, v3
    v_cvt_pk_bf16_f32 v5, v6, v7
    v_mfma_f32_16x16x32_bf16 v[76:79], a[216:219], a[84:87], v[76:79]
    ds_write2_b32 v228, v0, v1 offset0:16 offset1:20
    v_mfma_f32_16x16x32_bf16 v[80:83], a[216:219], a[108:111], v[80:83]
    ds_write2_b32 v228, v4, v5 offset0:0 offset1:4
    v_mfma_f32_16x16x32_bf16 v[84:87], a[216:219], a[132:135], v[84:87]
    s_waitcnt vmcnt(9)
    ds_write_b128 v103, v[164:167] offset:1024
    v_mfma_f32_16x16x32_bf16 v[8:11], a[216:219], a[156:159], v[8:11]
    v_xor_b32 v228, 0x2000, v228
    v_cvt_pk_bf16_f32 v20, v72, v73
    v_mfma_f32_16x16x32_bf16 v[12:15], a[220:223], a[156:159], v[12:15]
    ds_read_b128 a[192:195], v220 offset:61440
    ds_read_b128 a[196:199], v220 offset:49152
    s_waitcnt lgkmcnt(7)
    v_mfma_f32_16x16x32_bf16 v[76:79], a[224:227], a[88:91], v[76:79]
    s_waitcnt vmcnt(8)
    ds_write_b128 v103, v[168:171] offset:2048
    v_mfma_f32_16x16x32_bf16 v[80:83], a[224:227], a[112:115], v[80:83]
    buffer_load_dwordx4 a[24:27], v224, s[4:7], s17 offen offset:0
    v_mfma_f32_16x16x32_bf16 v[84:87], a[224:227], a[136:139], v[84:87]
    s_waitcnt lgkmcnt(4)
    ds_read_b128 a[200:203], v220 offset:62464
    s_barrier
    v_mfma_f32_16x16x32_bf16 v[8:11], a[224:227], a[160:163], v[8:11]
    ds_read_b64 v[22:23], v229 offset:20480
    ds_read_b128 v[16:19], v222 offset:19456
    v_mfma_f32_16x16x32_bf16 v[12:15], a[228:231], a[160:163], v[12:15]
    s_mov_b64 exec, s[60:61]
    ds_read_b128 a[168:171], v97 offset:20992
    s_mov_b64 exec, -1
    s_mov_b64 exec, s[62:63]
    ds_read_b128 a[180:183], v97 offset:21136
    s_mov_b64 exec, -1
    v_mfma_f32_16x16x32_bf16 v[76:79], a[232:235], a[92:95], v[76:79]
    buffer_load_dwordx4 a[28:31], v224, s[4:7], s17 offen offset:64
    v_mfma_f32_16x16x32_bf16 v[80:83], a[232:235], a[116:119], v[80:83]
    s_waitcnt vmcnt(9)
    ds_write_b128 v104, v[172:175] offset:0
    v_mfma_f32_16x16x32_bf16 v[84:87], a[232:235], a[140:143], v[84:87]
    v_cvt_pk_bf16_f32 v21, v74, v75
    v_max3_u32 v251, v251, v148, v149
    v_mfma_f32_16x16x32_bf16 v[8:11], a[232:235], a[164:167], v[8:11]
    ds_read_b128 a[204:207], v220 offset:50176
    v_cvt_pk_bf16_f32 v76, v76, v77
    v_mfma_f32_16x16x32_bf16 v[12:15], a[236:239], a[164:167], v[12:15]
    s_waitcnt vmcnt(8)
    ds_write_b128 v104, v[176:179] offset:1024
    s_waitcnt lgkmcnt(10)
    v_mfma_f32_16x16x32_bf16 v[64:67], a[192:195], a[72:75], 0
    v_cvt_pk_bf16_f32 v80, v80, v81
    v_cvt_pk_bf16_f32 v77, v78, v79
    v_mfma_f32_16x16x32_bf16 v[68:71], a[192:195], a[96:99], 0
    ds_write_b64 v222, v[76:77] offset:24576
    v_mfma_f32_16x16x32_bf16 v[72:75], a[192:195], a[120:123], 0
    ds_read_b128 a[208:211], v220 offset:63488
    v_cvt_pk_bf16_f32 v8, v8, v9
    v_mfma_f32_16x16x32_bf16 v[0:3], a[192:195], a[144:147], 0
    s_waitcnt vmcnt(7)
    ds_write_b128 v104, v[180:183] offset:2048
    s_waitcnt lgkmcnt(11)
    v_mfma_f32_16x16x32_bf16 v[4:7], a[196:199], a[144:147], 0
    buffer_load_dwordx4 a[48:51], v225, s[4:7], s17 offen offset:0
    s_waitcnt lgkmcnt(10)
    v_mfma_f32_16x16x32_bf16 v[64:67], a[200:203], a[76:79], v[64:67]
    ds_read_b128 a[212:215], v220 offset:51200
    v_cvt_pk_bf16_f32 v12, v12, v13
    v_mfma_f32_16x16x32_bf16 v[68:71], a[200:203], a[100:103], v[68:71]
    s_waitcnt vmcnt(7)
    ds_write_b128 v105, v[184:187] offset:0
    v_mfma_f32_16x16x32_bf16 v[72:75], a[200:203], a[124:127], v[72:75]
    buffer_load_dwordx4 a[52:55], v225, s[4:7], s17 offen offset:64
    v_mfma_f32_16x16x32_bf16 v[0:3], a[200:203], a[148:151], v[0:3]
    ds_read_b128 a[216:219], v220 offset:64512
    v_cvt_pk_bf16_f32 v81, v82, v83
    s_waitcnt lgkmcnt(7)
    v_mfma_f32_16x16x32_bf16 v[4:7], a[204:207], a[148:151], v[4:7]
    ds_write_b64 v222, v[80:81] offset:26112
    v_mfma_f32_16x16x32_bf16 v[32:35], a[72:75], v[16:19], 0
    s_waitcnt vmcnt(7)
    ds_write_b128 v105, v[188:191] offset:1024
    v_mfma_f32_16x16x32_bf16 v[36:39], a[96:99], v[16:19], 0
    v_cvt_pk_bf16_f32 v9, v10, v11
    v_cvt_pk_bf16_f32 v13, v14, v15
    v_mfma_f32_16x16x32_bf16 v[40:43], a[120:123], v[16:19], 0
    ds_write2_b32 v228, v8, v9 offset0:16 offset1:20
    v_mfma_f32_16x16x32_bf16 v[44:47], a[144:147], v[16:19], 0
    ds_write2_b32 v228, v12, v13 offset0:0 offset1:4
    s_waitcnt lgkmcnt(8)
    v_mfma_f32_16x16x32_bf16 v[64:67], a[208:211], a[80:83], v[64:67]
    s_waitcnt vmcnt(6)
    ds_write_b128 v105, v[192:195] offset:2048
    v_mfma_f32_16x16x32_bf16 v[68:71], a[208:211], a[104:107], v[68:71]
    buffer_load_dwordx4 a[8:11], v223, s[4:7], s17 offen offset:128
    v_mfma_f32_16x16x32_bf16 v[72:75], a[208:211], a[128:131], v[72:75]
    ds_read_b128 a[220:223], v220 offset:52224
    v_xor_b32 v228, 0x2000, v228
    v_mfma_f32_16x16x32_bf16 v[0:3], a[208:211], a[152:155], v[0:3]
    ds_read_b128 a[224:227], v221 offset:0
    ds_read_b128 a[228:231], v220 offset:53248
    s_waitcnt lgkmcnt(9)
    v_mfma_f32_16x16x32_bf16 v[4:7], a[212:215], a[152:155], v[4:7]
    buffer_load_dwordx4 a[12:15], v223, s[4:7], s17 offen offset:192
    v_mfma_f32_16x16x32_bf16 v[32:35], a[76:79], v[20:23], v[32:35]
    ds_read_b128 a[232:235], v221 offset:1024
    ds_read_b128 a[236:239], v220 offset:54272
    v_mfma_f32_16x16x32_bf16 v[36:39], a[100:103], v[20:23], v[36:39]
    s_waitcnt lgkmcnt(6)
    ds_read_b64_tr_b16 a[192:193], v92 offset:0
    s_barrier
    v_mfma_f32_16x16x32_bf16 v[40:43], a[124:127], v[20:23], v[40:43]
    ds_read_b64 v[30:31], v229 offset:28672
    ds_read_b128 v[24:27], v222 offset:27648
    v_mfma_f32_16x16x32_bf16 v[44:47], a[148:151], v[20:23], v[44:47]
    s_mov_b64 exec, s[60:61]
    ds_read_b128 a[172:175], v97 offset:29184
    s_mov_b64 exec, -1
    s_mov_b64 exec, s[62:63]
    ds_read_b128 a[184:187], v97 offset:29328
    s_mov_b64 exec, -1
    v_mfma_f32_16x16x32_bf16 v[64:67], a[216:219], a[84:87], v[64:67]
    ds_read_b64_tr_b16 a[194:195], v92 offset:6144
    ds_read_b64_tr_b16 a[196:197], v92 offset:12288
    v_mfma_f32_16x16x32_bf16 v[68:71], a[216:219], a[108:111], v[68:71]
    ds_read_b64_tr_b16 a[198:199], v92 offset:18432
    ds_read_b64_tr_b16 a[200:201], v92 offset:24576
    v_mfma_f32_16x16x32_bf16 v[72:75], a[216:219], a[132:135], v[72:75]
    ds_read_b64_tr_b16 a[202:203], v92 offset:30720
    ds_read_b64_tr_b16 a[204:205], v92 offset:36864
    v_mfma_f32_16x16x32_bf16 v[0:3], a[216:219], a[156:159], v[0:3]
    ds_read_b64_tr_b16 a[206:207], v92 offset:43008
    ds_read_b64_tr_b16 a[208:209], v92 offset:49152
    ds_read_b64_tr_b16 a[210:211], v92 offset:55296
    buffer_load_dwordx4 a[32:35], v224, s[4:7], s17 offen offset:128
    s_waitcnt lgkmcnt(15)
    v_mfma_f32_16x16x32_bf16 v[4:7], a[220:223], a[156:159], v[4:7]
    ds_read_b64_tr_b16 a[212:213], v92 offset:61440
    ds_read_b64_tr_b16 a[214:215], v93 offset:2048
    v_mfma_f32_16x16x32_bf16 v[64:67], a[224:227], a[88:91], v[64:67]
    ds_read_b64_tr_b16 a[216:217], v92 offset:1024
    ds_read_b64_tr_b16 a[218:219], v92 offset:7168
    v_mfma_f32_16x16x32_bf16 v[68:71], a[224:227], a[112:115], v[68:71]
    buffer_load_dwordx4 a[36:39], v224, s[4:7], s17 offen offset:192
    v_mfma_f32_16x16x32_bf16 v[72:75], a[224:227], a[136:139], v[72:75]
    ds_read_b64_tr_b16 a[220:221], v92 offset:13312
    ds_read_b64_tr_b16 a[222:223], v92 offset:19456
    v_mfma_f32_16x16x32_bf16 v[0:3], a[224:227], a[160:163], v[0:3]
    ds_read_b64_tr_b16 a[224:225], v92 offset:25600
    v_max3_u32 v251, v251, v150, v151
    v_mfma_f32_16x16x32_bf16 v[4:7], a[228:231], a[160:163], v[4:7]
    ds_read_b64_tr_b16 a[226:227], v92 offset:31744
    v_max3_u32 v251, v251, v152, v153
L_pad9:
    s_cbranch_execz L_pad10
    v_mfma_f32_16x16x32_bf16 v[64:67], a[232:235], a[92:95], v[64:67]
    ds_read_b64_tr_b16 a[228:229], v92 offset:37888
    v_max3_u32 v251, v251, v154, v155
    v_mfma_f32_16x16x32_bf16 v[68:71], a[232:235], a[116:119], v[68:71]
    ds_read_b64_tr_b16 a[230:231], v92 offset:44032
    v_max3_u32 v251, v251, v156, v157
    v_mfma_f32_16x16x32_bf16 v[72:75], a[232:235], a[140:143], v[72:75]
    v_max3_u32 v251, v251, v158, v159
    v_max3_u32 v251, v251, v160, v161
    v_mfma_f32_16x16x32_bf16 v[0:3], a[232:235], a[164:167], v[0:3]
    ds_read_b64_tr_b16 a[232:233], v92 offset:50176
    v_cvt_pk_bf16_f32 v64, v64, v65
    s_waitcnt lgkmcnt(15)
    v_mfma_f32_16x16x32_bf16 v[4:7], a[236:239], a[164:167], v[4:7]
    ds_read_b64_tr_b16 a[234:235], v92 offset:56320
    v_cvt_pk_bf16_f32 v68, v68, v69
    v_cvt_pk_bf16_f32 v65, v66, v67
    v_cvt_pk_bf16_f32 v69, v70, v71
    v_max3_u32 v251, v251, v162, v163
    v_max3_u32 v251, v251, v164, v165
    v_max3_u32 v251, v251, v166, v167
    v_max3_u32 v251, v251, v168, v169
    v_cvt_pk_bf16_f32 v0, v0, v1
    v_cvt_pk_bf16_f32 v1, v2, v3
    v_max3_u32 v251, v251, v170, v171
    v_max3_u32 v251, v251, v172, v173
    v_cvt_pk_bf16_f32 v4, v4, v5
    v_cvt_pk_bf16_f32 v5, v6, v7
    v_max3_u32 v251, v251, v174, v175
    v_max3_u32 v251, v251, v176, v177
    v_max3_u32 v251, v251, v178, v179
    v_max3_u32 v251, v251, v180, v181
    v_max3_u32 v251, v251, v182, v183
    v_max3_u32 v251, v251, v184, v185
    v_max3_u32 v251, v251, v186, v187
    v_max3_u32 v251, v251, v188, v189
    v_max3_u32 v251, v251, v190, v191
    v_max3_u32 v251, v251, v192, v193
    v_max3_u32 v251, v251, v194, v195
    v_cmp_eq_u32 vcc, -1, v251
    s_nop 1
    s_cbranch_vccnz L_again
L_back2:
    buffer_load_dwordx4 a[56:59], v225, s[4:7], s17 offen offset:128
    ds_write_b64 v222, v[64:65] offset:16384
    v_mfma_f32_16x16x32_bf16 v[64:67], a[192:195], a[144:147], 0
    ds_write_b64 v222, v[68:69] offset:17920
    v_mfma_f32_16x16x32_bf16 v[64:67], a[196:199], a[148:151], v[64:67]
    ds_write2_b32 v228, v0, v1 offset0:16 offset1:20
    v_mfma_f32_16x16x32_bf16 v[64:67], a[200:203], a[152:155], v[64:67]
    ds_write2_b32 v228, v4, v5 offset0:0 offset1:4
    s_waitcnt lgkmcnt(6)
    v_mfma_f32_16x16x32_bf16 v[64:67], a[204:207], a[156:159], v[64:67]
    ds_read_b64_tr_b16 a[236:237], v92 offset:62464
    ds_read_b64_tr_b16 a[238:239], v93 offset:3072
    v_mfma_f32_16x16x32_bf16 v[64:67], a[208:211], a[160:163], v[64:67]
    ds_read_b64_tr_b16 a[192:193], v92 offset:2048
    ds_read_b64_tr_b16 a[194:195], v92 offset:8192
    v_mfma_f32_16x16x32_bf16 v[64:67], a[212:215], a[164:167], v[64:67]
    ds_read_b64_tr_b16 a[196:197], v92 offset:14336
    ds_read_b64_tr_b16 a[198:199], v92 offset:20480
    v_mfma_f32_16x16x32_bf16 v[68:71], a[216:219], a[144:147], 0
    ds_read_b64_tr_b16 a[200:201], v92 offset:26624
    ds_read_b64_tr_b16 a[202:203], v92 offset:32768
    v_mfma_f32_16x16x32_bf16 v[68:71], a[220:223], a[148:151], v[68:71]
    buffer_load_dwordx4 a[60:63], v225, s[4:7], s17 offen offset:192
    v_mfma_f32_16x16x32_bf16 v[68:71], a[224:227], a[152:155], v[68:71]
    ds_read_b64_tr_b16 a[204:205], v92 offset:38912
    v_cvt_pk_bf16_f32 v64, v64, v65
    v_mfma_f32_16x16x32_bf16 v[68:71], a[228:231], a[156:159], v[68:71]
    ds_read_b64_tr_b16 a[206:207], v92 offset:45056
    s_waitcnt lgkmcnt(10)
    v_mfma_f32_16x16x32_bf16 v[68:71], a[232:235], a[160:163], v[68:71]
    s_barrier
    s_mov_b64 exec, s[60:61]
    ds_read_b128 a[176:179], v97 offset:20992
    s_mov_b64 exec, -1
    s_mov_b64 exec, s[62:63]
    ds_read_b128 a[188:191], v97 offset:21136
    s_mov_b64 exec, -1
    v_cvt_pk_bf16_f32 v65, v66, v67
    ds_write2_b32 v94, v64, v65 offset0:0 offset1:4
    ds_read_b64 v[22:23], v229 offset:20480
    ds_read_b128 v[16:19], v222 offset:19456
    ds_read_b64_tr_b16 a[208:209], v92 offset:51200
    ds_read_b64_tr_b16 a[210:211], v92 offset:57344
    ds_read_b64_tr_b16 a[212:213], v92 offset:63488
    ds_read_b64_tr_b16 a[214:215], v93 offset:4096
    ds_read_b64_tr_b16 a[216:217], v92 offset:3072
    ds_read_b64_tr_b16 a[218:219], v92 offset:9216
    ds_read_b64_tr_b16 a[220:221], v92 offset:15360
    ds_read_b64_tr_b16 a[222:223], v92 offset:21504
    v_cvt_pk_bf16_f32 v20, v72, v73
    s_waitcnt lgkmcnt(15)
    v_mfma_f32_16x16x32_bf16 v[68:71], a[236:239], a[164:167], v[68:71]
    ds_read_b64_tr_b16 a[224:225], v92 offset:27648
    v_cvt_pk_bf16_f32 v21, v74, v75
    v_mfma_f32_16x16x32_bf16 v[32:35], a[80:83], v[24:27], v[32:35]
    ds_read_b64_tr_b16 a[226:227], v92 offset:33792
    ds_read_b64_tr_b16 a[228:229], v92 offset:39936
    v_mfma_f32_16x16x32_bf16 v[36:39], a[104:107], v[24:27], v[36:39]
    ds_read_b64_tr_b16 a[230:231], v92 offset:46080
    ds_read_b64_tr_b16 a[232:233], v92 offset:52224
    v_mfma_f32_16x16x32_bf16 v[40:43], a[128:131], v[24:27], v[40:43]
    ds_read_b64_tr_b16 a[234:235], v92 offset:58368
    v_cvt_pk_bf16_f32 v68, v68, v69
    v_mfma_f32_16x16x32_bf16 v[44:47], a[152:155], v[24:27], v[44:47]
    buffer_load_dwordx4 a[16:19], v223, s[4:7], s17 offen offset:256
    v_mfma_f32_16x16x32_bf16 v[72:75], a[192:195], a[144:147], 0
    buffer_load_dwordx4 a[20:23], v223, s[4:7], s17 offen offset:320
    v_mfma_f32_16x16x32_bf16 v[72:75], a[196:199], a[148:151], v[72:75]
    ds_read_b64_tr_b16 a[236:237], v92 offset:64512
    v_cvt_pk_bf16_f32 v69, v70, v71
    v_mfma_f32_16x16x32_bf16 v[72:75], a[200:203], a[152:155], v[72:75]
    ds_write2_b32 v94, v68, v69 offset0:16 offset1:20
    s_waitcnt lgkmcnt(15)
    v_mfma_f32_16x16x32_bf16 v[72:75], a[204:207], a[156:159], v[72:75]
    ds_read_b64_tr_b16 a[238:239], v93 offset:5120
    ds_read_b64_tr_b16 a[192:193], v92 offset:4096
    ds_read_b64_tr_b16 a[194:195], v92 offset:10240
    ds_read_b64_tr_b16 a[196:197], v92 offset:16384
    s_waitcnt lgkmcnt(15)
    v_mfma_f32_16x16x32_bf16 v[72:75], a[208:211], a[160:163], v[72:75]
    ds_read_b64_tr_b16 a[198:199], v92 offset:22528
    v_cvt_pk_bf16_f32 v28, v84, v85
    v_mfma_f32_16x16x32_bf16 v[72:75], a[212:215], a[164:167], v[72:75]
    ds_read_b64_tr_b16 a[200:201], v92 offset:28672
    v_cvt_pk_bf16_f32 v29, v86, v87
    ds_read_b64_tr_b16 a[202:203], v92 offset:34816
    s_nop 0
    v_mfma_f32_16x16x32_bf16 v[32:35], a[84:87], v[28:31], v[32:35]
    ds_read_b64_tr_b16 a[204:205], v92 offset:40960
    ds_read_b64_tr_b16 a[206:207], v92 offset:47104
    v_mfma_f32_16x16x32_bf16 v[36:39], a[108:111], v[28:31], v[36:39]
    ds_read_b64_tr_b16 a[208:209], v92 offset:53248
    v_cvt_pk_bf16_f32 v72, v72, v73
    v_mfma_f32_16x16x32_bf16 v[40:43], a[132:135], v[28:31], v[40:43]
    ds_read_b64_tr_b16 a[210:211], v92 offset:59392
    v_cvt_pk_bf16_f32 v73, v74, v75
    v_mfma_f32_16x16x32_bf16 v[44:47], a[156:159], v[28:31], v[44:47]
    ds_write2_b32 v94, v72, v73 offset0:32 offset1:36
    s_waitcnt lgkmcnt(15)
    v_mfma_f32_16x16x32_bf16 v[76:79], a[216:219], a[144:147], 0
    ds_read_b64_tr_b16 a[212:213], v93 offset:0
    ds_read_b64_tr_b16 a[214:215], v93 offset:6144
    v_mfma_f32_16x16x32_bf16 v[76:79], a[220:223], a[148:151], v[76:79]
    buffer_load_dwordx4 a[40:43], v224, s[4:7], s17 offen offset:256
    v_mfma_f32_16x16x32_bf16 v[76:79], a[224:227], a[152:155], v[76:79]
    buffer_load_dwordx4 a[44:47], v224, s[4:7], s17 offen offset:320
    v_mfma_f32_16x16x32_bf16 v[76:79], a[228:231], a[156:159], v[76:79]
    ds_read_b64_tr_b16 a[216:217], v92 offset:5120
    ds_read_b64_tr_b16 a[218:219], v92 offset:11264
    s_waitcnt lgkmcnt(15)
    v_mfma_f32_16x16x32_bf16 v[76:79], a[232:235], a[160:163], v[76:79]
    ds_read_b64_tr_b16 a[220:221], v92 offset:17408
    ds_read_b64_tr_b16 a[222:223], v92 offset:23552
    v_mfma_f32_16x16x32_bf16 v[76:79], a[236:239], a[164:167], v[76:79]
    ds_read_b64_tr_b16 a[224:225], v92 offset:29696
    ds_read_b64_tr_b16 a[226:227], v92 offset:35840
    s_waitcnt lgkmcnt(15)
    v_mfma_f32_16x16x32_bf16 v[80:83], a[192:195], a[144:147], 0
    ds_read_b64_tr_b16 a[228:229], v92 offset:41984
    ds_read_b64_tr_b16 a[230:231], v92 offset:48128
    v_mfma_f32_16x16x32_bf16 v[80:83], a[196:199], a[148:151], v[80:83]
    ds_read_b64_tr_b16 a[232:233], v92 offset:54272
    ds_read_b64_tr_b16 a[234:235], v92 offset:60416
    s_waitcnt lgkmcnt(15)
    v_mfma_f32_16x16x32_bf16 v[80:83], a[200:203], a[152:155], v[80:83]
    ds_read_b64_tr_b16 a[236:237], v93 offset:1024
    v_cvt_pk_bf16_f32 v76, v76, v77
    v_mfma_f32_16x16x32_bf16 v[80:83], a[204:207], a[156:159], v[80:83]
    ds_read_b64_tr_b16 a[238:239], v93 offset:7168
    v_cvt_pk_bf16_f32 v77, v78, v79
    s_waitcnt lgkmcnt(15)
    v_mfma_f32_16x16x32_bf16 v[80:83], a[208:211], a[160:163], v[80:83]
    ds_write2_b32 v94, v76, v77 offset0:48 offset1:52
    ds_read_b128 a[192:195], v221 offset:20480
    ds_read_b128 a[196:199], v221 offset:8192
    ds_read_b128 a[200:203], v221 offset:21504
    ds_read_b128 a[204:207], v221 offset:9216
    s_waitcnt lgkmcnt(15)
    v_mfma_f32_16x16x32_bf16 v[80:83], a[212:215], a[164:167], v[80:83]
    ds_read_b128 a[208:211], v221 offset:22528
    ds_read_b128 a[212:215], v221 offset:10240
    v_mfma_f32_16x16x32_bf16 v[32:35], a[88:91], v[16:19], v[32:35]
    v_mov_b32 v139, 0
    v_mov_b32 v147, 0
    v_mfma_f32_16x16x32_bf16 v[36:39], a[112:115], v[16:19], v[36:39]
    v_mov_b32 v155, 0
    v_mov_b32 v228, 0x4444
    v_mfma_f32_16x16x32_bf16 v[40:43], a[136:139], v[16:19], v[40:43]
    buffer_load_dwordx4 a[64:67], v225, s[4:7], s17 offen offset:256
    v_mfma_f32_16x16x32_bf16 v[44:47], a[160:163], v[16:19], v[44:47]
    buffer_load_dwordx4 a[68:71], v225, s[4:7], s17 offen offset:320
    v_mfma_f32_16x16x32_bf16 v[32:35], a[92:95], v[20:23], v[32:35]
    v_cvt_pk_bf16_f32 v80, v80, v81
    v_cvt_pk_bf16_f32 v81, v82, v83
    v_mfma_f32_16x16x32_bf16 v[36:39], a[116:119], v[20:23], v[36:39]
    ds_write2_b32 v94, v80, v81 offset0:64 offset1:68
    v_mfma_f32_16x16x32_bf16 v[40:43], a[140:143], v[20:23], v[40:43]
    v_cndmask_b32 v228, v228, v96, s[66:67]
    v_mov_b32 v163, 0
    v_mfma_f32_16x16x32_bf16 v[44:47], a[164:167], v[20:23], v[44:47]
    v_max3_f32 v245, v32, v33, v34
    v_mov_b32 v171, 0
    v_mfma_f32_16x16x32_bf16 v[84:87], a[216:219], a[144:147], 0
    ds_read_b128 a[216:219], v221 offset:23552
    v_max3_f32 v246, v35, v36, v37
    s_waitcnt lgkmcnt(10)
    v_mfma_f32_16x16x32_bf16 v[84:87], a[220:223], a[148:151], v[84:87]
    ds_read_b128 a[220:223], v221 offset:11264
    v_max3_f32 v245, v245, v38, v39
    v_mfma_f32_16x16x32_bf16 v[84:87], a[224:227], a[152:155], v[84:87]
    ds_read_b128 a[224:227], v221 offset:24576
    v_cndmask_b32 v44, v244, v44, s[48:49]
    v_mfma_f32_16x16x32_bf16 v[84:87], a[228:231], a[156:159], v[84:87]
    ds_read_b128 a[228:231], v221 offset:12288
    v_cndmask_b32 v44, v44, v45, s[50:51]
    v_mfma_f32_16x16x32_bf16 v[84:87], a[232:235], a[160:163], v[84:87]
    ds_read_b128 a[232:235], v221 offset:25600
    v_max3_f32 v246, v246, v40, v41
    s_waitcnt lgkmcnt(8)
    v_mfma_f32_16x16x32_bf16 v[84:87], a[236:239], a[164:167], v[84:87]
    ds_read_b128 a[236:239], v221 offset:13312
    v_max3_f32 v245, v245, v42, v43
    v_mfma_f32_16x16x32_bf16 v[64:67], a[72:75], a[192:195], 0
    v_max3_f32 v245, v245, v246, v44
    v_mov_b32 v246, v245
    v_mfma_f32_16x16x32_bf16 v[68:71], a[96:99], a[192:195], 0
    v_mov_b32 v179, 0
    v_mov_b32 v187, 0
    v_mfma_f32_16x16x32_bf16 v[72:75], a[120:123], a[192:195], 0
    v_cvt_pk_bf16_f32 v84, v84, v85
    v_cvt_pk_bf16_f32 v85, v86, v87
    v_mfma_f32_16x16x32_bf16 v[0:3], a[144:147], a[192:195], 0
    ds_write2_b32 v94, v84, v85 offset0:80 offset1:84
    v_mfma_f32_16x16x32_bf16 v[4:7], a[144:147], a[196:199], 0
    ds_read_b128 a[192:195], v221 offset:45056
    ds_read_b128 a[196:199], v221 offset:32768
    v_mfma_f32_16x16x32_bf16 v[64:67], a[76:79], a[200:203], v[64:67]
    v_permlane32_swap_b32 v245, v246
    v_mfma_f32_16x16x32_bf16 v[68:71], a[100:103], a[200:203], v[68:71]
    v_max_f32 v245, v245, v246
    v_mov_b32 v246, v245
    v_mfma_f32_16x16x32_bf16 v[72:75], a[124:127], a[200:203], v[72:75]
    v_mov_b32 v195, 0
    v_mov_b32 v92, 0
    v_mfma_f32_16x16x32_bf16 v[0:3], a[148:151], a[200:203], v[0:3]
    ds_read_b128 a[200:203], v221 offset:46080
    v_mov_b32 v93, 0
    v_mfma_f32_16x16x32_bf16 v[4:7], a[148:151], a[204:207], v[4:7]
    ds_read_b128 a[204:207], v221 offset:33792
    s_waitcnt lgkmcnt(9)
    v_mfma_f32_16x16x32_bf16 v[64:67], a[80:83], a[208:211], v[64:67]
    s_waitcnt lgkmcnt(4)
    v_mfma_f32_16x16x32_bf16 v[68:71], a[104:107], a[208:211], v[68:71]
    s_barrier
    s_mov_b64 exec, s[56:57]
    ds_read_b128 a[168:171], v95 offset:24576
    s_mov_b64 exec, -1
    s_mov_b64 exec, s[58:59]
    ds_read_b128 a[180:183], v95 offset:24976
    s_mov_b64 exec, -1
    v_mfma_f32_16x16x32_bf16 v[72:75], a[128:131], a[208:211], v[72:75]
    s_mov_b64 exec, s[56:57]
    ds_read_b128 a[172:175], v95 offset:24704
    s_mov_b64 exec, -1
    s_mov_b64 exec, s[58:59]
    ds_read_b128 a[184:187], v95 offset:25104
    s_mov_b64 exec, -1
    v_mfma_f32_16x16x32_bf16 v[0:3], a[152:155], a[208:211], v[0:3]
    s_mov_b64 exec, s[56:57]
    ds_read_b128 a[176:179], v95 offset:24832
    s_mov_b64 exec, -1
    s_mov_b64 exec, s[58:59]
    ds_read_b128 a[188:191], v95 offset:25232
    s_mov_b64 exec, -1
    v_mfma_f32_16x16x32_bf16 v[4:7], a[152:155], a[212:215], v[4:7]
    ds_read_b128 a[208:211], v221 offset:47104
    ds_read_b128 a[212:215], v221 offset:34816
    v_mfma_f32_16x16x32_bf16 v[64:67], a[84:87], a[216:219], v[64:67]
    v_permlane16_swap_b32 v245, v246
    v_mfma_f32_16x16x32_bf16 v[68:71], a[108:111], a[216:219], v[68:71]
    v_max_f32 v245, v245, v246
    v_sub_f32 v32, v32, v245
    v_mfma_f32_16x16x32_bf16 v[72:75], a[132:135], a[216:219], v[72:75]
    v_sub_f32 v33, v33, v245
    v_sub_f32 v34, v34, v245
    v_mfma_f32_16x16x32_bf16 v[0:3], a[156:159], a[216:219], v[0:3]
    ds_read_b128 a[216:219], v221 offset:48128
    v_sub_f32 v35, v35, v245
    v_mfma_f32_16x16x32_bf16 v[4:7], a[156:159], a[220:223], v[4:7]
    ds_read_b128 a[220:223], v221 offset:35840
    v_sub_f32 v36, v36, v245
    v_mfma_f32_16x16x32_bf16 v[64:67], a[88:91], a[224:227], v[64:67]
    v_exp_f32 v32, v32
    v_mfma_f32_16x16x32_bf16 v[68:71], a[112:115], a[224:227], v[68:71]
    v_exp_f32 v33, v33
    v_mfma_f32_16x16x32_bf16 v[72:75], a[136:139], a[224:227], v[72:75]
    v_exp_f32 v34, v34
    v_mfma_f32_16x16x32_bf16 v[0:3], a[160:163], a[224:227], v[0:3]
    ds_read_b128 a[224:227], v221 offset:49152
    v_sub_f32 v37, v37, v245
    v_mfma_f32_16x16x32_bf16 v[4:7], a[160:163], a[228:231], v[4:7]
    ds_read_b128 a[228:231], v221 offset:36864
    v_sub_f32 v38, v38, v245
    v_mfma_f32_16x16x32_bf16 v[64:67], a[92:95], a[232:235], v[64:67]
    v_exp_f32 v35, v35
    v_mfma_f32_16x16x32_bf16 v[68:71], a[116:119], a[232:235], v[68:71]
    v_exp_f32 v36, v36
    v_mfma_f32_16x16x32_bf16 v[72:75], a[140:143], a[232:235], v[72:75]
    v_exp_f32 v37, v37
    v_mfma_f32_16x16x32_bf16 v[0:3], a[164:167], a[232:235], v[0:3]
    ds_read_b128 a[232:235], v221 offset:50176
    v_sub_f32 v39, v39, v245
    v_mfma_f32_16x16x32_bf16 v[4:7], a[164:167], a[236:239], v[4:7]
    ds_read_b128 a[236:239], v221 offset:37888
    v_cvt_pk_bf16_f32 v140, v64, v65
    s_waitcnt lgkmcnt(6)
    v_mfma_f32_16x16x32_bf16 v[76:79], a[72:75], a[192:195], 0
    v_cvt_pk_bf16_f32 v141, v66, v67
    v_cvt_pk_bf16_f32 v142, v68, v69
    v_mfma_f32_16x16x32_bf16 v[80:83], a[96:99], a[192:195], 0
    v_cvt_pk_bf16_f32 v143, v70, v71
    v_cvt_pk_bf16_f32 v144, v72, v73
    v_mfma_f32_16x16x32_bf16 v[84:87], a[120:123], a[192:195], 0
    ds_write_b128 v222, v[140:143] offset:18432
    v_mfma_f32_16x16x32_bf16 v[8:11], a[144:147], a[192:195], 0
    ds_read_b128 a[192:195], v222 offset:4096
    v_cvt_pk_bf16_f32 v145, v74, v75
    v_mfma_f32_16x16x32_bf16 v[12:15], a[144:147], a[196:199], 0
    ds_write_b64 v229, v[144:145] offset:21504
    v_mfma_f32_16x16x32_bf16 v[76:79], a[76:79], a[200:203], v[76:79]
    ds_read_b128 a[196:199], v221 offset:57344
    v_cvt_pk_bf16_f32 v2, v2, v3
    v_mfma_f32_16x16x32_bf16 v[80:83], a[100:103], a[200:203], v[80:83]
    ds_write_b32 v230, v2 offset:23552
    v_mfma_f32_16x16x32_bf16 v[84:87], a[124:127], a[200:203], v[84:87]
    v_cvt_pk_bf16_f32 v6, v6, v7
    v_cvt_pk_bf16_f32 v146, v0, v1
    v_mfma_f32_16x16x32_bf16 v[8:11], a[148:151], a[200:203], v[8:11]
    ds_write_b32 v230, v6 offset:23808
    v_mfma_f32_16x16x32_bf16 v[12:15], a[148:151], a[204:207], v[12:15]
    ds_read_b128 a[200:203], v222 offset:5120
    ds_read_b128 a[204:207], v221 offset:58368
    v_mfma_f32_16x16x32_bf16 v[76:79], a[80:83], a[208:211], v[76:79]
    v_cvt_pk_bf16_f32 v130, v4, v5
    v_sub_f32 v40, v40, v245
    v_mfma_f32_16x16x32_bf16 v[80:83], a[104:107], a[208:211], v[80:83]
    v_exp_f32 v38, v38
    v_mfma_f32_16x16x32_bf16 v[84:87], a[128:131], a[208:211], v[84:87]
    v_add_f32 v247, v32, v33
    v_sub_f32 v41, v41, v245
    v_mfma_f32_16x16x32_bf16 v[8:11], a[152:155], a[208:211], v[8:11]
    ds_read_b128 a[208:211], v222 offset:6144
    v_sub_f32 v42, v42, v245
    v_mfma_f32_16x16x32_bf16 v[12:15], a[152:155], a[212:215], v[12:15]
    ds_read_b128 a[212:215], v221 offset:59392
    v_add_f32 v248, v34, v35
    s_waitcnt lgkmcnt(10)
    v_mfma_f32_16x16x32_bf16 v[76:79], a[84:87], a[216:219], v[76:79]
    s_waitcnt lgkmcnt(4)
    v_mfma_f32_16x16x32_bf16 v[80:83], a[108:111], a[216:219], v[80:83]
    s_barrier
    ds_read_b128 v[124:127], v222 offset:16384
    ds_read_b64 v[128:129], v229 offset:20480
    v_mfma_f32_16x16x32_bf16 v[84:87], a[132:135], a[216:219], v[84:87]
    ds_read_b128 v[132:135], v222 offset:17408
    ds_read_b64 v[136:137], v229 offset:20992
    v_mfma_f32_16x16x32_bf16 v[8:11], a[156:159], a[216:219], v[8:11]
    ds_read_b32 v138, v230 offset:24320
    v_add_f32 v247, v247, v36
    v_mfma_f32_16x16x32_bf16 v[12:15], a[156:159], a[220:223], v[12:15]
    ds_read_b128 v[148:151], v222 offset:19456
    v_sub_f32 v43, v43, v245
    v_mfma_f32_16x16x32_bf16 v[76:79], a[88:91], a[224:227], v[76:79]
    ds_read_b64 v[152:153], v229 offset:22016
    v_sub_f32 v44, v44, v245
    v_mfma_f32_16x16x32_bf16 v[80:83], a[112:115], a[224:227], v[80:83]
    ds_read_b32 v154, v230 offset:24064
    v_add_f32 v248, v248, v37
    v_mfma_f32_16x16x32_bf16 v[84:87], a[136:139], a[224:227], v[84:87]
    ds_read_b128 a[216:219], v222 offset:7168
    v_add_f32 v247, v247, v38
    v_mfma_f32_16x16x32_bf16 v[8:11], a[160:163], a[224:227], v[8:11]
    ds_read_b128 a[220:223], v221 offset:60416
    ds_read_b128 a[224:227], v222 offset:8192
    v_mfma_f32_16x16x32_bf16 v[12:15], a[160:163], a[228:231], v[12:15]
    ds_read_b128 a[228:231], v221 offset:61440
    v_mfma_f32_16x16x32_bf16 v[76:79], a[92:95], a[232:235], v[76:79]
    v_exp_f32 v39, v39
    v_mfma_f32_16x16x32_bf16 v[80:83], a[116:119], a[232:235], v[80:83]
    v_exp_f32 v40, v40
    v_mfma_f32_16x16x32_bf16 v[84:87], a[140:143], a[232:235], v[84:87]
    v_exp_f32 v41, v41
    v_mfma_f32_16x16x32_bf16 v[8:11], a[164:167], a[232:235], v[8:11]
    ds_read_b128 a[232:235], v222 offset:9216
    v_add_f32 v248, v248, v39
    v_mfma_f32_16x16x32_bf16 v[12:15], a[164:167], a[236:239], v[12:15]
    ds_read_b128 a[236:239], v221 offset:62464
    v_add_f32 v247, v247, v40
    v_mfma_f32_16x16x32_bf16 v[64:67], a[72:75], a[192:195], 0
    v_exp_f32 v42, v42
    v_mfma_f32_16x16x32_bf16 v[68:71], a[96:99], a[192:195], 0
    v_exp_f32 v43, v43
    v_mfma_f32_16x16x32_bf16 v[72:75], a[120:123], a[192:195], 0
    v_exp_f32 v44, v44
    v_mfma_f32_16x16x32_bf16 v[0:3], a[144:147], a[192:195], 0
    ds_read_b128 a[192:195], v220 offset:0
    v_add_f32 v248, v248, v41
    v_mfma_f32_16x16x32_bf16 v[4:7], a[144:147], a[196:199], 0
    ds_read_b128 a[196:199], v220 offset:1024
    v_add_f32 v247, v247, v42
    s_waitcnt lgkmcnt(9)
    v_mfma_f32_16x16x32_bf16 v[64:67], a[76:79], a[200:203], v[64:67]
    v_add_f32 v248, v248, v43
    v_add_f32 v247, v247, v44
    v_mfma_f32_16x16x32_bf16 v[68:71], a[100:103], a[200:203], v[68:71]
    v_add_f32 v247, v247, v248
    v_mov_b32 v248, v247
    v_mfma_f32_16x16x32_bf16 v[72:75], a[124:127], a[200:203], v[72:75]
    v_cvt_pk_bf16_f32 v172, v76, v77
    v_cvt_pk_bf16_f32 v173, v78, v79
    v_mfma_f32_16x16x32_bf16 v[0:3], a[148:151], a[200:203], v[0:3]
    ds_read_b128 a[200:203], v220 offset:2048
    v_cvt_pk_bf16_f32 v174, v80, v81
    v_mfma_f32_16x16x32_bf16 v[4:7], a[148:151], a[204:207], v[4:7]
    ds_read_b128 a[204:207], v220 offset:3072
    v_permlane32_swap_b32 v247, v248
    v_add_f32 v247, v247, v248
    v_mov_b32 v248, v247
    v_cvt_pk_bf16_f32 v175, v82, v83
    v_cvt_pk_bf16_f32 v176, v84, v85
    v_permlane16_swap_b32 v247, v248
    v_add_f32 v247, v247, v248
    v_rcp_f32 v249, v247
    v_cvt_pk_bf16_f32 v177, v86, v87
    v_mul_f32 v32, v32, v249
    v_mul_f32 v33, v33, v249
    v_cvt_pk_bf16_f32 v32, v32, v33
    v_mul_f32 v34, v34, v249
    v_mul_f32 v35, v35, v249
    v_cvt_pk_bf16_f32 v33, v34, v35
    v_mul_f32 v36, v36, v249
    v_mul_f32 v37, v37, v249
    v_mul_f32 v38, v38, v249
    v_mul_f32 v39, v39, v249
    v_cvt_pk_bf16_f32 v34, v36, v37
    v_cvt_pk_bf16_f32 v35, v38, v39
    v_mul_f32 v44, v44, v249
    v_mul_f32 v40, v40, v249
    v_mfma_f32_16x16x32_bf16 v[48:51], v[32:35], v[124:127], 0
    ds_write_b128 v222, v[172:175] offset:26624
    v_mul_f32 v41, v41, v249
    v_mul_f32 v42, v42, v249
    v_mul_f32 v43, v43, v249
    v_cvt_pk_bf16_f32 v38, v44, 0
    v_cvt_pk_bf16_f32 v36, v40, v41
    v_cvt_pk_bf16_f32 v37, v42, v43
    v_lshlrev_b32 v38, s54, v38
    v_mov_b32 v39, 0
    s_nop 0
    s_nop 0
    v_mfma_f32_16x16x32_bf16 v[48:51], v[36:39], v[128:131], v[48:51]
    ds_write_b64 v229, v[176:177] offset:29696
    v_mfma_f32_16x16x32_bf16 v[52:55], v[32:35], v[132:135], 0
    v_cvt_pk_bf16_f32 v10, v10, v11
    v_cvt_pk_bf16_f32 v14, v14, v15
    v_mfma_f32_16x16x32_bf16 v[52:55], v[36:39], v[136:139], v[52:55]
    ds_write_b32 v230, v10 offset:31744
    v_mfma_f32_16x16x32_bf16 v[64:67], a[80:83], a[208:211], v[64:67]
    ds_write_b32 v230, v14 offset:32000
    v_mfma_f32_16x16x32_bf16 v[68:71], a[104:107], a[208:211], v[68:71]
    v_mov_b32 v10, 0
    v_mov_b32 v11, 0
    v_mfma_f32_16x16x32_bf16 v[72:75], a[128:131], a[208:211], v[72:75]
    v_cvt_pk_bf16_f32 v178, v8, v9
    v_mov_b32 v14, 0
    v_mfma_f32_16x16x32_bf16 v[0:3], a[152:155], a[208:211], v[0:3]
    ds_read_b128 a[208:211], v220 offset:4096
    v_mov_b32 v15, 0
    v_mfma_f32_16x16x32_bf16 v[4:7], a[152:155], a[212:215], v[4:7]
    ds_read_b128 a[212:215], v220 offset:5120
    v_cvt_pk_bf16_f32 v162, v12, v13
    v_mfma_f32_16x16x32_bf16 v[56:59], v[32:35], v[140:143], 0
    v_cvt_pk_bf16_f32 v100, v48, v52
    v_cvt_pk_bf16_f32 v102, v49, v53
    v_mfma_f32_16x16x32_bf16 v[56:59], v[36:39], v[144:147], v[56:59]
    v_cvt_pk_bf16_f32 v104, v50, v54
    v_cvt_pk_bf16_f32 v106, v51, v55
    v_mfma_f32_16x16x32_bf16 v[60:63], v[32:35], v[148:151], 0
    s_waitcnt lgkmcnt(2)
    v_mfma_f32_16x16x32_bf16 v[60:63], v[36:39], v[152:155], v[60:63]
    s_barrier
    ds_read_b128 v[156:159], v222 offset:24576
    ds_read_b64 v[160:161], v229 offset:28672
    v_mfma_f32_16x16x32_bf16 v[64:67], a[84:87], a[216:219], v[64:67]
    ds_read_b128 v[164:167], v222 offset:25600
    ds_read_b64 v[168:169], v229 offset:29184
    v_mfma_f32_16x16x32_bf16 v[68:71], a[108:111], a[216:219], v[68:71]
    ds_read_b32 v170, v230 offset:32512
    ds_read_b128 v[180:183], v222 offset:27648
    v_mfma_f32_16x16x32_bf16 v[72:75], a[132:135], a[216:219], v[72:75]
    ds_read_b64 v[184:185], v229 offset:30208
    ds_read_b32 v186, v230 offset:32256
    v_mfma_f32_16x16x32_bf16 v[0:3], a[156:159], a[216:219], v[0:3]
    ds_read_b128 a[216:219], v220 offset:6144
    v_cvt_pk_bf16_f32 v101, v56, v60
    v_mfma_f32_16x16x32_bf16 v[4:7], a[156:159], a[220:223], v[4:7]
    ds_read_b128 a[220:223], v220 offset:7168
    v_cvt_pk_bf16_f32 v103, v57, v61
    v_mfma_f32_16x16x32_bf16 v[64:67], a[88:91], a[224:227], v[64:67]
    buffer_store_dwordx2 v[100:101], v235, s[8:11], s20 offen offset:1920 sc0 sc1
    v_cvt_pk_bf16_f32 v105, v58, v62
    v_mfma_f32_16x16x32_bf16 v[68:71], a[112:115], a[224:227], v[68:71]
    v_cvt_pk_bf16_f32 v107, v59, v63
    v_mfma_f32_16x16x32_bf16 v[72:75], a[136:139], a[224:227], v[72:75]
    v_mfma_f32_16x16x32_bf16 v[0:3], a[160:163], a[224:227], v[0:3]
    buffer_store_dwordx2 v[102:103], v235, s[8:11], s20 offen offset:2304 sc0 sc1
    ds_read_b128 a[224:227], v220 offset:8192
    v_mfma_f32_16x16x32_bf16 v[4:7], a[160:163], a[228:231], v[4:7]
    ds_read_b128 a[228:231], v220 offset:9216
    v_mfma_f32_16x16x32_bf16 v[64:67], a[92:95], a[232:235], v[64:67]
    v_mfma_f32_16x16x32_bf16 v[68:71], a[116:119], a[232:235], v[68:71]
    buffer_store_dwordx2 v[104:105], v237, s[8:11], s24 offen offset:1536 sc0 sc1
    v_mfma_f32_16x16x32_bf16 v[72:75], a[140:143], a[232:235], v[72:75]
    v_mfma_f32_16x16x32_bf16 v[0:3], a[164:167], a[232:235], v[0:3]
    ds_read_b128 a[232:235], v220 offset:10240
    v_mfma_f32_16x16x32_bf16 v[4:7], a[164:167], a[236:239], v[4:7]
    buffer_store_dwordx2 v[106:107], v239, s[8:11], s24 offen offset:0 sc0 sc1
    ds_read_b128 a[236:239], v220 offset:11264
    v_smfmac_f32_16x16x64_bf16 v[8:11], a[168:171], a[144:151], v228
    v_cvt_pk_bf16_f32 v204, v64, v65
    v_cvt_pk_bf16_f32 v205, v66, v67
    v_smfmac_f32_16x16x64_bf16 v[8:11], a[172:175], a[152:159], v228
    v_cvt_pk_bf16_f32 v206, v68, v69
    v_cvt_pk_bf16_f32 v207, v70, v71
    v_smfmac_f32_16x16x64_bf16 v[8:11], a[176:179], a[160:167], v228
    ds_write_b128 v222, v[204:207] offset:18432
    v_smfmac_f32_16x16x64_bf16 v[12:15], a[180:183], a[144:151], v228
    v_cvt_pk_bf16_f32 v208, v72, v73
    v_cvt_pk_bf16_f32 v209, v74, v75
    v_smfmac_f32_16x16x64_bf16 v[12:15], a[184:187], a[152:159], v228
    ds_write_b64 v229, v[208:209] offset:21504
    v_smfmac_f32_16x16x64_bf16 v[12:15], a[188:191], a[160:167], v228
    v_cvt_pk_bf16_f32 v2, v2, v3
    v_cvt_pk_bf16_f32 v6, v6, v7
    s_waitcnt lgkmcnt(6)
    v_mfma_f32_16x16x32_bf16 v[48:51], v[32:35], v[156:159], 0
    ds_write_b32 v230, v2 offset:23552
    v_mfma_f32_16x16x32_bf16 v[48:51], v[36:39], v[160:163], v[48:51]
    ds_write_b32 v230, v6 offset:23808
    v_mfma_f32_16x16x32_bf16 v[52:55], v[32:35], v[164:167], 0
    v_cvt_pk_bf16_f32 v194, v4, v5
    v_cvt_pk_bf16_f32 v210, v0, v1
    v_mfma_f32_16x16x32_bf16 v[52:55], v[36:39], v[168:171], v[52:55]
    v_add_f32 v10, v10, v11
    v_add_f32 v14, v14, v15
    v_mfma_f32_16x16x32_bf16 v[56:59], v[32:35], v[172:175], 0
    v_cndmask_b32 v231, v10, v14, s[66:67]
    v_mfma_f32_16x16x32_bf16 v[56:59], v[36:39], v[176:179], v[56:59]
    v_mfma_f32_16x16x32_bf16 v[60:63], v[32:35], v[180:183], 0
    v_mfma_f32_16x16x32_bf16 v[60:63], v[36:39], v[184:187], v[60:63]
    s_waitcnt lgkmcnt(0)
    s_barrier
    ds_read_b128 v[188:191], v222 offset:16384
    ds_read_b64 v[192:193], v229 offset:20480
    ds_read_b128 v[196:199], v222 offset:17408
    ds_read_b64 v[200:201], v229 offset:20992
    ds_read_b32 v202, v230 offset:24320
    ds_read_b128 v[212:215], v222 offset:19456
    ds_read_b64 v[216:217], v229 offset:22016
    ds_read_b32 v218, v230 offset:24064
    v_cvt_pk_bf16_f32 v108, v48, v52
    v_cvt_pk_bf16_f32 v110, v49, v53
    v_cvt_pk_bf16_f32 v112, v50, v54
    v_cvt_pk_bf16_f32 v114, v51, v55
    v_cvt_pk_bf16_f32 v109, v56, v60
L_pad10:
    s_cbranch_execz L_pad14
    v_cvt_pk_bf16_f32 v111, v57, v61
    v_cvt_pk_bf16_f32 v113, v58, v62
    v_cvt_pk_bf16_f32 v115, v59, v63
    buffer_store_dwordx2 v[108:109], v235, s[8:11], s20 offen offset:2048 sc0 sc1
    buffer_store_dwordx2 v[110:111], v235, s[8:11], s20 offen offset:2432 sc0 sc1
    buffer_store_dwordx2 v[112:113], v237, s[8:11], s24 offen offset:1664 sc0 sc1
    ds_write_b64 v227, v[92:93] offset:0
    ds_write_b64 v227, v[92:93] offset:8
    s_waitcnt lgkmcnt(9)
    v_mfma_f32_16x16x32_bf16 v[48:51], v[32:35], v[188:191], 0
    buffer_store_dwordx2 v[114:115], v239, s[8:11], s24 offen offset:128 sc0 sc1
    s_waitcnt lgkmcnt(8)
    v_mfma_f32_16x16x32_bf16 v[48:51], v[36:39], v[192:195], v[48:51]
    s_waitcnt lgkmcnt(7)
    v_mfma_f32_16x16x32_bf16 v[52:55], v[32:35], v[196:199], 0
    s_waitcnt lgkmcnt(5)
    v_mfma_f32_16x16x32_bf16 v[52:55], v[36:39], v[200:203], v[52:55]
    v_mfma_f32_16x16x32_bf16 v[56:59], v[32:35], v[204:207], 0
    v_mfma_f32_16x16x32_bf16 v[56:59], v[36:39], v[208:211], v[56:59]
    s_waitcnt lgkmcnt(2)
    v_mfma_f32_16x16x32_bf16 v[60:63], v[32:35], v[212:215], 0
    v_mfma_f32_16x16x32_bf16 v[60:63], v[36:39], v[216:219], v[60:63]
    s_nop 0
    s_nop 0
    s_nop 0
    s_nop 0
    v_cvt_pk_bf16_f32 v116, v48, v52
    v_cvt_pk_bf16_f32 v118, v49, v53
    v_cvt_pk_bf16_f32 v120, v50, v54
    v_cvt_pk_bf16_f32 v122, v51, v55
    v_cvt_pk_bf16_f32 v117, v56, v60
    v_cvt_pk_bf16_f32 v119, v57, v61
    v_cvt_pk_bf16_f32 v121, v58, v62
    v_cvt_pk_bf16_f32 v123, v59, v63
    buffer_store_dwordx2 v[116:117], v235, s[8:11], s20 offen offset:2176 sc0 sc1
    buffer_store_dwordx2 v[118:119], v235, s[8:11], s20 offen offset:2560 sc0 sc1
    buffer_store_dwordx2 v[120:121], v237, s[8:11], s24 offen offset:1792 sc0 sc1
    buffer_store_dwordx2 v[122:123], v239, s[8:11], s24 offen offset:256 sc0 sc1
    s_mov_b32 s10, 0
    s_waitcnt vmcnt(12) lgkmcnt(0)
L_b0:
L_pad3:
    s_cbranch_execz L_pad12
    s_waitcnt vmcnt(57)
    v_mfma_f32_16x16x32_bf16 v[64:67], a[192:195], a[0:3], 0
    s_sub_u32 s16, s16, 1024
    v_mov_b32 v56, 0
    v_mov_b32 v57, 0
    s_waitcnt vmcnt(56)
    v_mfma_f32_16x16x32_bf16 v[64:67], a[196:199], a[4:7], v[64:67]
    s_mul_hi_u32 s27, s16, s29
    v_cvt_pk_bf16_f32 v212, v76, v77
    v_cvt_pk_bf16_f32 v213, v78, v79
    s_waitcnt vmcnt(42)
    v_mfma_f32_16x16x32_bf16 v[64:67], a[200:203], a[8:11], v[64:67]
    s_mul_i32 s17, s27, 73
    v_cvt_pk_bf16_f32 v214, v80, v81
    v_cvt_pk_bf16_f32 v215, v82, v83
    v_mfma_f32_16x16x32_bf16 v[68:71], a[192:195], a[24:27], 0
    s_sub_u32 s17, s16, s17
    v_cvt_pk_bf16_f32 v216, v84, v85
    v_cvt_pk_bf16_f32 v217, v86, v87
    v_mfma_f32_16x16x32_bf16 v[68:71], a[196:199], a[28:31], v[68:71]
    s_mul_i32 s17, s17, 2688
    v_mov_b32 v60, 0
    v_mov_b32 v61, 0
    s_waitcnt vmcnt(36)
    v_mfma_f32_16x16x32_bf16 v[68:71], a[200:203], a[32:35], v[68:71]
    s_mul_i32 s27, s27, 1373568
    v_mul_f32 v32, v32, v249
    v_mul_f32 v33, v33, v249
    v_mfma_f32_16x16x32_bf16 v[72:75], a[192:195], a[48:51], 0
    s_add_u32 s17, s17, s27
    ds_read_b128 a[192:195], v220 offset:12288
    v_cvt_pk_bf16_f32 v32, v32, v33
    v_mfma_f32_16x16x32_bf16 v[72:75], a[196:199], a[52:55], v[72:75]
    s_lshl_b32 s30, s19, 3
    ds_read_b128 a[196:199], v220 offset:13312
    v_mul_f32 v34, v34, v249
    s_waitcnt vmcnt(31)
    v_mfma_f32_16x16x32_bf16 v[72:75], a[200:203], a[56:59], v[72:75]
    s_mul_i32 s70, s19, 10
    ds_read_b128 a[200:203], v220 offset:14336
    v_mul_f32 v35, v35, v249
    s_waitcnt lgkmcnt(3)
    v_mfma_f32_16x16x32_bf16 v[64:67], a[204:207], a[12:15], v[64:67]
    s_lshl_b64 s[52:53], s[40:41], s30
    v_cvt_pk_bf16_f32 v33, v34, v35
    v_mul_f32 v38, v38, v249
    s_waitcnt vmcnt(27)
    v_mfma_f32_16x16x32_bf16 v[64:67], a[208:211], a[16:19], v[64:67]
    s_lshl_b64 s[70:71], 1, s70
    v_mul_f32 v39, v39, v249
    v_cvt_pk_bf16_f32 v35, v38, v39
    s_waitcnt vmcnt(26)
    v_mfma_f32_16x16x32_bf16 v[64:67], a[212:215], a[20:23], v[64:67]
    s_add_u32 s19, s19, 1
    v_mul_f32 v44, v44, v249
    v_cvt_pk_bf16_f32 v38, 0, v44
    v_mfma_f32_16x16x32_bf16 v[68:71], a[204:207], a[36:39], v[68:71]
    s_waitcnt vmcnt(22)
    v_mov_b32 v44, 0
    v_mov_b32 v45, 0
    v_mfma_f32_16x16x32_bf16 v[68:71], a[208:211], a[40:43], v[68:71]
    s_waitcnt vmcnt(21)
    v_mov_b32 v46, 0
    v_mov_b32 v47, 0
    v_mfma_f32_16x16x32_bf16 v[68:71], a[212:215], a[44:47], v[68:71]
    v_cvt_pk_bf16_f32 v88, v64, v65
    v_cvt_pk_bf16_f32 v89, v66, v67
    v_mfma_f32_16x16x32_bf16 v[72:75], a[204:207], a[60:63], v[72:75]
    s_waitcnt vmcnt(19)
    ds_read_b128 a[204:207], v220 offset:15360
    v_mul_f32 v36, v36, v249
    v_mfma_f32_16x16x32_bf16 v[72:75], a[208:211], a[64:67], v[72:75]
    s_waitcnt vmcnt(18)
    ds_read_b128 a[208:211], v220 offset:16384
    v_mul_f32 v37, v37, v249
    v_mfma_f32_16x16x32_bf16 v[72:75], a[212:215], a[68:71], v[72:75]
    ds_read_b128 a[212:215], v220 offset:17408
    v_cvt_pk_bf16_f32 v92, v68, v69
    v_smfmac_f32_16x16x64_bf16 v[56:59], v[48:51], v[204:211], v228
    v_cvt_pk_bf16_f32 v93, v70, v71
    v_cvt_pk_bf16_f32 v34, v36, v37
    v_smfmac_f32_16x16x64_bf16 v[60:63], v[48:51], v[212:219], v228
    buffer_load_dwordx4 a[72:75], v223, s[4:7], s17 offen offset:0
    v_mfma_f32_16x16x32_bf16 v[8:11], v[0:3], v[204:207], 0
    buffer_load_dwordx4 a[76:79], v223, s[4:7], s17 offen offset:64
    v_mfma_f32_16x16x32_bf16 v[8:11], v[4:7], v[208:211], v[8:11]
    v_cvt_pk_bf16_f32 v96, v72, v73
    v_cvt_pk_bf16_f32 v97, v74, v75
    v_mfma_f32_16x16x32_bf16 v[12:15], v[0:3], v[212:215], 0
    v_accvgpr_write_b32 a248, v32
    v_accvgpr_write_b32 a249, v33
    v_mfma_f32_16x16x32_bf16 v[12:15], v[4:7], v[216:219], v[12:15]
    v_accvgpr_write_b32 a250, v34
    v_accvgpr_write_b32 a251, v35
    v_mfma_f32_16x16x32_bf16 v[24:27], v[16:19], v[204:207], 0
    v_mul_f32 v40, v40, v249
    v_mul_f32 v41, v41, v249
    v_mfma_f32_16x16x32_bf16 v[24:27], v[20:23], v[208:211], v[24:27]
    v_mul_f32 v42, v42, v249
    v_mul_f32 v43, v43, v249
    v_mfma_f32_16x16x32_bf16 v[28:31], v[16:19], v[212:215], 0
    v_cvt_pk_bf16_f32 v101, v8, v12
    v_cvt_pk_bf16_f32 v103, v9, v13
    v_mfma_f32_16x16x32_bf16 v[28:31], v[20:23], v[216:219], v[28:31]
    buffer_store_dwordx2 v[100:101], v233, s[8:11], s20 offen offset:256 sc0 sc1
    v_cvt_pk_bf16_f32 v105, v10, v14
    v_mfma_f32_16x16x32_bf16 v[76:79], a[216:219], a[0:3], 0
    v_cvt_pk_bf16_f32 v107, v11, v15
    v_mov_b32 v12, 0
    v_mfma_f32_16x16x32_bf16 v[76:79], a[220:223], a[4:7], v[76:79]
    v_mov_b32 v13, 0
    v_mov_b32 v14, 0
    v_mfma_f32_16x16x32_bf16 v[76:79], a[224:227], a[8:11], v[76:79]
    v_mov_b32 v15, 0
    v_cvt_pk_bf16_f32 v109, v24, v28
    v_mfma_f32_16x16x32_bf16 v[80:83], a[216:219], a[24:27], 0
    v_cvt_pk_bf16_f32 v111, v25, v29
    v_cvt_pk_bf16_f32 v113, v26, v30
    v_mfma_f32_16x16x32_bf16 v[80:83], a[220:223], a[28:31], v[80:83]
    v_cvt_pk_bf16_f32 v115, v27, v31
    v_mov_b32 v28, 0
    v_mfma_f32_16x16x32_bf16 v[80:83], a[224:227], a[32:35], v[80:83]
    v_mov_b32 v29, 0
    v_mov_b32 v30, 0
    v_mfma_f32_16x16x32_bf16 v[84:87], a[216:219], a[48:51], 0
    ds_read_b128 a[216:219], v220 offset:18432
    v_mov_b32 v31, 0
    v_mfma_f32_16x16x32_bf16 v[84:87], a[220:223], a[52:55], v[84:87]
    ds_read_b128 a[220:223], v220 offset:19456
    v_cvt_pk_bf16_f32 v36, v40, v41
    v_mfma_f32_16x16x32_bf16 v[84:87], a[224:227], a[56:59], v[84:87]
    ds_read_b128 a[224:227], v220 offset:20480
    v_cvt_pk_bf16_f32 v37, v42, v43
    v_mfma_f32_16x16x32_bf16 v[76:79], a[228:231], a[12:15], v[76:79]
    v_accvgpr_write_b32 a252, v36
    v_accvgpr_write_b32 a253, v37
    v_mfma_f32_16x16x32_bf16 v[76:79], a[232:235], a[16:19], v[76:79]
    v_accvgpr_write_b32 a254, v38
    v_add_f32 v56, v56, v57
    v_mfma_f32_16x16x32_bf16 v[76:79], a[236:239], a[20:23], v[76:79]
    v_add_f32 v60, v60, v61
    v_cvt_pk_bf16_f32 v251, v56, v60
    v_mfma_f32_16x16x32_bf16 v[80:83], a[228:231], a[36:39], v[80:83]
    buffer_store_dwordx2 v[102:103], v233, s[8:11], s21 offen offset:256 sc0 sc1
    v_cndmask_b32 v51, v244, v231, s[70:71]
    v_mfma_f32_16x16x32_bf16 v[80:83], a[232:235], a[40:43], v[80:83]
    s_add_u32 s21, s18, 196224
    v_mad_i32_i24 v55, s30, -8, v226
    v_mfma_f32_16x16x32_bf16 v[80:83], a[236:239], a[44:47], v[80:83]
    v_cvt_pk_bf16_f32 v90, v76, v77
    v_cvt_pk_bf16_f32 v91, v78, v79
    v_mfma_f32_16x16x32_bf16 v[84:87], a[228:231], a[60:63], v[84:87]
    ds_read_b128 a[228:231], v220 offset:21504
    v_mfma_f32_16x16x32_bf16 v[84:87], a[232:235], a[64:67], v[84:87]
    ds_read_b128 a[232:235], v220 offset:22528
    v_mfma_f32_16x16x32_bf16 v[84:87], a[236:239], a[68:71], v[84:87]
    ds_read_b128 a[236:239], v220 offset:23552
    v_cvt_pk_bf16_f32 v94, v80, v81
    v_smfmac_f32_16x16x64_bf16 v[12:15], a[168:171], a[0:7], v228
    v_cvt_pk_bf16_f32 v95, v82, v83
    v_smfmac_f32_16x16x64_bf16 v[12:15], a[172:175], a[8:15], v228
    v_smfmac_f32_16x16x64_bf16 v[12:15], a[176:179], a[16:23], v228
    v_smfmac_f32_16x16x64_bf16 v[28:31], a[168:171], a[24:31], v228
    v_smfmac_f32_16x16x64_bf16 v[28:31], a[172:175], a[32:39], v228
    v_cvt_pk_bf16_f32 v98, v84, v85
    v_cvt_pk_bf16_f32 v99, v86, v87
    v_smfmac_f32_16x16x64_bf16 v[28:31], a[176:179], a[40:47], v228
    v_smfmac_f32_16x16x64_bf16 v[44:47], a[168:171], a[48:55], v228
    s_waitcnt lgkmcnt(3)
    v_smfmac_f32_16x16x64_bf16 v[44:47], a[172:175], a[56:63], v228
    buffer_store_dwordx2 v[104:105], v233, s[8:11], s22 offen offset:256 sc0 sc1
    v_add_f32 v48, v14, v15
    v_smfmac_f32_16x16x64_bf16 v[44:47], a[176:179], a[64:71], v228
    s_add_u32 s22, s18, 392448
    v_add_f32 v12, v12, v13
    v_cndmask_b32 v12, v244, v12, s[52:53]
    v_mfma_f32_16x16x32_bf16 v[64:67], a[192:195], a[0:3], 0
    v_add_f32 v49, v30, v31
    v_add_f32 v28, v28, v29
    v_mfma_f32_16x16x32_bf16 v[64:67], a[196:199], a[4:7], v[64:67]
    v_cndmask_b32 v28, v244, v28, s[52:53]
    v_mfma_f32_16x16x32_bf16 v[64:67], a[200:203], a[8:11], v[64:67]
    v_add_f32 v50, v46, v47
    v_max3_f32 v52, v48, v49, v50
    v_mfma_f32_16x16x32_bf16 v[68:71], a[192:195], a[24:27], 0
    v_max_f32 v52, v52, v51
    v_add_f32 v44, v44, v45
    v_mfma_f32_16x16x32_bf16 v[68:71], a[196:199], a[28:31], v[68:71]
    v_max_f32_dpp v52, v52, v52 row_ror:8 row_mask:0xf bank_mask:0xf
    v_cndmask_b32 v44, v244, v44, s[52:53]
    v_mfma_f32_16x16x32_bf16 v[68:71], a[200:203], a[32:35], v[68:71]
    v_max_f32_dpp v52, v52, v52 row_ror:4 row_mask:0xf bank_mask:0xf
    v_mfma_f32_16x16x32_bf16 v[72:75], a[192:195], a[48:51], 0
    ds_read_b128 a[192:195], v220 offset:24576
    v_max_f32_dpp v52, v52, v52 row_ror:2 row_mask:0xf bank_mask:0xf
    v_mfma_f32_16x16x32_bf16 v[72:75], a[196:199], a[52:55], v[72:75]
    ds_read_b128 a[196:199], v220 offset:25600
    v_max_f32_dpp v52, v52, v52 row_ror:1 row_mask:0xf bank_mask:0xf
    v_mfma_f32_16x16x32_bf16 v[72:75], a[200:203], a[56:59], v[72:75]
    ds_read_b128 a[200:203], v220 offset:26624
    v_sub_f32 v48, v48, v52
    v_mfma_f32_16x16x32_bf16 v[64:67], a[204:207], a[12:15], v[64:67]
    v_sub_f32 v49, v49, v52
    v_sub_f32 v50, v50, v52
    v_mfma_f32_16x16x32_bf16 v[64:67], a[208:211], a[16:19], v[64:67]
    v_sub_f32 v51, v51, v52
    v_mfma_f32_16x16x32_bf16 v[64:67], a[212:215], a[20:23], v[64:67]
    buffer_store_dwordx2 v[106:107], v233, s[8:11], s23 offen offset:256 sc0 sc1
    v_mfma_f32_16x16x32_bf16 v[68:71], a[204:207], a[36:39], v[68:71]
    s_add_u32 s23, s18, 588672
    v_exp_f32 v48, v48
    v_mfma_f32_16x16x32_bf16 v[68:71], a[208:211], a[40:43], v[68:71]
    v_exp_f32 v49, v49
    v_mfma_f32_16x16x32_bf16 v[68:71], a[212:215], a[44:47], v[68:71]
    v_exp_f32 v50, v50
    v_mfma_f32_16x16x32_bf16 v[72:75], a[204:207], a[60:63], v[72:75]
    ds_read_b128 a[204:207], v220 offset:27648
    v_add_f32 v53, v48, v49
    v_mfma_f32_16x16x32_bf16 v[72:75], a[208:211], a[64:67], v[72:75]
    ds_read_b128 a[208:211], v220 offset:28672
    v_mfma_f32_16x16x32_bf16 v[72:75], a[212:215], a[68:71], v[72:75]
    ds_read_b128 a[212:215], v220 offset:29696
    v_mfma_f32_16x16x32_bf16 v[0:3], a[0:3], v[88:91], 0
    v_exp_f32 v51, v51
    v_mfma_f32_16x16x32_bf16 v[4:7], a[24:27], v[88:91], 0
    v_add_f32 v54, v50, v51
    v_add_f32 v53, v53, v54
    v_mfma_f32_16x16x32_bf16 v[8:11], a[48:51], v[88:91], 0
    v_cvt_pk_bf16_f32 v88, v64, v65
    v_cvt_pk_bf16_f32 v89, v66, v67
    v_mfma_f32_16x16x32_bf16 v[16:19], a[0:3], v[92:95], 0
    v_add_f32_dpp v53, v53, v53 row_ror:8 row_mask:0xf bank_mask:0xf
    v_mfma_f32_16x16x32_bf16 v[20:23], a[24:27], v[92:95], 0
    v_mfma_f32_16x16x32_bf16 v[24:27], a[48:51], v[92:95], 0
    v_cvt_pk_bf16_f32 v92, v68, v69
    v_cvt_pk_bf16_f32 v93, v70, v71
    v_mfma_f32_16x16x32_bf16 v[32:35], a[0:3], v[96:99], 0
    buffer_load_dwordx4 a[96:99], v224, s[4:7], s17 offen offset:0
    v_mfma_f32_16x16x32_bf16 v[36:39], a[24:27], v[96:99], 0
    buffer_load_dwordx4 a[100:103], v224, s[4:7], s17 offen offset:64
    v_mfma_f32_16x16x32_bf16 v[40:43], a[48:51], v[96:99], 0
    buffer_store_dwordx2 v[108:109], v233, s[8:11], s24 offen offset:256 sc0 sc1
    v_cvt_pk_bf16_f32 v96, v72, v73
    v_mfma_f32_16x16x32_bf16 v[76:79], a[216:219], a[0:3], 0
    v_cvt_pk_bf16_f32 v97, v74, v75
    v_add_f32_dpp v53, v53, v53 row_ror:4 row_mask:0xf bank_mask:0xf
    v_mfma_f32_16x16x32_bf16 v[76:79], a[220:223], a[4:7], v[76:79]
    v_mfma_f32_16x16x32_bf16 v[76:79], a[224:227], a[8:11], v[76:79]
    v_add_f32_dpp v53, v53, v53 row_ror:2 row_mask:0xf bank_mask:0xf
    v_mfma_f32_16x16x32_bf16 v[80:83], a[216:219], a[24:27], 0
    v_mfma_f32_16x16x32_bf16 v[80:83], a[220:223], a[28:31], v[80:83]
    v_add_f32_dpp v53, v53, v53 row_ror:1 row_mask:0xf bank_mask:0xf
    v_mfma_f32_16x16x32_bf16 v[80:83], a[224:227], a[32:35], v[80:83]
    v_rcp_f32 v53, v53
    v_mfma_f32_16x16x32_bf16 v[84:87], a[216:219], a[48:51], 0
    ds_read_b128 a[216:219], v220 offset:30720
    v_mul_f32 v48, v48, v53
    v_mfma_f32_16x16x32_bf16 v[84:87], a[220:223], a[52:55], v[84:87]
    ds_read_b128 a[220:223], v220 offset:31744
    v_mul_f32 v49, v49, v53
    v_mfma_f32_16x16x32_bf16 v[84:87], a[224:227], a[56:59], v[84:87]
    s_waitcnt lgkmcnt(2)
    ds_read_b128 a[224:227], v220 offset:32768
    v_mul_f32 v50, v50, v53
    v_mfma_f32_16x16x32_bf16 v[76:79], a[228:231], a[12:15], v[76:79]
    v_mul_f32 v51, v51, v53
    v_cvt_pk_bf16_f32 v52, v48, v49
    v_mfma_f32_16x16x32_bf16 v[76:79], a[232:235], a[16:19], v[76:79]
    ds_write_b16 v55, v52 offset:0
    v_mfma_f32_16x16x32_bf16 v[76:79], a[236:239], a[20:23], v[76:79]
    buffer_store_dwordx2 v[110:111], v233, s[8:11], s25 offen offset:256 sc0 sc1
    v_cvt_pk_bf16_f32 v54, v50, v51
    v_mfma_f32_16x16x32_bf16 v[80:83], a[228:231], a[36:39], v[80:83]
    ds_write_b16_d16_hi v55, v52 offset:4
    v_mfma_f32_16x16x32_bf16 v[80:83], a[232:235], a[40:43], v[80:83]
    ds_write_b16 v55, v54 offset:64
    v_mfma_f32_16x16x32_bf16 v[80:83], a[236:239], a[44:47], v[80:83]
    ds_write_b16_d16_hi v55, v54 offset:68
    v_mfma_f32_16x16x32_bf16 v[84:87], a[228:231], a[60:63], v[84:87]
    ds_read_b128 a[228:231], v220 offset:33792
    v_cvt_pk_bf16_f32 v90, v76, v77
    v_mfma_f32_16x16x32_bf16 v[84:87], a[232:235], a[64:67], v[84:87]
    ds_read_b128 a[232:235], v220 offset:34816
    v_cvt_pk_bf16_f32 v91, v78, v79
    v_mfma_f32_16x16x32_bf16 v[84:87], a[236:239], a[68:71], v[84:87]
    ds_read_b128 a[236:239], v220 offset:35840
    v_cvt_pk_bf16_f32 v94, v80, v81
    v_mfma_f32_16x16x32_bf16 v[64:67], a[192:195], a[0:3], 0
    ds_read_b128 v[48:51], v227 offset:0
    v_cvt_pk_bf16_f32 v95, v82, v83
    v_mfma_f32_16x16x32_bf16 v[64:67], a[196:199], a[4:7], v[64:67]
    v_mfma_f32_16x16x32_bf16 v[64:67], a[200:203], a[8:11], v[64:67]
    v_mfma_f32_16x16x32_bf16 v[68:71], a[192:195], a[24:27], 0
    v_cvt_pk_bf16_f32 v98, v84, v85
    v_cvt_pk_bf16_f32 v99, v86, v87
    v_mfma_f32_16x16x32_bf16 v[68:71], a[196:199], a[28:31], v[68:71]
    v_mfma_f32_16x16x32_bf16 v[68:71], a[200:203], a[32:35], v[68:71]
    buffer_store_dwordx2 v[112:113], v233, s[8:11], s26 offen offset:256 sc0 sc1
    v_mfma_f32_16x16x32_bf16 v[72:75], a[192:195], a[48:51], 0
    ds_read_b128 a[192:195], v220 offset:36864
    v_mfma_f32_16x16x32_bf16 v[72:75], a[196:199], a[52:55], v[72:75]
    ds_read_b128 a[196:199], v220 offset:37888
    v_mfma_f32_16x16x32_bf16 v[72:75], a[200:203], a[56:59], v[72:75]
    ds_read_b128 a[200:203], v220 offset:38912
    v_mfma_f32_16x16x32_bf16 v[64:67], a[204:207], a[12:15], v[64:67]
    v_mfma_f32_16x16x32_bf16 v[64:67], a[208:211], a[16:19], v[64:67]
    v_mfma_f32_16x16x32_bf16 v[64:67], a[212:215], a[20:23], v[64:67]
    v_mfma_f32_16x16x32_bf16 v[68:71], a[204:207], a[36:39], v[68:71]
    v_mfma_f32_16x16x32_bf16 v[68:71], a[208:211], a[40:43], v[68:71]
    v_mfma_f32_16x16x32_bf16 v[68:71], a[212:215], a[44:47], v[68:71]
    v_mfma_f32_16x16x32_bf16 v[72:75], a[204:207], a[60:63], v[72:75]
    ds_read_b128 a[204:207], v220 offset:39936
    v_mfma_f32_16x16x32_bf16 v[72:75], a[208:211], a[64:67], v[72:75]
    ds_read_b128 a[208:211], v220 offset:40960
    v_mfma_f32_16x16x32_bf16 v[72:75], a[212:215], a[68:71], v[72:75]
    ds_read_b128 a[212:215], v220 offset:41984
    v_mfma_f32_16x16x32_bf16 v[0:3], a[4:7], v[88:91], v[0:3]
    buffer_store_dwordx2 v[114:115], v235, s[8:11], s20 offen offset:1792 sc0 sc1
    v_mfma_f32_16x16x32_bf16 v[4:7], a[28:31], v[88:91], v[4:7]
    v_mfma_f32_16x16x32_bf16 v[8:11], a[52:55], v[88:91], v[8:11]
    v_cvt_pk_bf16_f32 v88, v64, v65
    v_cvt_pk_bf16_f32 v89, v66, v67
    v_mfma_f32_16x16x32_bf16 v[16:19], a[4:7], v[92:95], v[16:19]
    v_mfma_f32_16x16x32_bf16 v[20:23], a[28:31], v[92:95], v[20:23]
    v_mfma_f32_16x16x32_bf16 v[24:27], a[52:55], v[92:95], v[24:27]
    v_cvt_pk_bf16_f32 v92, v68, v69
    v_cvt_pk_bf16_f32 v93, v70, v71
    v_mfma_f32_16x16x32_bf16 v[32:35], a[4:7], v[96:99], v[32:35]
    v_mfma_f32_16x16x32_bf16 v[36:39], a[28:31], v[96:99], v[36:39]
    v_mfma_f32_16x16x32_bf16 v[40:43], a[52:55], v[96:99], v[40:43]
    v_cvt_pk_bf16_f32 v96, v72, v73
    v_cvt_pk_bf16_f32 v97, v74, v75
    v_mfma_f32_16x16x32_bf16 v[56:59], a[248:251], v[124:127], 0
    v_mfma_f32_16x16x32_bf16 v[56:59], a[252:255], v[128:131], v[56:59]
    v_mfma_f32_16x16x32_bf16 v[60:63], a[248:251], v[132:135], 0
    v_mfma_f32_16x16x32_bf16 v[60:63], a[252:255], v[136:139], v[60:63]
    s_waitcnt lgkmcnt(1)
    v_mfma_f32_16x16x32_bf16 v[76:79], a[216:219], a[0:3], 0
    buffer_load_dwordx4 a[120:123], v225, s[4:7], s17 offen offset:0
    v_mfma_f32_16x16x32_bf16 v[76:79], a[220:223], a[4:7], v[76:79]
    buffer_load_dwordx4 a[124:127], v225, s[4:7], s17 offen offset:64
    v_mfma_f32_16x16x32_bf16 v[76:79], a[224:227], a[8:11], v[76:79]
    buffer_store_dwordx2 v[250:251], v241, s[8:11], s26 offen offset:2560 sc0 sc1
    v_mfma_f32_16x16x32_bf16 v[80:83], a[216:219], a[24:27], 0
    v_mfma_f32_16x16x32_bf16 v[80:83], a[220:223], a[28:31], v[80:83]
    v_cvt_pk_bf16_f32 v116, v56, v60
    v_cvt_pk_bf16_f32 v118, v57, v61
    v_mfma_f32_16x16x32_bf16 v[80:83], a[224:227], a[32:35], v[80:83]
    v_cvt_pk_bf16_f32 v120, v58, v62
    v_cvt_pk_bf16_f32 v122, v59, v63
    v_mfma_f32_16x16x32_bf16 v[84:87], a[216:219], a[48:51], 0
    ds_read_b128 a[216:219], v220 offset:43008
    v_mfma_f32_16x16x32_bf16 v[84:87], a[220:223], a[52:55], v[84:87]
    ds_read_b128 a[220:223], v220 offset:44032
    v_mfma_f32_16x16x32_bf16 v[84:87], a[224:227], a[56:59], v[84:87]
    ds_read_b128 a[224:227], v220 offset:45056
    v_mfma_f32_16x16x32_bf16 v[76:79], a[228:231], a[12:15], v[76:79]
    v_mfma_f32_16x16x32_bf16 v[76:79], a[232:235], a[16:19], v[76:79]
    v_mfma_f32_16x16x32_bf16 v[76:79], a[236:239], a[20:23], v[76:79]
    v_mfma_f32_16x16x32_bf16 v[80:83], a[228:231], a[36:39], v[80:83]
    v_mfma_f32_16x16x32_bf16 v[80:83], a[232:235], a[40:43], v[80:83]
    v_mfma_f32_16x16x32_bf16 v[80:83], a[236:239], a[44:47], v[80:83]
    v_mfma_f32_16x16x32_bf16 v[84:87], a[228:231], a[60:63], v[84:87]
    ds_read_b128 a[228:231], v220 offset:46080
    v_mfma_f32_16x16x32_bf16 v[84:87], a[232:235], a[64:67], v[84:87]
    ds_read_b128 a[232:235], v220 offset:47104
    v_mfma_f32_16x16x32_bf16 v[84:87], a[236:239], a[68:71], v[84:87]
    ds_read_b128 a[236:239], v220 offset:48128
    v_cvt_pk_bf16_f32 v90, v76, v77
    v_mfma_f32_16x16x32_bf16 v[64:67], a[192:195], a[0:3], 0
    v_cvt_pk_bf16_f32 v91, v78, v79
    v_cvt_pk_bf16_f32 v94, v80, v81
    v_mfma_f32_16x16x32_bf16 v[64:67], a[196:199], a[4:7], v[64:67]
    v_cvt_pk_bf16_f32 v95, v82, v83
    v_mfma_f32_16x16x32_bf16 v[64:67], a[200:203], a[8:11], v[64:67]
    v_cvt_pk_bf16_f32 v98, v84, v85
    v_cvt_pk_bf16_f32 v99, v86, v87
    v_mfma_f32_16x16x32_bf16 v[68:71], a[192:195], a[24:27], 0
    v_mfma_f32_16x16x32_bf16 v[68:71], a[196:199], a[28:31], v[68:71]
    v_mfma_f32_16x16x32_bf16 v[68:71], a[200:203], a[32:35], v[68:71]
    v_mfma_f32_16x16x32_bf16 v[72:75], a[192:195], a[48:51], 0
    ds_read_b128 a[192:195], v220 offset:49152
    v_mfma_f32_16x16x32_bf16 v[72:75], a[196:199], a[52:55], v[72:75]
    ds_read_b128 a[196:199], v220 offset:50176
    v_mfma_f32_16x16x32_bf16 v[72:75], a[200:203], a[56:59], v[72:75]
    ds_read_b128 a[200:203], v220 offset:51200
    v_mfma_f32_16x16x32_bf16 v[64:67], a[204:207], a[12:15], v[64:67]
    v_mfma_f32_16x16x32_bf16 v[64:67], a[208:211], a[16:19], v[64:67]
    s_waitcnt lgkmcnt(6)
    v_mfma_f32_16x16x32_bf16 v[64:67], a[212:215], a[20:23], v[64:67]
    v_mfma_f32_16x16x32_bf16 v[68:71], a[204:207], a[36:39], v[68:71]
    v_mfma_f32_16x16x32_bf16 v[68:71], a[208:211], a[40:43], v[68:71]
    v_mfma_f32_16x16x32_bf16 v[68:71], a[212:215], a[44:47], v[68:71]
    v_mfma_f32_16x16x32_bf16 v[72:75], a[204:207], a[60:63], v[72:75]
    ds_read_b128 a[204:207], v220 offset:52224
    v_mfma_f32_16x16x32_bf16 v[72:75], a[208:211], a[64:67], v[72:75]
    ds_read_b128 a[208:211], v220 offset:53248
    v_mfma_f32_16x16x32_bf16 v[72:75], a[212:215], a[68:71], v[72:75]
    ds_read_b128 a[212:215], v220 offset:54272
    v_mfma_f32_16x16x32_bf16 v[56:59], a[248:251], v[140:143], 0
    v_mfma_f32_16x16x32_bf16 v[56:59], a[252:255], v[144:147], v[56:59]
    v_mfma_f32_16x16x32_bf16 v[60:63], a[248:251], v[148:151], 0
    buffer_load_dwordx4 a[80:83], v223, s[4:7], s17 offen offset:128
    v_mfma_f32_16x16x32_bf16 v[60:63], a[252:255], v[152:155], v[60:63]
    buffer_load_dwordx4 a[84:87], v223, s[4:7], s17 offen offset:192
    v_mfma_f32_16x16x32_bf16 v[0:3], a[8:11], v[88:91], v[0:3]
    v_mfma_f32_16x16x32_bf16 v[4:7], a[32:35], v[88:91], v[4:7]
    v_mfma_f32_16x16x32_bf16 v[8:11], a[56:59], v[88:91], v[8:11]
    v_cvt_pk_bf16_f32 v88, v64, v65
    v_cvt_pk_bf16_f32 v89, v66, v67
    v_mfma_f32_16x16x32_bf16 v[16:19], a[8:11], v[92:95], v[16:19]
    v_mfma_f32_16x16x32_bf16 v[20:23], a[32:35], v[92:95], v[20:23]
    v_cvt_pk_bf16_f32 v117, v56, v60
    v_cvt_pk_bf16_f32 v119, v57, v61
    v_mfma_f32_16x16x32_bf16 v[24:27], a[56:59], v[92:95], v[24:27]
    buffer_store_dwordx2 v[116:117], v235, s[8:11], s20 offen offset:1920 sc0 sc1
    v_cvt_pk_bf16_f32 v121, v58, v62
    v_mfma_f32_16x16x32_bf16 v[32:35], a[8:11], v[96:99], v[32:35]
    v_cvt_pk_bf16_f32 v123, v59, v63
    v_cvt_pk_bf16_f32 v92, v68, v69
    v_mfma_f32_16x16x32_bf16 v[36:39], a[32:35], v[96:99], v[36:39]
    v_cvt_pk_bf16_f32 v93, v70, v71
    v_mfma_f32_16x16x32_bf16 v[40:43], a[56:59], v[96:99], v[40:43]
    v_cvt_pk_bf16_f32 v96, v72, v73
    v_cvt_pk_bf16_f32 v97, v74, v75
    v_mfma_f32_16x16x32_bf16 v[76:79], a[216:219], a[0:3], 0
    v_mfma_f32_16x16x32_bf16 v[76:79], a[220:223], a[4:7], v[76:79]
    v_mfma_f32_16x16x32_bf16 v[76:79], a[224:227], a[8:11], v[76:79]
    v_mfma_f32_16x16x32_bf16 v[80:83], a[216:219], a[24:27], 0
    v_mfma_f32_16x16x32_bf16 v[80:83], a[220:223], a[28:31], v[80:83]
    v_mfma_f32_16x16x32_bf16 v[80:83], a[224:227], a[32:35], v[80:83]
    v_mfma_f32_16x16x32_bf16 v[84:87], a[216:219], a[48:51], 0
    ds_read_b128 a[216:219], v220 offset:55296
    v_mfma_f32_16x16x32_bf16 v[84:87], a[220:223], a[52:55], v[84:87]
    ds_read_b128 a[220:223], v220 offset:56320
    v_mfma_f32_16x16x32_bf16 v[84:87], a[224:227], a[56:59], v[84:87]
    s_waitcnt lgkmcnt(2)
    ds_read_b128 a[224:227], v220 offset:57344
    v_mfma_f32_16x16x32_bf16 v[76:79], a[228:231], a[12:15], v[76:79]
    buffer_store_dwordx2 v[118:119], v235, s[8:11], s20 offen offset:2304 sc0 sc1
    v_mfma_f32_16x16x32_bf16 v[76:79], a[232:235], a[16:19], v[76:79]
    v_mfma_f32_16x16x32_bf16 v[76:79], a[236:239], a[20:23], v[76:79]
    v_mfma_f32_16x16x32_bf16 v[80:83], a[228:231], a[36:39], v[80:83]
    v_mfma_f32_16x16x32_bf16 v[80:83], a[232:235], a[40:43], v[80:83]
    v_mfma_f32_16x16x32_bf16 v[80:83], a[236:239], a[44:47], v[80:83]
    v_mfma_f32_16x16x32_bf16 v[84:87], a[228:231], a[60:63], v[84:87]
    ds_read_b128 a[228:231], v220 offset:58368
    v_mfma_f32_16x16x32_bf16 v[84:87], a[232:235], a[64:67], v[84:87]
    ds_read_b128 a[232:235], v220 offset:59392
    v_mfma_f32_16x16x32_bf16 v[84:87], a[236:239], a[68:71], v[84:87]
    ds_read_b128 a[236:239], v220 offset:60416
    v_cvt_pk_bf16_f32 v90, v76, v77
    v_mfma_f32_16x16x32_bf16 v[56:59], a[248:251], v[156:159], 0
    v_cvt_pk_bf16_f32 v91, v78, v79
    v_cvt_pk_bf16_f32 v94, v80, v81
    v_mfma_f32_16x16x32_bf16 v[56:59], a[252:255], v[160:163], v[56:59]
    v_cvt_pk_bf16_f32 v95, v82, v83
    v_mfma_f32_16x16x32_bf16 v[60:63], a[248:251], v[164:167], 0
    v_cvt_pk_bf16_f32 v98, v84, v85
    v_cvt_pk_bf16_f32 v99, v86, v87
    v_mfma_f32_16x16x32_bf16 v[60:63], a[252:255], v[168:171], v[60:63]
    v_mfma_f32_16x16x32_bf16 v[64:67], a[192:195], a[0:3], 0
    buffer_store_dwordx2 v[120:121], v237, s[8:11], s24 offen offset:1536 sc0 sc1
    v_mfma_f32_16x16x32_bf16 v[64:67], a[196:199], a[4:7], v[64:67]
    v_mfma_f32_16x16x32_bf16 v[64:67], a[200:203], a[8:11], v[64:67]
    v_mfma_f32_16x16x32_bf16 v[68:71], a[192:195], a[24:27], 0
    v_mfma_f32_16x16x32_bf16 v[68:71], a[196:199], a[28:31], v[68:71]
    v_mfma_f32_16x16x32_bf16 v[68:71], a[200:203], a[32:35], v[68:71]
    v_mfma_f32_16x16x32_bf16 v[72:75], a[192:195], a[48:51], 0
    ds_read_b128 a[192:195], v220 offset:61440
    v_cvt_pk_bf16_f32 v100, v56, v60
    v_mfma_f32_16x16x32_bf16 v[72:75], a[196:199], a[52:55], v[72:75]
    ds_read_b128 a[196:199], v220 offset:62464
    v_cvt_pk_bf16_f32 v102, v57, v61
    v_mfma_f32_16x16x32_bf16 v[72:75], a[200:203], a[56:59], v[72:75]
    ds_read_b128 a[200:203], v220 offset:63488
    v_cvt_pk_bf16_f32 v104, v58, v62
    v_mfma_f32_16x16x32_bf16 v[64:67], a[204:207], a[12:15], v[64:67]
    v_cvt_pk_bf16_f32 v106, v59, v63
    v_mfma_f32_16x16x32_bf16 v[64:67], a[208:211], a[16:19], v[64:67]
    v_mfma_f32_16x16x32_bf16 v[64:67], a[212:215], a[20:23], v[64:67]
    v_mfma_f32_16x16x32_bf16 v[68:71], a[204:207], a[36:39], v[68:71]
    v_mfma_f32_16x16x32_bf16 v[68:71], a[208:211], a[40:43], v[68:71]
    buffer_store_dwordx2 v[122:123], v239, s[8:11], s24 offen offset:0 sc0 sc1
    v_mfma_f32_16x16x32_bf16 v[68:71], a[212:215], a[44:47], v[68:71]
    v_mfma_f32_16x16x32_bf16 v[72:75], a[204:207], a[60:63], v[72:75]
    ds_read_b128 a[204:207], v220 offset:64512
    v_mfma_f32_16x16x32_bf16 v[72:75], a[208:211], a[64:67], v[72:75]
    ds_read_b128 a[208:211], v221 offset:0
    v_mfma_f32_16x16x32_bf16 v[72:75], a[212:215], a[68:71], v[72:75]
    ds_read_b128 a[212:215], v221 offset:1024
    v_mfma_f32_16x16x32_bf16 v[0:3], a[12:15], v[88:91], v[0:3]
    v_mfma_f32_16x16x32_bf16 v[4:7], a[36:39], v[88:91], v[4:7]
    v_mfma_f32_16x16x32_bf16 v[8:11], a[60:63], v[88:91], v[8:11]
    v_cvt_pk_bf16_f32 v88, v64, v65
    v_cvt_pk_bf16_f32 v89, v66, v67
    v_mfma_f32_16x16x32_bf16 v[16:19], a[12:15], v[92:95], v[16:19]
    v_mfma_f32_16x16x32_bf16 v[20:23], a[36:39], v[92:95], v[20:23]
    v_mfma_f32_16x16x32_bf16 v[24:27], a[60:63], v[92:95], v[24:27]
    v_cvt_pk_bf16_f32 v92, v68, v69
    v_cvt_pk_bf16_f32 v93, v70, v71
    v_mfma_f32_16x16x32_bf16 v[32:35], a[12:15], v[96:99], v[32:35]
    v_mfma_f32_16x16x32_bf16 v[36:39], a[36:39], v[96:99], v[36:39]
    v_mfma_f32_16x16x32_bf16 v[40:43], a[60:63], v[96:99], v[40:43]
    buffer_load_dwordx4 a[104:107], v224, s[4:7], s17 offen offset:128
    v_mfma_f32_16x16x32_bf16 v[56:59], a[248:251], v[172:175], 0
    buffer_load_dwordx4 a[108:111], v224, s[4:7], s17 offen offset:192
    v_mfma_f32_16x16x32_bf16 v[56:59], a[252:255], v[176:179], v[56:59]
    v_cvt_pk_bf16_f32 v96, v72, v73
    v_cvt_pk_bf16_f32 v97, v74, v75
    v_mfma_f32_16x16x32_bf16 v[60:63], a[248:251], v[180:183], 0
    v_mfma_f32_16x16x32_bf16 v[60:63], a[252:255], v[184:187], v[60:63]
    s_waitcnt lgkmcnt(1)
    v_mfma_f32_16x16x32_bf16 v[76:79], a[216:219], a[0:3], 0
    v_mfma_f32_16x16x32_bf16 v[76:79], a[220:223], a[4:7], v[76:79]
    v_mfma_f32_16x16x32_bf16 v[76:79], a[224:227], a[8:11], v[76:79]
    v_mfma_f32_16x16x32_bf16 v[80:83], a[216:219], a[24:27], 0
L_pad11:
    s_cbranch_execz L_pad15
    v_mfma_f32_16x16x32_bf16 v[80:83], a[220:223], a[28:31], v[80:83]
    v_mfma_f32_16x16x32_bf16 v[80:83], a[224:227], a[32:35], v[80:83]
    v_mfma_f32_16x16x32_bf16 v[84:87], a[216:219], a[48:51], 0
    ds_read_b128 a[216:219], v221 offset:2048
    v_cvt_pk_bf16_f32 v101, v56, v60
    v_mfma_f32_16x16x32_bf16 v[84:87], a[220:223], a[52:55], v[84:87]
    ds_read_b128 a[220:223], v221 offset:3072
    v_cvt_pk_bf16_f32 v103, v57, v61
    v_mfma_f32_16x16x32_bf16 v[84:87], a[224:227], a[56:59], v[84:87]
    ds_read_b128 a[224:227], v221 offset:4096
    v_cvt_pk_bf16_f32 v105, v58, v62
    v_mfma_f32_16x16x32_bf16 v[76:79], a[228:231], a[12:15], v[76:79]
    buffer_store_dwordx2 v[100:101], v235, s[8:11], s20 offen offset:2048 sc0 sc1
    v_cvt_pk_bf16_f32 v107, v59, v63
    v_mfma_f32_16x16x32_bf16 v[76:79], a[232:235], a[16:19], v[76:79]
    v_mfma_f32_16x16x32_bf16 v[76:79], a[236:239], a[20:23], v[76:79]
    v_mfma_f32_16x16x32_bf16 v[80:83], a[228:231], a[36:39], v[80:83]
    v_mfma_f32_16x16x32_bf16 v[80:83], a[232:235], a[40:43], v[80:83]
    v_mfma_f32_16x16x32_bf16 v[80:83], a[236:239], a[44:47], v[80:83]
    v_mfma_f32_16x16x32_bf16 v[84:87], a[228:231], a[60:63], v[84:87]
    ds_read_b128 a[228:231], v221 offset:5120
    v_mfma_f32_16x16x32_bf16 v[84:87], a[232:235], a[64:67], v[84:87]
    ds_read_b128 a[232:235], v221 offset:6144
    v_mfma_f32_16x16x32_bf16 v[84:87], a[236:239], a[68:71], v[84:87]
    ds_read_b128 a[236:239], v221 offset:7168
    v_cvt_pk_bf16_f32 v90, v76, v77
    v_mfma_f32_16x16x32_bf16 v[64:67], a[192:195], a[0:3], 0
    v_cvt_pk_bf16_f32 v91, v78, v79
    v_cvt_pk_bf16_f32 v94, v80, v81
    v_mfma_f32_16x16x32_bf16 v[64:67], a[196:199], a[4:7], v[64:67]
    v_cvt_pk_bf16_f32 v95, v82, v83
    v_mfma_f32_16x16x32_bf16 v[64:67], a[200:203], a[8:11], v[64:67]
    v_cvt_pk_bf16_f32 v98, v84, v85
    v_cvt_pk_bf16_f32 v99, v86, v87
    v_mfma_f32_16x16x32_bf16 v[68:71], a[192:195], a[24:27], 0
    v_mfma_f32_16x16x32_bf16 v[68:71], a[196:199], a[28:31], v[68:71]
    buffer_load_dword v243, v242, s[84:87], s88 offen
    v_mfma_f32_16x16x32_bf16 v[68:71], a[200:203], a[32:35], v[68:71]
    buffer_store_dwordx2 v[102:103], v235, s[8:11], s20 offen offset:2432 sc0 sc1
    v_mfma_f32_16x16x32_bf16 v[72:75], a[192:195], a[48:51], 0
    ds_read_b128 a[192:195], v221 offset:8192
    v_mfma_f32_16x16x32_bf16 v[72:75], a[196:199], a[52:55], v[72:75]
    ds_read_b128 a[196:199], v221 offset:9216
    v_mfma_f32_16x16x32_bf16 v[72:75], a[200:203], a[56:59], v[72:75]
    ds_read_b128 a[200:203], v221 offset:10240
    v_mfma_f32_16x16x32_bf16 v[64:67], a[204:207], a[12:15], v[64:67]
    v_mfma_f32_16x16x32_bf16 v[64:67], a[208:211], a[16:19], v[64:67]
    s_waitcnt lgkmcnt(6)
    v_mfma_f32_16x16x32_bf16 v[64:67], a[212:215], a[20:23], v[64:67]
    v_mfma_f32_16x16x32_bf16 v[68:71], a[204:207], a[36:39], v[68:71]
    v_mfma_f32_16x16x32_bf16 v[68:71], a[208:211], a[40:43], v[68:71]
    v_mfma_f32_16x16x32_bf16 v[68:71], a[212:215], a[44:47], v[68:71]
    v_mfma_f32_16x16x32_bf16 v[72:75], a[204:207], a[60:63], v[72:75]
    ds_read_b128 a[204:207], v221 offset:11264
    v_mfma_f32_16x16x32_bf16 v[72:75], a[208:211], a[64:67], v[72:75]
    ds_read_b128 a[208:211], v221 offset:12288
    v_mfma_f32_16x16x32_bf16 v[72:75], a[212:215], a[68:71], v[72:75]
    ds_read_b128 a[212:215], v221 offset:13312
    v_mfma_f32_16x16x32_bf16 v[56:59], a[248:251], v[188:191], 0
    buffer_load_dwordx4 a[128:131], v225, s[4:7], s17 offen offset:128
    v_mfma_f32_16x16x32_bf16 v[56:59], a[252:255], v[192:195], v[56:59]
    buffer_load_dwordx4 a[132:135], v225, s[4:7], s17 offen offset:192
    v_mfma_f32_16x16x32_bf16 v[60:63], a[248:251], v[196:199], 0
    v_mfma_f32_16x16x32_bf16 v[60:63], a[252:255], v[200:203], v[60:63]
    v_mfma_f32_16x16x32_bf16 v[0:3], a[16:19], v[88:91], v[0:3]
    v_mfma_f32_16x16x32_bf16 v[4:7], a[40:43], v[88:91], v[4:7]
    v_mfma_f32_16x16x32_bf16 v[8:11], a[64:67], v[88:91], v[8:11]
    buffer_store_dwordx2 v[104:105], v237, s[8:11], s24 offen offset:1664 sc0 sc1
    v_cvt_pk_bf16_f32 v88, v64, v65
    v_mfma_f32_16x16x32_bf16 v[16:19], a[16:19], v[92:95], v[16:19]
    v_cvt_pk_bf16_f32 v89, v66, v67
    v_mfma_f32_16x16x32_bf16 v[20:23], a[40:43], v[92:95], v[20:23]
    v_cvt_pk_bf16_f32 v108, v56, v60
    v_cvt_pk_bf16_f32 v110, v57, v61
    v_mfma_f32_16x16x32_bf16 v[24:27], a[64:67], v[92:95], v[24:27]
    v_cvt_pk_bf16_f32 v112, v58, v62
    v_cvt_pk_bf16_f32 v114, v59, v63
    v_mfma_f32_16x16x32_bf16 v[32:35], a[16:19], v[96:99], v[32:35]
    v_cvt_pk_bf16_f32 v92, v68, v69
    v_cvt_pk_bf16_f32 v93, v70, v71
    v_mfma_f32_16x16x32_bf16 v[36:39], a[40:43], v[96:99], v[36:39]
    v_mfma_f32_16x16x32_bf16 v[40:43], a[64:67], v[96:99], v[40:43]
    v_cvt_pk_bf16_f32 v96, v72, v73
    v_cvt_pk_bf16_f32 v97, v74, v75
    v_mfma_f32_16x16x32_bf16 v[76:79], a[216:219], a[0:3], 0
    v_mfma_f32_16x16x32_bf16 v[76:79], a[220:223], a[4:7], v[76:79]
    v_mfma_f32_16x16x32_bf16 v[76:79], a[224:227], a[8:11], v[76:79]
    v_mfma_f32_16x16x32_bf16 v[80:83], a[216:219], a[24:27], 0
    v_mfma_f32_16x16x32_bf16 v[80:83], a[220:223], a[28:31], v[80:83]
    v_mfma_f32_16x16x32_bf16 v[80:83], a[224:227], a[32:35], v[80:83]
    v_mfma_f32_16x16x32_bf16 v[84:87], a[216:219], a[48:51], 0
    ds_read_b128 a[216:219], v221 offset:14336
    v_mfma_f32_16x16x32_bf16 v[84:87], a[220:223], a[52:55], v[84:87]
    ds_read_b128 a[220:223], v221 offset:15360
    v_mfma_f32_16x16x32_bf16 v[84:87], a[224:227], a[56:59], v[84:87]
    s_waitcnt lgkmcnt(2)
    ds_read_b128 a[224:227], v221 offset:16384
    v_mfma_f32_16x16x32_bf16 v[76:79], a[228:231], a[12:15], v[76:79]
    v_mfma_f32_16x16x32_bf16 v[76:79], a[232:235], a[16:19], v[76:79]
    v_mfma_f32_16x16x32_bf16 v[76:79], a[236:239], a[20:23], v[76:79]
    v_mfma_f32_16x16x32_bf16 v[80:83], a[228:231], a[36:39], v[80:83]
    buffer_store_dwordx2 v[106:107], v239, s[8:11], s24 offen offset:128 sc0 sc1
    v_mfma_f32_16x16x32_bf16 v[80:83], a[232:235], a[40:43], v[80:83]
    v_mfma_f32_16x16x32_bf16 v[80:83], a[236:239], a[44:47], v[80:83]
    v_mfma_f32_16x16x32_bf16 v[84:87], a[228:231], a[60:63], v[84:87]
    ds_read_b128 a[228:231], v221 offset:17408
    v_mfma_f32_16x16x32_bf16 v[84:87], a[232:235], a[64:67], v[84:87]
    ds_read_b128 a[232:235], v221 offset:18432
    v_cvt_pk_bf16_f32 v90, v76, v77
    v_mfma_f32_16x16x32_bf16 v[84:87], a[236:239], a[68:71], v[84:87]
    ds_read_b128 a[236:239], v221 offset:19456
    v_cvt_pk_bf16_f32 v91, v78, v79
    v_mfma_f32_16x16x32_bf16 v[56:59], a[248:251], v[204:207], 0
    v_cvt_pk_bf16_f32 v94, v80, v81
    v_cvt_pk_bf16_f32 v95, v82, v83
    v_mfma_f32_16x16x32_bf16 v[56:59], a[252:255], v[208:211], v[56:59]
    v_mfma_f32_16x16x32_bf16 v[60:63], a[248:251], v[212:215], 0
    v_mfma_f32_16x16x32_bf16 v[60:63], a[252:255], v[216:219], v[60:63]
    v_cvt_pk_bf16_f32 v98, v84, v85
    v_cvt_pk_bf16_f32 v99, v86, v87
    v_mfma_f32_16x16x32_bf16 v[64:67], a[0:3], a[192:195], 0
    v_mfma_f32_16x16x32_bf16 v[64:67], a[4:7], a[196:199], v[64:67]
    v_mfma_f32_16x16x32_bf16 v[64:67], a[8:11], a[200:203], v[64:67]
    v_mfma_f32_16x16x32_bf16 v[68:71], a[24:27], a[192:195], 0
    v_mfma_f32_16x16x32_bf16 v[68:71], a[28:31], a[196:199], v[68:71]
    v_mfma_f32_16x16x32_bf16 v[68:71], a[32:35], a[200:203], v[68:71]
    v_cvt_pk_bf16_f32 v109, v56, v60
    v_cvt_pk_bf16_f32 v111, v57, v61
    v_mfma_f32_16x16x32_bf16 v[72:75], a[48:51], a[192:195], 0
    ds_read_b128 a[192:195], v221 offset:20480
    v_mov_b32 v56, 0
    v_mfma_f32_16x16x32_bf16 v[72:75], a[52:55], a[196:199], v[72:75]
    ds_read_b128 a[196:199], v221 offset:21504
    v_mov_b32 v57, 0
    v_mfma_f32_16x16x32_bf16 v[72:75], a[56:59], a[200:203], v[72:75]
    ds_read_b128 a[200:203], v221 offset:22528
    v_cvt_pk_bf16_f32 v113, v58, v62
    v_mfma_f32_16x16x32_bf16 v[64:67], a[12:15], a[204:207], v[64:67]
    v_cvt_pk_bf16_f32 v115, v59, v63
    v_mov_b32 v60, 0
    v_mfma_f32_16x16x32_bf16 v[64:67], a[16:19], a[208:211], v[64:67]
    v_mov_b32 v61, 0
    v_mfma_f32_16x16x32_bf16 v[64:67], a[20:23], a[212:215], v[64:67]
    v_mfma_f32_16x16x32_bf16 v[68:71], a[36:39], a[204:207], v[68:71]
    v_mfma_f32_16x16x32_bf16 v[68:71], a[40:43], a[208:211], v[68:71]
    v_mfma_f32_16x16x32_bf16 v[68:71], a[44:47], a[212:215], v[68:71]
    v_mfma_f32_16x16x32_bf16 v[72:75], a[60:63], a[204:207], v[72:75]
    buffer_load_dwordx4 a[88:91], v223, s[4:7], s17 offen offset:256
    v_mfma_f32_16x16x32_bf16 v[72:75], a[64:67], a[208:211], v[72:75]
    buffer_load_dwordx4 a[92:95], v223, s[4:7], s17 offen offset:320
    v_mfma_f32_16x16x32_bf16 v[72:75], a[68:71], a[212:215], v[72:75]
    ds_read_b128 a[204:207], v221 offset:23552
    ds_read_b128 a[208:211], v221 offset:24576
    v_mfma_f32_16x16x32_bf16 v[0:3], a[20:23], v[88:91], v[0:3]
    ds_read_b128 a[212:215], v221 offset:25600
    v_cvt_pk_bf16_f32 v124, v64, v65
    v_mfma_f32_16x16x32_bf16 v[4:7], a[44:47], v[88:91], v[4:7]
    v_cvt_pk_bf16_f32 v125, v66, v67
    v_cvt_pk_bf16_f32 v126, v68, v69
    v_mfma_f32_16x16x32_bf16 v[8:11], a[68:71], v[88:91], v[8:11]
    v_cvt_pk_bf16_f32 v127, v70, v71
    v_cvt_pk_bf16_f32 v128, v72, v73
    v_mfma_f32_16x16x32_bf16 v[16:19], a[20:23], v[92:95], v[16:19]
    buffer_store_dwordx2 v[108:109], v235, s[8:11], s20 offen offset:2176 sc0 sc1
    v_cvt_pk_bf16_f32 v129, v74, v75
    v_mfma_f32_16x16x32_bf16 v[20:23], a[44:47], v[92:95], v[20:23]
    v_max3_f32 v245, v0, v1, v2
    v_max3_f32 v246, v3, v4, v5
    v_mfma_f32_16x16x32_bf16 v[24:27], a[68:71], v[92:95], v[24:27]
    v_max3_f32 v245, v245, v6, v7
    v_max3_f32 v246, v246, v8, v9
    v_mfma_f32_16x16x32_bf16 v[32:35], a[20:23], v[96:99], v[32:35]
    v_max3_f32 v245, v245, v10, v11
    v_max3_f32 v245, v245, v246, v12
    v_mfma_f32_16x16x32_bf16 v[36:39], a[44:47], v[96:99], v[36:39]
    v_mov_b32 v246, v245
    v_max3_f32 v250, v16, v17, v18
    v_mfma_f32_16x16x32_bf16 v[40:43], a[68:71], v[96:99], v[40:43]
    s_waitcnt lgkmcnt(3)
    v_permlane32_swap_b32 v245, v246
    v_mfma_f32_16x16x32_bf16 v[76:79], a[0:3], a[216:219], 0
    v_max_f32 v245, v245, v246
    v_mov_b32 v246, v245
    v_mfma_f32_16x16x32_bf16 v[76:79], a[4:7], a[220:223], v[76:79]
    v_max3_f32 v251, v19, v20, v21
    v_max3_f32 v250, v250, v22, v23
    v_mfma_f32_16x16x32_bf16 v[76:79], a[8:11], a[224:227], v[76:79]
    v_permlane16_swap_b32 v245, v246
    v_mfma_f32_16x16x32_bf16 v[80:83], a[24:27], a[216:219], 0
    v_max_f32 v245, v245, v246
    v_sub_f32 v0, v0, v245
    v_mfma_f32_16x16x32_bf16 v[80:83], a[28:31], a[220:223], v[80:83]
    v_sub_f32 v1, v1, v245
    v_sub_f32 v2, v2, v245
    v_mfma_f32_16x16x32_bf16 v[80:83], a[32:35], a[224:227], v[80:83]
    v_exp_f32 v0, v0
    v_mfma_f32_16x16x32_bf16 v[84:87], a[48:51], a[216:219], 0
    ds_read_b128 a[216:219], v221 offset:26624
    v_sub_f32 v3, v3, v245
    v_mfma_f32_16x16x32_bf16 v[84:87], a[52:55], a[220:223], v[84:87]
    ds_read_b128 a[220:223], v221 offset:27648
    v_sub_f32 v4, v4, v245
    v_mfma_f32_16x16x32_bf16 v[84:87], a[56:59], a[224:227], v[84:87]
    ds_read_b128 a[224:227], v221 offset:28672
    v_sub_f32 v5, v5, v245
    v_mfma_f32_16x16x32_bf16 v[76:79], a[12:15], a[228:231], v[76:79]
    v_exp_f32 v1, v1
    v_mfma_f32_16x16x32_bf16 v[76:79], a[16:19], a[232:235], v[76:79]
    v_exp_f32 v2, v2
    v_mfma_f32_16x16x32_bf16 v[76:79], a[20:23], a[236:239], v[76:79]
    v_exp_f32 v3, v3
    v_mfma_f32_16x16x32_bf16 v[80:83], a[36:39], a[228:231], v[80:83]
    v_exp_f32 v4, v4
    v_mfma_f32_16x16x32_bf16 v[80:83], a[40:43], a[232:235], v[80:83]
    buffer_store_dwordx2 v[110:111], v235, s[8:11], s20 offen offset:2560 sc0 sc1
    v_sub_f32 v6, v6, v245
    v_mfma_f32_16x16x32_bf16 v[80:83], a[44:47], a[236:239], v[80:83]
    s_mov_b32 s20, s18
    v_cvt_pk_bf16_f32 v132, v76, v77
    v_cvt_pk_bf16_f32 v133, v78, v79
    v_mfma_f32_16x16x32_bf16 v[84:87], a[60:63], a[228:231], v[84:87]
    ds_read_b128 a[228:231], v221 offset:29696
    v_sub_f32 v7, v7, v245
    v_mfma_f32_16x16x32_bf16 v[84:87], a[64:67], a[232:235], v[84:87]
    ds_read_b128 a[232:235], v221 offset:30720
    v_sub_f32 v8, v8, v245
    v_mfma_f32_16x16x32_bf16 v[84:87], a[68:71], a[236:239], v[84:87]
    ds_read_b128 a[236:239], v221 offset:31744
    v_cvt_pk_bf16_f32 v134, v80, v81
    v_mfma_f32_16x16x32_bf16 v[64:67], a[0:3], a[192:195], 0
    v_cvt_pk_bf16_f32 v135, v82, v83
    v_add_f32 v247, v0, v1
    v_mfma_f32_16x16x32_bf16 v[64:67], a[4:7], a[196:199], v[64:67]
    v_exp_f32 v5, v5
    v_mfma_f32_16x16x32_bf16 v[64:67], a[8:11], a[200:203], v[64:67]
    v_cvt_pk_bf16_f32 v136, v84, v85
    v_cvt_pk_bf16_f32 v137, v86, v87
    v_mfma_f32_16x16x32_bf16 v[68:71], a[24:27], a[192:195], 0
    v_exp_f32 v6, v6
    v_mfma_f32_16x16x32_bf16 v[68:71], a[28:31], a[196:199], v[68:71]
    v_exp_f32 v7, v7
    v_mfma_f32_16x16x32_bf16 v[68:71], a[32:35], a[200:203], v[68:71]
    v_exp_f32 v8, v8
    v_mfma_f32_16x16x32_bf16 v[72:75], a[48:51], a[192:195], 0
    ds_read_b128 a[192:195], v221 offset:32768
    v_sub_f32 v9, v9, v245
    v_mfma_f32_16x16x32_bf16 v[72:75], a[52:55], a[196:199], v[72:75]
    ds_read_b128 a[196:199], v221 offset:33792
    v_sub_f32 v10, v10, v245
    v_mfma_f32_16x16x32_bf16 v[72:75], a[56:59], a[200:203], v[72:75]
    s_waitcnt lgkmcnt(5)
    ds_read_b128 a[200:203], v221 offset:34816
    v_add_f32 v248, v2, v3
    v_mfma_f32_16x16x32_bf16 v[64:67], a[12:15], a[204:207], v[64:67]
    v_add_f32 v247, v247, v4
    v_sub_f32 v11, v11, v245
    v_mfma_f32_16x16x32_bf16 v[64:67], a[16:19], a[208:211], v[64:67]
    v_exp_f32 v9, v9
    v_mfma_f32_16x16x32_bf16 v[64:67], a[20:23], a[212:215], v[64:67]
    v_exp_f32 v10, v10
    v_mfma_f32_16x16x32_bf16 v[68:71], a[36:39], a[204:207], v[68:71]
    v_sub_f32 v12, v12, v245
    v_add_f32 v248, v248, v5
    v_mfma_f32_16x16x32_bf16 v[68:71], a[40:43], a[208:211], v[68:71]
    v_add_f32 v247, v247, v6
    v_add_f32 v248, v248, v7
    v_mfma_f32_16x16x32_bf16 v[68:71], a[44:47], a[212:215], v[68:71]
    buffer_store_dwordx2 v[112:113], v237, s[8:11], s24 offen offset:1792 sc0 sc1
    v_cvt_pk_bf16_f32 v140, v64, v65
    v_mfma_f32_16x16x32_bf16 v[72:75], a[60:63], a[204:207], v[72:75]
    ds_read_b128 a[204:207], v221 offset:35840
    v_cvt_pk_bf16_f32 v141, v66, v67
    v_mfma_f32_16x16x32_bf16 v[72:75], a[64:67], a[208:211], v[72:75]
    ds_read_b128 a[208:211], v221 offset:36864
    v_add_f32 v247, v247, v8
    v_mfma_f32_16x16x32_bf16 v[72:75], a[68:71], a[212:215], v[72:75]
    ds_read_b128 a[212:215], v221 offset:37888
    v_cvt_pk_bf16_f32 v142, v68, v69
    v_mfma_f32_16x16x32_bf16 v[76:79], a[0:3], a[216:219], 0
    v_cvt_pk_bf16_f32 v143, v70, v71
    v_add_f32 v248, v248, v9
    v_mfma_f32_16x16x32_bf16 v[76:79], a[4:7], a[220:223], v[76:79]
    v_exp_f32 v11, v11
    v_mfma_f32_16x16x32_bf16 v[76:79], a[8:11], a[224:227], v[76:79]
    v_cvt_pk_bf16_f32 v144, v72, v73
    v_cvt_pk_bf16_f32 v145, v74, v75
    v_mfma_f32_16x16x32_bf16 v[80:83], a[24:27], a[216:219], 0
    v_exp_f32 v12, v12
    v_mfma_f32_16x16x32_bf16 v[80:83], a[28:31], a[220:223], v[80:83]
    v_add_f32 v247, v247, v10
    v_add_f32 v248, v248, v11
    v_mfma_f32_16x16x32_bf16 v[80:83], a[32:35], a[224:227], v[80:83]
    v_add_f32 v247, v247, v12
    v_add_f32 v247, v247, v248
    v_mfma_f32_16x16x32_bf16 v[84:87], a[48:51], a[216:219], 0
    ds_read_b128 a[216:219], v221 offset:38912
    v_mov_b32 v248, v247
    v_mfma_f32_16x16x32_bf16 v[84:87], a[52:55], a[220:223], v[84:87]
    ds_read_b128 a[220:223], v221 offset:39936
    v_max3_f32 v251, v251, v24, v25
    v_mfma_f32_16x16x32_bf16 v[84:87], a[56:59], a[224:227], v[84:87]
    s_waitcnt lgkmcnt(5)
    ds_read_b128 a[224:227], v221 offset:40960
    v_max3_f32 v250, v250, v26, v27
    v_mfma_f32_16x16x32_bf16 v[76:79], a[12:15], a[228:231], v[76:79]
    buffer_load_dwordx4 a[112:115], v224, s[4:7], s17 offen offset:256
    v_mfma_f32_16x16x32_bf16 v[76:79], a[16:19], a[232:235], v[76:79]
    buffer_load_dwordx4 a[116:119], v224, s[4:7], s17 offen offset:320
    v_mfma_f32_16x16x32_bf16 v[76:79], a[20:23], a[236:239], v[76:79]
    v_permlane32_swap_b32 v247, v248
    v_mfma_f32_16x16x32_bf16 v[80:83], a[36:39], a[228:231], v[80:83]
    v_add_f32 v247, v247, v248
    v_mov_b32 v248, v247
    v_mfma_f32_16x16x32_bf16 v[80:83], a[40:43], a[232:235], v[80:83]
    v_max3_f32 v250, v250, v251, v28
    v_mov_b32 v251, v250
    v_mfma_f32_16x16x32_bf16 v[80:83], a[44:47], a[236:239], v[80:83]
    buffer_store_dwordx2 v[114:115], v239, s[8:11], s24 offen offset:256 sc0 sc1
    v_cvt_pk_bf16_f32 v148, v76, v77
    v_mfma_f32_16x16x32_bf16 v[84:87], a[60:63], a[228:231], v[84:87]
    s_add_u32 s24, s18, 784896
    ds_read_b128 a[228:231], v221 offset:41984
    v_cvt_pk_bf16_f32 v149, v78, v79
    v_mfma_f32_16x16x32_bf16 v[84:87], a[64:67], a[232:235], v[84:87]
    s_add_u32 s25, s18, 981120
    ds_read_b128 a[232:235], v221 offset:43008
    v_max3_f32 v245, v32, v33, v34
    v_mfma_f32_16x16x32_bf16 v[84:87], a[68:71], a[236:239], v[84:87]
    s_mov_b32 s10, s31
    ds_read_b128 a[236:239], v221 offset:44032
    v_cvt_pk_bf16_f32 v150, v80, v81
    v_mfma_f32_16x16x32_bf16 v[64:67], a[0:3], a[192:195], 0
    s_add_u32 s26, s18, 1177344
    v_cvt_pk_bf16_f32 v151, v82, v83
    v_max3_f32 v246, v35, v36, v37
    v_mfma_f32_16x16x32_bf16 v[64:67], a[4:7], a[196:199], v[64:67]
    s_mov_b32 s18, s17
    v_permlane16_swap_b32 v247, v248
    v_mfma_f32_16x16x32_bf16 v[64:67], a[8:11], a[200:203], v[64:67]
    v_cvt_pk_bf16_f32 v152, v84, v85
    v_cvt_pk_bf16_f32 v153, v86, v87
    v_mfma_f32_16x16x32_bf16 v[68:71], a[24:27], a[192:195], 0
    v_add_f32 v247, v247, v248
    v_max3_f32 v245, v245, v38, v39
    v_mfma_f32_16x16x32_bf16 v[68:71], a[28:31], a[196:199], v[68:71]
    v_rcp_f32 v249, v247
    v_mfma_f32_16x16x32_bf16 v[68:71], a[32:35], a[200:203], v[68:71]
    v_mul_f32 v0, v0, v249
    v_mul_f32 v1, v1, v249
    v_mfma_f32_16x16x32_bf16 v[72:75], a[48:51], a[192:195], 0
    ds_read_b128 a[192:195], v221 offset:45056
    v_cvt_pk_bf16_f32 v0, v0, v1
    v_mfma_f32_16x16x32_bf16 v[72:75], a[52:55], a[196:199], v[72:75]
    ds_read_b128 a[196:199], v221 offset:46080
    v_mul_f32 v2, v2, v249
    v_mfma_f32_16x16x32_bf16 v[72:75], a[56:59], a[200:203], v[72:75]
    s_waitcnt lgkmcnt(5)
    ds_read_b128 a[200:203], v221 offset:47104
    v_mul_f32 v3, v3, v249
    v_mfma_f32_16x16x32_bf16 v[64:67], a[12:15], a[204:207], v[64:67]
    v_cvt_pk_bf16_f32 v1, v2, v3
    v_mul_f32 v4, v4, v249
    v_mfma_f32_16x16x32_bf16 v[64:67], a[16:19], a[208:211], v[64:67]
    v_mul_f32 v5, v5, v249
    v_mul_f32 v6, v6, v249
    v_mfma_f32_16x16x32_bf16 v[64:67], a[20:23], a[212:215], v[64:67]
    v_mul_f32 v7, v7, v249
    v_cvt_pk_bf16_f32 v2, v4, v5
    v_mfma_f32_16x16x32_bf16 v[68:71], a[36:39], a[204:207], v[68:71]
    v_cvt_pk_bf16_f32 v3, v6, v7
    v_mul_f32 v8, v8, v249
    v_mfma_f32_16x16x32_bf16 v[68:71], a[40:43], a[208:211], v[68:71]
    v_mul_f32 v9, v9, v249
    v_mul_f32 v10, v10, v249
    v_mfma_f32_16x16x32_bf16 v[68:71], a[44:47], a[212:215], v[68:71]
    v_mul_f32 v11, v11, v249
    v_cvt_pk_bf16_f32 v4, v8, v9
    v_mfma_f32_16x16x32_bf16 v[72:75], a[60:63], a[204:207], v[72:75]
    ds_read_b128 a[204:207], v221 offset:48128
    v_cvt_pk_bf16_f32 v5, v10, v11
    v_mfma_f32_16x16x32_bf16 v[72:75], a[64:67], a[208:211], v[72:75]
    ds_read_b128 a[208:211], v221 offset:49152
    v_mul_f32 v12, v12, v249
    v_mfma_f32_16x16x32_bf16 v[72:75], a[68:71], a[212:215], v[72:75]
    ds_read_b128 a[212:215], v221 offset:50176
    v_cvt_pk_bf16_f32 v6, v12, 0
    v_mfma_f32_16x16x32_bf16 v[76:79], a[0:3], a[216:219], 0
    v_mov_b32 v7, 0
    v_cvt_pk_bf16_f32 v156, v64, v65
    v_mfma_f32_16x16x32_bf16 v[76:79], a[4:7], a[220:223], v[76:79]
    v_cvt_pk_bf16_f32 v157, v66, v67
    v_cvt_pk_bf16_f32 v158, v68, v69
    v_mfma_f32_16x16x32_bf16 v[76:79], a[8:11], a[224:227], v[76:79]
    v_cvt_pk_bf16_f32 v159, v70, v71
    v_cvt_pk_bf16_f32 v160, v72, v73
    v_mfma_f32_16x16x32_bf16 v[80:83], a[24:27], a[216:219], 0
    v_cvt_pk_bf16_f32 v161, v74, v75
    v_max3_f32 v246, v246, v40, v41
    v_mfma_f32_16x16x32_bf16 v[80:83], a[28:31], a[220:223], v[80:83]
    v_permlane32_swap_b32 v250, v251
    v_mfma_f32_16x16x32_bf16 v[80:83], a[32:35], a[224:227], v[80:83]
    v_max_f32 v250, v250, v251
    v_mov_b32 v251, v250
    v_mfma_f32_16x16x32_bf16 v[84:87], a[48:51], a[216:219], 0
    ds_read_b128 a[216:219], v221 offset:51200
    v_max3_f32 v245, v245, v42, v43
    v_mfma_f32_16x16x32_bf16 v[84:87], a[52:55], a[220:223], v[84:87]
    ds_read_b128 a[220:223], v221 offset:52224
    v_max3_f32 v245, v245, v246, v44
    v_mfma_f32_16x16x32_bf16 v[84:87], a[56:59], a[224:227], v[84:87]
    s_waitcnt lgkmcnt(5)
    ds_read_b128 a[224:227], v221 offset:53248
    v_mov_b32 v246, v245
    v_mfma_f32_16x16x32_bf16 v[76:79], a[12:15], a[228:231], v[76:79]
    v_permlane16_swap_b32 v250, v251
    v_mfma_f32_16x16x32_bf16 v[76:79], a[16:19], a[232:235], v[76:79]
    v_max_f32 v250, v250, v251
    v_sub_f32 v16, v16, v250
    v_mfma_f32_16x16x32_bf16 v[76:79], a[20:23], a[236:239], v[76:79]
    v_sub_f32 v17, v17, v250
    v_sub_f32 v18, v18, v250
    v_mfma_f32_16x16x32_bf16 v[80:83], a[36:39], a[228:231], v[80:83]
    v_exp_f32 v16, v16
    v_mfma_f32_16x16x32_bf16 v[80:83], a[40:43], a[232:235], v[80:83]
    v_exp_f32 v17, v17
    v_mfma_f32_16x16x32_bf16 v[80:83], a[44:47], a[236:239], v[80:83]
    v_sub_f32 v19, v19, v250
    v_cvt_pk_bf16_f32 v164, v76, v77
    v_mfma_f32_16x16x32_bf16 v[84:87], a[60:63], a[228:231], v[84:87]
    ds_read_b128 a[228:231], v221 offset:54272
    v_cvt_pk_bf16_f32 v165, v78, v79
    v_mfma_f32_16x16x32_bf16 v[84:87], a[64:67], a[232:235], v[84:87]
    buffer_load_dwordx4 a[136:139], v225, s[4:7], s17 offen offset:256
    v_mfma_f32_16x16x32_bf16 v[84:87], a[68:71], a[236:239], v[84:87]
    buffer_load_dwordx4 a[140:143], v225, s[4:7], s17 offen offset:320
    v_smfmac_f32_16x16x64_bf16 v[56:59], v[48:51], v[124:131], v228
    ds_read_b128 a[232:235], v221 offset:55296
    ds_read_b128 a[236:239], v221 offset:56320
    v_smfmac_f32_16x16x64_bf16 v[60:63], v[48:51], v[132:139], v228
    v_cvt_pk_bf16_f32 v166, v80, v81
    v_cvt_pk_bf16_f32 v167, v82, v83
    v_mfma_f32_16x16x32_bf16 v[8:11], v[0:3], v[124:127], 0
    v_cvt_pk_bf16_f32 v168, v84, v85
    v_cvt_pk_bf16_f32 v169, v86, v87
    v_mfma_f32_16x16x32_bf16 v[8:11], v[4:7], v[128:131], v[8:11]
    v_add_f32 v56, v56, v57
    v_mov_b32 v57, 0
    v_mfma_f32_16x16x32_bf16 v[12:15], v[0:3], v[132:135], 0
    v_add_f32 v60, v60, v61
    v_cvt_pk_bf16_f32 v88, v56, v60
    v_mfma_f32_16x16x32_bf16 v[12:15], v[4:7], v[136:139], v[12:15]
    v_mov_b32 v56, 0
    v_mov_b32 v60, 0
    v_mfma_f32_16x16x32_bf16 v[64:67], a[0:3], a[192:195], 0
    v_mov_b32 v61, 0
    v_sub_f32 v20, v20, v250
    v_mfma_f32_16x16x32_bf16 v[64:67], a[4:7], a[196:199], v[64:67]
    v_exp_f32 v18, v18
    v_mfma_f32_16x16x32_bf16 v[64:67], a[8:11], a[200:203], v[64:67]
    v_cvt_pk_bf16_f32 v100, v8, v12
    v_cvt_pk_bf16_f32 v102, v9, v13
    v_mfma_f32_16x16x32_bf16 v[68:71], a[24:27], a[192:195], 0
    v_cvt_pk_bf16_f32 v104, v10, v14
    v_cvt_pk_bf16_f32 v106, v11, v15
    v_mfma_f32_16x16x32_bf16 v[68:71], a[28:31], a[196:199], v[68:71]
    v_exp_f32 v19, v19
    v_mfma_f32_16x16x32_bf16 v[68:71], a[32:35], a[200:203], v[68:71]
    v_exp_f32 v20, v20
    v_mfma_f32_16x16x32_bf16 v[72:75], a[48:51], a[192:195], 0
    ds_read_b128 a[192:195], v221 offset:57344
    v_sub_f32 v21, v21, v250
    v_mfma_f32_16x16x32_bf16 v[72:75], a[52:55], a[196:199], v[72:75]
    ds_read_b128 a[196:199], v221 offset:58368
    v_sub_f32 v22, v22, v250
    v_mfma_f32_16x16x32_bf16 v[72:75], a[56:59], a[200:203], v[72:75]
    s_waitcnt lgkmcnt(3)
    ds_read_b128 a[200:203], v221 offset:59392
    v_sub_f32 v23, v23, v250
    v_mfma_f32_16x16x32_bf16 v[64:67], a[12:15], a[204:207], v[64:67]
    v_exp_f32 v21, v21
    v_mfma_f32_16x16x32_bf16 v[64:67], a[16:19], a[208:211], v[64:67]
    v_exp_f32 v22, v22
    v_mfma_f32_16x16x32_bf16 v[64:67], a[20:23], a[212:215], v[64:67]
    v_sub_f32 v24, v24, v250
    v_add_f32 v252, v16, v17
    v_mfma_f32_16x16x32_bf16 v[68:71], a[36:39], a[204:207], v[68:71]
    v_exp_f32 v23, v23
    v_mfma_f32_16x16x32_bf16 v[68:71], a[40:43], a[208:211], v[68:71]
    v_exp_f32 v24, v24
    v_mfma_f32_16x16x32_bf16 v[68:71], a[44:47], a[212:215], v[68:71]
    v_sub_f32 v25, v25, v250
    v_sub_f32 v26, v26, v250
    v_mfma_f32_16x16x32_bf16 v[72:75], a[60:63], a[204:207], v[72:75]
    ds_read_b128 a[204:207], v221 offset:60416
    v_add_f32 v253, v18, v19
    v_mfma_f32_16x16x32_bf16 v[72:75], a[64:67], a[208:211], v[72:75]
    ds_read_b128 a[208:211], v221 offset:61440
    v_add_f32 v252, v252, v20
    v_mfma_f32_16x16x32_bf16 v[72:75], a[68:71], a[212:215], v[72:75]
    ds_read_b128 a[212:215], v221 offset:62464
    v_sub_f32 v27, v27, v250
    v_smfmac_f32_16x16x64_bf16 v[56:59], v[48:51], v[140:147], v228
    v_exp_f32 v25, v25
    v_smfmac_f32_16x16x64_bf16 v[60:63], v[48:51], v[148:155], v228
    v_exp_f32 v26, v26
    v_mfma_f32_16x16x32_bf16 v[8:11], v[0:3], v[140:143], 0
    v_sub_f32 v28, v28, v250
    v_add_f32 v253, v253, v21
    v_mfma_f32_16x16x32_bf16 v[8:11], v[4:7], v[144:147], v[8:11]
    v_add_f32 v252, v252, v22
    v_add_f32 v253, v253, v23
    v_mfma_f32_16x16x32_bf16 v[12:15], v[0:3], v[148:151], 0
    v_exp_f32 v27, v27
    v_mfma_f32_16x16x32_bf16 v[12:15], v[4:7], v[152:155], v[12:15]
    v_exp_f32 v28, v28
    v_mfma_f32_16x16x32_bf16 v[76:79], a[0:3], a[216:219], 0
    v_add_f32 v252, v252, v24
    v_add_f32 v253, v253, v25
    v_mfma_f32_16x16x32_bf16 v[76:79], a[4:7], a[220:223], v[76:79]
    v_add_f32 v252, v252, v26
    v_add_f32 v253, v253, v27
    v_mfma_f32_16x16x32_bf16 v[76:79], a[8:11], a[224:227], v[76:79]
    v_add_f32 v252, v252, v28
    v_add_f32 v252, v252, v253
    v_mfma_f32_16x16x32_bf16 v[80:83], a[24:27], a[216:219], 0
    v_mov_b32 v253, v252
    v_add_f32 v56, v56, v57
    v_mfma_f32_16x16x32_bf16 v[80:83], a[28:31], a[220:223], v[80:83]
    v_permlane32_swap_b32 v252, v253
    v_mfma_f32_16x16x32_bf16 v[80:83], a[32:35], a[224:227], v[80:83]
    v_add_f32 v252, v252, v253
    v_mov_b32 v253, v252
    v_mfma_f32_16x16x32_bf16 v[84:87], a[48:51], a[216:219], 0
    ds_read_b128 a[216:219], v221 offset:63488
    v_add_f32 v60, v60, v61
    v_mfma_f32_16x16x32_bf16 v[84:87], a[52:55], a[220:223], v[84:87]
    ds_read_b128 a[220:223], v221 offset:64512
    v_cvt_pk_bf16_f32 v89, v56, v60
    v_mfma_f32_16x16x32_bf16 v[84:87], a[56:59], a[224:227], v[84:87]
    ds_read_b128 a[224:227], v222 offset:0
    v_mov_b32 v56, 0
    v_mfma_f32_16x16x32_bf16 v[76:79], a[12:15], a[228:231], v[76:79]
    buffer_store_dwordx2 v[88:89], v241, s[8:11], s26 offen offset:2304 sc0 sc1
    v_mov_b32 v57, 0
    v_mfma_f32_16x16x32_bf16 v[76:79], a[16:19], a[232:235], v[76:79]
    s_waitcnt lgkmcnt(3)
    v_permlane16_swap_b32 v252, v253
    v_mfma_f32_16x16x32_bf16 v[76:79], a[20:23], a[236:239], v[76:79]
    v_add_f32 v252, v252, v253
    v_mov_b32 v60, 0
    v_mfma_f32_16x16x32_bf16 v[80:83], a[36:39], a[228:231], v[80:83]
    v_rcp_f32 v254, v252
    v_mfma_f32_16x16x32_bf16 v[80:83], a[40:43], a[232:235], v[80:83]
    v_mul_f32 v16, v16, v254
    v_mul_f32 v17, v17, v254
    v_mfma_f32_16x16x32_bf16 v[80:83], a[44:47], a[236:239], v[80:83]
    v_cvt_pk_bf16_f32 v16, v16, v17
    v_mul_f32 v18, v18, v254
    v_mfma_f32_16x16x32_bf16 v[84:87], a[60:63], a[228:231], v[84:87]
    ds_read_b128 a[228:231], v222 offset:1024
    v_mul_f32 v19, v19, v254
    v_mfma_f32_16x16x32_bf16 v[84:87], a[64:67], a[232:235], v[84:87]
    ds_read_b128 a[232:235], v222 offset:2048
    v_cvt_pk_bf16_f32 v17, v18, v19
    v_mfma_f32_16x16x32_bf16 v[84:87], a[68:71], a[236:239], v[84:87]
    ds_read_b128 a[236:239], v222 offset:3072
    v_mul_f32 v20, v20, v254
    v_mul_f32 v21, v21, v254
    v_mul_f32 v22, v22, v254
    v_mul_f32 v23, v23, v254
    v_cvt_pk_bf16_f32 v18, v20, v21
    v_cvt_pk_bf16_f32 v19, v22, v23
    v_mul_f32 v24, v24, v254
    v_mul_f32 v25, v25, v254
    v_mul_f32 v26, v26, v254
    v_mul_f32 v27, v27, v254
    v_cvt_pk_bf16_f32 v20, v24, v25
    v_cvt_pk_bf16_f32 v21, v26, v27
    v_mfma_f32_16x16x32_bf16 v[24:27], v[16:19], v[124:127], 0
    v_mul_f32 v28, v28, v254
    v_cvt_pk_bf16_f32 v22, v28, 0
    v_mov_b32 v23, 0
    s_nop 0
    s_nop 0
    v_mfma_f32_16x16x32_bf16 v[24:27], v[20:23], v[128:131], v[24:27]
    v_mov_b32 v61, 0
    v_cvt_pk_bf16_f32 v101, v8, v12
    v_mfma_f32_16x16x32_bf16 v[28:31], v[16:19], v[132:135], 0
    buffer_store_dwordx2 v[100:101], v233, s[8:11], s20 offen offset:0 sc0 sc1
    v_cvt_pk_bf16_f32 v103, v9, v13
    v_mfma_f32_16x16x32_bf16 v[28:31], v[20:23], v[136:139], v[28:31]
    v_cvt_pk_bf16_f32 v105, v10, v14
L_pad12:
    s_cbranch_execz L_pad16
    v_cvt_pk_bf16_f32 v107, v11, v15
    v_smfmac_f32_16x16x64_bf16 v[56:59], v[48:51], v[156:163], v228
    v_cvt_pk_bf16_f32 v172, v64, v65
    v_cvt_pk_bf16_f32 v173, v66, v67
    v_smfmac_f32_16x16x64_bf16 v[60:63], v[48:51], v[164:171], v228
    v_cvt_pk_bf16_f32 v174, v68, v69
    v_cvt_pk_bf16_f32 v175, v70, v71
    v_mfma_f32_16x16x32_bf16 v[8:11], v[0:3], v[156:159], 0
    v_cvt_pk_bf16_f32 v108, v24, v28
    v_cvt_pk_bf16_f32 v110, v25, v29
    v_mfma_f32_16x16x32_bf16 v[8:11], v[4:7], v[160:163], v[8:11]
    v_cvt_pk_bf16_f32 v112, v26, v30
    v_cvt_pk_bf16_f32 v114, v27, v31
    v_mfma_f32_16x16x32_bf16 v[12:15], v[0:3], v[164:167], 0
    v_cvt_pk_bf16_f32 v176, v72, v73
    v_cvt_pk_bf16_f32 v177, v74, v75
    v_mfma_f32_16x16x32_bf16 v[12:15], v[4:7], v[168:171], v[12:15]
    v_add_f32 v56, v56, v57
    v_add_f32 v60, v60, v61
    v_mfma_f32_16x16x32_bf16 v[24:27], v[16:19], v[140:143], 0
    buffer_store_dwordx2 v[102:103], v233, s[8:11], s21 offen offset:0 sc0 sc1
    v_cvt_pk_bf16_f32 v90, v56, v60
    v_mfma_f32_16x16x32_bf16 v[24:27], v[20:23], v[144:147], v[24:27]
    v_mov_b32 v56, 0
    v_mov_b32 v57, 0
    v_mfma_f32_16x16x32_bf16 v[28:31], v[16:19], v[148:151], 0
    v_cvt_pk_bf16_f32 v180, v76, v77
    v_cvt_pk_bf16_f32 v181, v78, v79
    v_mfma_f32_16x16x32_bf16 v[28:31], v[20:23], v[152:155], v[28:31]
    v_cvt_pk_bf16_f32 v182, v80, v81
    v_cvt_pk_bf16_f32 v183, v82, v83
    v_mfma_f32_16x16x32_bf16 v[64:67], a[0:3], a[192:195], 0
    v_cvt_pk_bf16_f32 v184, v84, v85
    v_cvt_pk_bf16_f32 v185, v86, v87
    v_mfma_f32_16x16x32_bf16 v[64:67], a[4:7], a[196:199], v[64:67]
    v_mov_b32 v60, 0
    v_mov_b32 v61, 0
    v_mfma_f32_16x16x32_bf16 v[64:67], a[8:11], a[200:203], v[64:67]
    v_cvt_pk_bf16_f32 v109, v24, v28
    v_cvt_pk_bf16_f32 v111, v25, v29
    v_mfma_f32_16x16x32_bf16 v[68:71], a[24:27], a[192:195], 0
    v_cvt_pk_bf16_f32 v113, v26, v30
    v_cvt_pk_bf16_f32 v115, v27, v31
    v_mfma_f32_16x16x32_bf16 v[68:71], a[28:31], a[196:199], v[68:71]
    buffer_store_dwordx2 v[104:105], v233, s[8:11], s22 offen offset:0 sc0 sc1
    v_cvt_pk_bf16_f32 v116, v8, v12
    v_mfma_f32_16x16x32_bf16 v[68:71], a[32:35], a[200:203], v[68:71]
    v_cvt_pk_bf16_f32 v118, v9, v13
    v_cvt_pk_bf16_f32 v120, v10, v14
    v_mfma_f32_16x16x32_bf16 v[72:75], a[48:51], a[192:195], 0
    ds_read_b128 a[192:195], v222 offset:4096
    v_cvt_pk_bf16_f32 v122, v11, v15
    v_mfma_f32_16x16x32_bf16 v[72:75], a[52:55], a[196:199], v[72:75]
    ds_read_b128 a[196:199], v222 offset:5120
    v_mfma_f32_16x16x32_bf16 v[72:75], a[56:59], a[200:203], v[72:75]
    ds_read_b128 a[200:203], v222 offset:6144
    v_mfma_f32_16x16x32_bf16 v[64:67], a[12:15], a[204:207], v[64:67]
    v_permlane32_swap_b32 v245, v246
    v_mfma_f32_16x16x32_bf16 v[64:67], a[16:19], a[208:211], v[64:67]
    v_max_f32 v245, v245, v246
    v_mov_b32 v246, v245
    v_mfma_f32_16x16x32_bf16 v[64:67], a[20:23], a[212:215], v[64:67]
    v_mfma_f32_16x16x32_bf16 v[68:71], a[36:39], a[204:207], v[68:71]
    buffer_store_dwordx2 v[106:107], v233, s[8:11], s23 offen offset:0 sc0 sc1
    v_mfma_f32_16x16x32_bf16 v[68:71], a[40:43], a[208:211], v[68:71]
    v_permlane16_swap_b32 v245, v246
    v_mfma_f32_16x16x32_bf16 v[68:71], a[44:47], a[212:215], v[68:71]
    v_max_f32 v245, v245, v246
    v_sub_f32 v32, v32, v245
    v_mfma_f32_16x16x32_bf16 v[72:75], a[60:63], a[204:207], v[72:75]
    ds_read_b128 a[204:207], v222 offset:7168
    v_cvt_pk_bf16_f32 v188, v64, v65
    v_mfma_f32_16x16x32_bf16 v[72:75], a[64:67], a[208:211], v[72:75]
    ds_read_b128 a[208:211], v222 offset:8192
    v_cvt_pk_bf16_f32 v189, v66, v67
    v_mfma_f32_16x16x32_bf16 v[72:75], a[68:71], a[212:215], v[72:75]
    ds_read_b128 a[212:215], v222 offset:9216
    v_cvt_pk_bf16_f32 v190, v68, v69
    v_mfma_f32_16x16x32_bf16 v[24:27], v[16:19], v[156:159], 0
    v_cvt_pk_bf16_f32 v191, v70, v71
    v_sub_f32 v33, v33, v245
    v_mfma_f32_16x16x32_bf16 v[24:27], v[20:23], v[160:163], v[24:27]
    v_exp_f32 v32, v32
    v_mfma_f32_16x16x32_bf16 v[28:31], v[16:19], v[164:167], 0
    buffer_store_dwordx2 v[108:109], v233, s[8:11], s24 offen offset:0 sc0 sc1
    v_cvt_pk_bf16_f32 v192, v72, v73
    v_mfma_f32_16x16x32_bf16 v[28:31], v[20:23], v[168:171], v[28:31]
    v_cvt_pk_bf16_f32 v193, v74, v75
    v_sub_f32 v34, v34, v245
    v_smfmac_f32_16x16x64_bf16 v[56:59], v[48:51], v[172:179], v228
    v_exp_f32 v33, v33
    v_smfmac_f32_16x16x64_bf16 v[60:63], v[48:51], v[180:187], v228
    v_sub_f32 v35, v35, v245
    v_sub_f32 v36, v36, v245
    v_mfma_f32_16x16x32_bf16 v[8:11], v[0:3], v[172:175], 0
    v_cvt_pk_bf16_f32 v92, v24, v28
    v_cvt_pk_bf16_f32 v94, v25, v29
    v_mfma_f32_16x16x32_bf16 v[8:11], v[4:7], v[176:179], v[8:11]
    v_cvt_pk_bf16_f32 v96, v26, v30
    v_cvt_pk_bf16_f32 v98, v27, v31
    v_mfma_f32_16x16x32_bf16 v[12:15], v[0:3], v[180:183], 0
    v_add_f32 v56, v56, v57
    v_add_f32 v60, v60, v61
    v_mfma_f32_16x16x32_bf16 v[12:15], v[4:7], v[184:187], v[12:15]
    v_cvt_pk_bf16_f32 v91, v56, v60
    v_mov_b32 v56, 0
    v_mfma_f32_16x16x32_bf16 v[24:27], v[16:19], v[172:175], 0
    buffer_store_dwordx2 v[110:111], v233, s[8:11], s25 offen offset:0 sc0 sc1
    v_mov_b32 v57, 0
    v_mfma_f32_16x16x32_bf16 v[24:27], v[20:23], v[176:179], v[24:27]
    v_mov_b32 v60, 0
    v_mov_b32 v61, 0
    v_mfma_f32_16x16x32_bf16 v[28:31], v[16:19], v[180:183], 0
    v_cvt_pk_bf16_f32 v117, v8, v12
    v_cvt_pk_bf16_f32 v119, v9, v13
    v_mfma_f32_16x16x32_bf16 v[28:31], v[20:23], v[184:187], v[28:31]
    s_waitcnt lgkmcnt(0)
    v_cvt_pk_bf16_f32 v121, v10, v14
    v_cvt_pk_bf16_f32 v123, v11, v15
    v_mfma_f32_16x16x32_bf16 v[76:79], a[0:3], a[216:219], 0
    v_exp_f32 v34, v34
    v_mfma_f32_16x16x32_bf16 v[76:79], a[4:7], a[220:223], v[76:79]
    v_exp_f32 v35, v35
    v_mfma_f32_16x16x32_bf16 v[76:79], a[8:11], a[224:227], v[76:79]
    v_exp_f32 v36, v36
    v_mfma_f32_16x16x32_bf16 v[80:83], a[24:27], a[216:219], 0
    v_cvt_pk_bf16_f32 v93, v24, v28
    v_cvt_pk_bf16_f32 v95, v25, v29
    v_mfma_f32_16x16x32_bf16 v[80:83], a[28:31], a[220:223], v[80:83]
    buffer_store_dwordx2 v[112:113], v233, s[8:11], s26 offen offset:0 sc0 sc1
    v_cvt_pk_bf16_f32 v97, v26, v30
    v_mfma_f32_16x16x32_bf16 v[80:83], a[32:35], a[224:227], v[80:83]
    v_cvt_pk_bf16_f32 v99, v27, v31
    v_sub_f32 v37, v37, v245
    v_mfma_f32_16x16x32_bf16 v[84:87], a[48:51], a[216:219], 0
    ds_read_b128 a[216:219], v222 offset:10240
    v_sub_f32 v38, v38, v245
    v_mfma_f32_16x16x32_bf16 v[84:87], a[52:55], a[220:223], v[84:87]
    ds_read_b128 a[220:223], v222 offset:11264
    v_sub_f32 v39, v39, v245
    v_mfma_f32_16x16x32_bf16 v[84:87], a[56:59], a[224:227], v[84:87]
    ds_read_b128 a[224:227], v222 offset:12288
    v_sub_f32 v40, v40, v245
    v_mfma_f32_16x16x32_bf16 v[76:79], a[12:15], a[228:231], v[76:79]
    v_exp_f32 v37, v37
    v_mfma_f32_16x16x32_bf16 v[76:79], a[16:19], a[232:235], v[76:79]
    v_exp_f32 v38, v38
    v_mfma_f32_16x16x32_bf16 v[76:79], a[20:23], a[236:239], v[76:79]
    v_add_f32 v247, v32, v33
    v_sub_f32 v41, v41, v245
    v_mfma_f32_16x16x32_bf16 v[80:83], a[36:39], a[228:231], v[80:83]
    buffer_store_dwordx2 v[114:115], v235, s[8:11], s20 offen offset:1536 sc0 sc1
    v_sub_f32 v42, v42, v245
    v_mfma_f32_16x16x32_bf16 v[80:83], a[40:43], a[232:235], v[80:83]
    v_exp_f32 v39, v39
    v_mfma_f32_16x16x32_bf16 v[80:83], a[44:47], a[236:239], v[80:83]
    v_cvt_pk_bf16_f32 v196, v76, v77
    v_cvt_pk_bf16_f32 v197, v78, v79
    v_mfma_f32_16x16x32_bf16 v[84:87], a[60:63], a[228:231], v[84:87]
    ds_read_b128 a[228:231], v222 offset:13312
    v_add_f32 v248, v34, v35
    v_mfma_f32_16x16x32_bf16 v[84:87], a[64:67], a[232:235], v[84:87]
    ds_read_b128 a[232:235], v222 offset:14336
    v_add_f32 v247, v247, v36
    v_mfma_f32_16x16x32_bf16 v[84:87], a[68:71], a[236:239], v[84:87]
    ds_read_b128 a[236:239], v222 offset:15360
    v_cvt_pk_bf16_f32 v198, v80, v81
    v_mfma_f32_16x16x32_bf16 v[64:67], a[0:3], a[192:195], 0
    v_cvt_pk_bf16_f32 v199, v82, v83
    v_sub_f32 v43, v43, v245
    v_mfma_f32_16x16x32_bf16 v[64:67], a[4:7], a[196:199], v[64:67]
    v_exp_f32 v40, v40
    v_mfma_f32_16x16x32_bf16 v[64:67], a[8:11], a[200:203], v[64:67]
    buffer_store_dwordx2 v[90:91], v241, s[8:11], s26 offen offset:2432 sc0 sc1
    v_cvt_pk_bf16_f32 v200, v84, v85
    v_mfma_f32_16x16x32_bf16 v[68:71], a[24:27], a[192:195], 0
    v_cvt_pk_bf16_f32 v201, v86, v87
    v_sub_f32 v44, v44, v245
    v_mfma_f32_16x16x32_bf16 v[68:71], a[28:31], a[196:199], v[68:71]
    v_exp_f32 v41, v41
    v_mfma_f32_16x16x32_bf16 v[68:71], a[32:35], a[200:203], v[68:71]
    v_exp_f32 v42, v42
    v_mfma_f32_16x16x32_bf16 v[72:75], a[48:51], a[192:195], 0
    ds_read_b128 a[192:195], v220 offset:0
    v_add_f32 v248, v248, v37
    v_mfma_f32_16x16x32_bf16 v[72:75], a[52:55], a[196:199], v[72:75]
    ds_read_b128 a[196:199], v220 offset:1024
    v_add_f32 v247, v247, v38
    v_mfma_f32_16x16x32_bf16 v[72:75], a[56:59], a[200:203], v[72:75]
    ds_read_b128 a[200:203], v220 offset:2048
    v_add_f32 v248, v248, v39
    v_mfma_f32_16x16x32_bf16 v[64:67], a[12:15], a[204:207], v[64:67]
    v_exp_f32 v43, v43
    v_mfma_f32_16x16x32_bf16 v[64:67], a[16:19], a[208:211], v[64:67]
    buffer_store_dwordx2 v[116:117], v233, s[8:11], s20 offen offset:128 sc0 sc1
    v_add_f32 v247, v247, v40
    v_mfma_f32_16x16x32_bf16 v[64:67], a[20:23], a[212:215], v[64:67]
    v_exp_f32 v44, v44
    v_mfma_f32_16x16x32_bf16 v[68:71], a[36:39], a[204:207], v[68:71]
    v_add_f32 v248, v248, v41
    v_add_f32 v247, v247, v42
    v_mfma_f32_16x16x32_bf16 v[68:71], a[40:43], a[208:211], v[68:71]
    v_add_f32 v248, v248, v43
    v_add_f32 v247, v247, v44
    v_mfma_f32_16x16x32_bf16 v[68:71], a[44:47], a[212:215], v[68:71]
    v_add_f32 v247, v247, v248
    v_mov_b32 v248, v247
    v_mfma_f32_16x16x32_bf16 v[72:75], a[60:63], a[204:207], v[72:75]
    ds_read_b128 a[204:207], v220 offset:3072
    v_cvt_pk_bf16_f32 v204, v64, v65
    v_mfma_f32_16x16x32_bf16 v[72:75], a[64:67], a[208:211], v[72:75]
    ds_read_b128 a[208:211], v220 offset:4096
    v_cvt_pk_bf16_f32 v205, v66, v67
    v_mfma_f32_16x16x32_bf16 v[72:75], a[68:71], a[212:215], v[72:75]
    ds_read_b128 a[212:215], v220 offset:5120
    v_cvt_pk_bf16_f32 v206, v68, v69
    v_smfmac_f32_16x16x64_bf16 v[56:59], v[48:51], v[188:195], v228
    buffer_store_dwordx2 v[118:119], v233, s[8:11], s21 offen offset:128 sc0 sc1
    v_cvt_pk_bf16_f32 v207, v70, v71
    v_smfmac_f32_16x16x64_bf16 v[60:63], v[48:51], v[196:203], v228
    v_permlane32_swap_b32 v247, v248
    v_mfma_f32_16x16x32_bf16 v[8:11], v[0:3], v[188:191], 0
    v_add_f32 v247, v247, v248
    v_mov_b32 v248, v247
    v_mfma_f32_16x16x32_bf16 v[8:11], v[4:7], v[192:195], v[8:11]
    v_add_f32 v56, v56, v57
    v_cvt_pk_bf16_f32 v208, v72, v73
    v_mfma_f32_16x16x32_bf16 v[12:15], v[0:3], v[196:199], 0
    v_permlane16_swap_b32 v247, v248
    v_mfma_f32_16x16x32_bf16 v[12:15], v[4:7], v[200:203], v[12:15]
    v_add_f32 v247, v247, v248
    v_add_f32 v60, v60, v61
    v_mfma_f32_16x16x32_bf16 v[24:27], v[16:19], v[188:191], 0
    v_rcp_f32 v249, v247
    v_mfma_f32_16x16x32_bf16 v[24:27], v[20:23], v[192:195], v[24:27]
    v_cvt_pk_bf16_f32 v250, v56, v60
    v_cvt_pk_bf16_f32 v209, v74, v75
    v_mfma_f32_16x16x32_bf16 v[28:31], v[16:19], v[196:199], 0
    buffer_store_dwordx2 v[120:121], v233, s[8:11], s22 offen offset:128 sc0 sc1
    v_cvt_pk_bf16_f32 v100, v8, v12
    v_mfma_f32_16x16x32_bf16 v[28:31], v[20:23], v[200:203], v[28:31]
    s_waitcnt lgkmcnt(3)
    v_cvt_pk_bf16_f32 v102, v9, v13
    v_cvt_pk_bf16_f32 v104, v10, v14
    v_mfma_f32_16x16x32_bf16 v[76:79], a[0:3], a[216:219], 0
    v_cvt_pk_bf16_f32 v106, v11, v15
    v_mfma_f32_16x16x32_bf16 v[76:79], a[4:7], a[220:223], v[76:79]
    v_mfma_f32_16x16x32_bf16 v[76:79], a[8:11], a[224:227], v[76:79]
    v_mfma_f32_16x16x32_bf16 v[80:83], a[24:27], a[216:219], 0
    v_mfma_f32_16x16x32_bf16 v[80:83], a[28:31], a[220:223], v[80:83]
    v_cvt_pk_bf16_f32 v108, v24, v28
    v_cvt_pk_bf16_f32 v110, v25, v29
    v_mfma_f32_16x16x32_bf16 v[80:83], a[32:35], a[224:227], v[80:83]
    v_cvt_pk_bf16_f32 v112, v26, v30
    v_cvt_pk_bf16_f32 v114, v27, v31
    v_mfma_f32_16x16x32_bf16 v[84:87], a[48:51], a[216:219], 0
    buffer_store_dwordx2 v[122:123], v233, s[8:11], s23 offen offset:128 sc0 sc1
    ds_read_b128 a[216:219], v220 offset:6144
    v_mfma_f32_16x16x32_bf16 v[84:87], a[52:55], a[220:223], v[84:87]
    ds_read_b128 a[220:223], v220 offset:7168
    v_mfma_f32_16x16x32_bf16 v[84:87], a[56:59], a[224:227], v[84:87]
    ds_read_b128 a[224:227], v220 offset:8192
    v_mfma_f32_16x16x32_bf16 v[76:79], a[12:15], a[228:231], v[76:79]
    v_mfma_f32_16x16x32_bf16 v[76:79], a[16:19], a[232:235], v[76:79]
    v_mfma_f32_16x16x32_bf16 v[76:79], a[20:23], a[236:239], v[76:79]
    v_mfma_f32_16x16x32_bf16 v[80:83], a[36:39], a[228:231], v[80:83]
    v_mfma_f32_16x16x32_bf16 v[80:83], a[40:43], a[232:235], v[80:83]
    v_mfma_f32_16x16x32_bf16 v[80:83], a[44:47], a[236:239], v[80:83]
    buffer_store_dwordx2 v[92:93], v233, s[8:11], s24 offen offset:128 sc0 sc1
    v_mfma_f32_16x16x32_bf16 v[84:87], a[60:63], a[228:231], v[84:87]
    ds_read_b128 a[228:231], v220 offset:9216
    v_mfma_f32_16x16x32_bf16 v[84:87], a[64:67], a[232:235], v[84:87]
    ds_read_b128 a[232:235], v220 offset:10240
    v_mfma_f32_16x16x32_bf16 v[84:87], a[68:71], a[236:239], v[84:87]
    ds_read_b128 a[236:239], v220 offset:11264
    buffer_store_dwordx2 v[94:95], v233, s[8:11], s25 offen offset:128 sc0 sc1
    buffer_store_dwordx2 v[96:97], v233, s[8:11], s26 offen offset:128 sc0 sc1
    buffer_store_dwordx2 v[98:99], v235, s[8:11], s20 offen offset:1664 sc0 sc1
L_b1:
    s_waitcnt vmcnt(57)
    v_mfma_f32_16x16x32_bf16 v[64:67], a[192:195], a[72:75], 0
    s_sub_u32 s16, s16, 1024
    v_mov_b32 v56, 0
    v_mov_b32 v57, 0
    s_waitcnt vmcnt(56)
    v_mfma_f32_16x16x32_bf16 v[64:67], a[196:199], a[76:79], v[64:67]
    s_mul_hi_u32 s27, s16, s29
    v_cvt_pk_bf16_f32 v212, v76, v77
    v_cvt_pk_bf16_f32 v213, v78, v79
    s_waitcnt vmcnt(42)
    v_mfma_f32_16x16x32_bf16 v[64:67], a[200:203], a[80:83], v[64:67]
    s_mul_i32 s17, s27, 73
    v_cvt_pk_bf16_f32 v214, v80, v81
    v_cvt_pk_bf16_f32 v215, v82, v83
    v_mfma_f32_16x16x32_bf16 v[68:71], a[192:195], a[96:99], 0
    s_sub_u32 s17, s16, s17
    v_cvt_pk_bf16_f32 v216, v84, v85
    v_cvt_pk_bf16_f32 v217, v86, v87
    v_mfma_f32_16x16x32_bf16 v[68:71], a[196:199], a[100:103], v[68:71]
    s_mul_i32 s17, s17, 2688
    v_mov_b32 v60, 0
    v_mov_b32 v61, 0
    s_waitcnt vmcnt(36)
    v_mfma_f32_16x16x32_bf16 v[68:71], a[200:203], a[104:107], v[68:71]
    s_mul_i32 s27, s27, 1373568
    v_mul_f32 v32, v32, v249
    v_mul_f32 v33, v33, v249
    v_mfma_f32_16x16x32_bf16 v[72:75], a[192:195], a[120:123], 0
    s_add_u32 s17, s17, s27
    ds_read_b128 a[192:195], v220 offset:12288
    v_cvt_pk_bf16_f32 v32, v32, v33
    v_mfma_f32_16x16x32_bf16 v[72:75], a[196:199], a[124:127], v[72:75]
    s_lshl_b32 s30, s19, 3
    ds_read_b128 a[196:199], v220 offset:13312
    v_mul_f32 v34, v34, v249
    s_waitcnt vmcnt(31)
    v_mfma_f32_16x16x32_bf16 v[72:75], a[200:203], a[128:131], v[72:75]
    s_mul_i32 s70, s19, 10
    ds_read_b128 a[200:203], v220 offset:14336
    v_mul_f32 v35, v35, v249
    s_waitcnt lgkmcnt(3)
    v_mfma_f32_16x16x32_bf16 v[64:67], a[204:207], a[84:87], v[64:67]
    s_sub_u32 s30, s30, 8
    v_cvt_pk_bf16_f32 v33, v34, v35
    v_mul_f32 v38, v38, v249
    s_waitcnt vmcnt(27)
    v_mfma_f32_16x16x32_bf16 v[64:67], a[208:211], a[88:91], v[64:67]
    s_sub_u32 s70, s70, 9
    v_mul_f32 v39, v39, v249
    v_cvt_pk_bf16_f32 v35, v38, v39
    s_waitcnt vmcnt(26)
    v_mfma_f32_16x16x32_bf16 v[64:67], a[212:215], a[92:95], v[64:67]
    s_lshl_b64 s[52:53], s[40:41], s30
    v_mul_f32 v44, v44, v249
    v_cvt_pk_bf16_f32 v38, v44, 0
    v_mfma_f32_16x16x32_bf16 v[68:71], a[204:207], a[108:111], v[68:71]
    s_lshl_b64 s[70:71], 1, s70
    v_mov_b32 v44, 0
    v_mov_b32 v45, 0
    s_waitcnt vmcnt(22)
    v_mfma_f32_16x16x32_bf16 v[68:71], a[208:211], a[112:115], v[68:71]
    s_add_u32 s19, s19, 1
    v_mov_b32 v46, 0
    v_mov_b32 v47, 0
    s_waitcnt vmcnt(21)
    v_mfma_f32_16x16x32_bf16 v[68:71], a[212:215], a[116:119], v[68:71]
    v_cvt_pk_bf16_f32 v88, v64, v65
    v_cvt_pk_bf16_f32 v89, v66, v67
    v_mfma_f32_16x16x32_bf16 v[72:75], a[204:207], a[132:135], v[72:75]
    s_waitcnt vmcnt(19)
    ds_read_b128 a[204:207], v220 offset:15360
    v_mul_f32 v36, v36, v249
    v_mfma_f32_16x16x32_bf16 v[72:75], a[208:211], a[136:139], v[72:75]
    s_waitcnt vmcnt(18)
    ds_read_b128 a[208:211], v220 offset:16384
    v_mul_f32 v37, v37, v249
    v_mfma_f32_16x16x32_bf16 v[72:75], a[212:215], a[140:143], v[72:75]
    ds_read_b128 a[212:215], v220 offset:17408
    v_cvt_pk_bf16_f32 v92, v68, v69
    v_smfmac_f32_16x16x64_bf16 v[56:59], v[48:51], v[204:211], v228
    v_cvt_pk_bf16_f32 v93, v70, v71
    v_cvt_pk_bf16_f32 v34, v36, v37
    v_smfmac_f32_16x16x64_bf16 v[60:63], v[48:51], v[212:219], v228
    buffer_load_dwordx4 a[0:3], v223, s[4:7], s17 offen offset:0
    v_mfma_f32_16x16x32_bf16 v[8:11], v[0:3], v[204:207], 0
    buffer_load_dwordx4 a[4:7], v223, s[4:7], s17 offen offset:64
    v_mfma_f32_16x16x32_bf16 v[8:11], v[4:7], v[208:211], v[8:11]
    v_cvt_pk_bf16_f32 v96, v72, v73
    v_cvt_pk_bf16_f32 v97, v74, v75
    v_mfma_f32_16x16x32_bf16 v[12:15], v[0:3], v[212:215], 0
    v_accvgpr_write_b32 a248, v32
    v_accvgpr_write_b32 a249, v33
    v_mfma_f32_16x16x32_bf16 v[12:15], v[4:7], v[216:219], v[12:15]
    v_accvgpr_write_b32 a250, v34
    v_accvgpr_write_b32 a251, v35
    v_mfma_f32_16x16x32_bf16 v[24:27], v[16:19], v[204:207], 0
    v_mul_f32 v40, v40, v249
    v_mul_f32 v41, v41, v249
    v_mfma_f32_16x16x32_bf16 v[24:27], v[20:23], v[208:211], v[24:27]
    v_mul_f32 v42, v42, v249
    v_mul_f32 v43, v43, v249
    v_mfma_f32_16x16x32_bf16 v[28:31], v[16:19], v[212:215], 0
    v_cvt_pk_bf16_f32 v101, v8, v12
    v_cvt_pk_bf16_f32 v103, v9, v13
    v_mfma_f32_16x16x32_bf16 v[28:31], v[20:23], v[216:219], v[28:31]
    buffer_store_dwordx2 v[100:101], v233, s[8:11], s20 offen offset:256 sc0 sc1
    v_cvt_pk_bf16_f32 v105, v10, v14
    v_mfma_f32_16x16x32_bf16 v[76:79], a[216:219], a[72:75], 0
    v_cvt_pk_bf16_f32 v107, v11, v15
    v_mov_b32 v12, 0
    v_mfma_f32_16x16x32_bf16 v[76:79], a[220:223], a[76:79], v[76:79]
    v_mov_b32 v13, 0
    v_mov_b32 v14, 0
    v_mfma_f32_16x16x32_bf16 v[76:79], a[224:227], a[80:83], v[76:79]
    v_mov_b32 v15, 0
    v_cvt_pk_bf16_f32 v109, v24, v28
    v_mfma_f32_16x16x32_bf16 v[80:83], a[216:219], a[96:99], 0
    v_cvt_pk_bf16_f32 v111, v25, v29
    v_cvt_pk_bf16_f32 v113, v26, v30
    v_mfma_f32_16x16x32_bf16 v[80:83], a[220:223], a[100:103], v[80:83]
    v_cvt_pk_bf16_f32 v115, v27, v31
    v_mov_b32 v28, 0
    v_mfma_f32_16x16x32_bf16 v[80:83], a[224:227], a[104:107], v[80:83]
    v_mov_b32 v29, 0
    v_mov_b32 v30, 0
    v_mfma_f32_16x16x32_bf16 v[84:87], a[216:219], a[120:123], 0
    ds_read_b128 a[216:219], v220 offset:18432
    v_mov_b32 v31, 0
    v_mfma_f32_16x16x32_bf16 v[84:87], a[220:223], a[124:127], v[84:87]
    ds_read_b128 a[220:223], v220 offset:19456
    v_cvt_pk_bf16_f32 v36, v40, v41
    v_mfma_f32_16x16x32_bf16 v[84:87], a[224:227], a[128:131], v[84:87]
    ds_read_b128 a[224:227], v220 offset:20480
    v_cvt_pk_bf16_f32 v37, v42, v43
    v_mfma_f32_16x16x32_bf16 v[76:79], a[228:231], a[84:87], v[76:79]
    v_accvgpr_write_b32 a252, v36
    v_accvgpr_write_b32 a253, v37
    v_mfma_f32_16x16x32_bf16 v[76:79], a[232:235], a[88:91], v[76:79]
    v_accvgpr_write_b32 a254, v38
    v_add_f32 v56, v56, v57
    v_mfma_f32_16x16x32_bf16 v[76:79], a[236:239], a[92:95], v[76:79]
    v_add_f32 v60, v60, v61
    v_cvt_pk_bf16_f32 v251, v56, v60
    v_mfma_f32_16x16x32_bf16 v[80:83], a[228:231], a[108:111], v[80:83]
    buffer_store_dwordx2 v[102:103], v233, s[8:11], s21 offen offset:256 sc0 sc1
    v_cndmask_b32 v51, v244, v231, s[70:71]
    v_mfma_f32_16x16x32_bf16 v[80:83], a[232:235], a[112:115], v[80:83]
    s_add_u32 s21, s18, 196224
    v_mad_i32_i24 v55, s30, -8, v226
    v_mfma_f32_16x16x32_bf16 v[80:83], a[236:239], a[116:119], v[80:83]
    v_cvt_pk_bf16_f32 v90, v76, v77
    v_cvt_pk_bf16_f32 v91, v78, v79
    v_mfma_f32_16x16x32_bf16 v[84:87], a[228:231], a[132:135], v[84:87]
    ds_read_b128 a[228:231], v220 offset:21504
    v_mfma_f32_16x16x32_bf16 v[84:87], a[232:235], a[136:139], v[84:87]
    ds_read_b128 a[232:235], v220 offset:22528
    v_mfma_f32_16x16x32_bf16 v[84:87], a[236:239], a[140:143], v[84:87]
    ds_read_b128 a[236:239], v220 offset:23552
    v_cvt_pk_bf16_f32 v94, v80, v81
    v_smfmac_f32_16x16x64_bf16 v[12:15], a[180:183], a[72:79], v228
    v_cvt_pk_bf16_f32 v95, v82, v83
    v_smfmac_f32_16x16x64_bf16 v[12:15], a[184:187], a[80:87], v228
    v_smfmac_f32_16x16x64_bf16 v[12:15], a[188:191], a[88:95], v228
    v_smfmac_f32_16x16x64_bf16 v[28:31], a[180:183], a[96:103], v228
    v_smfmac_f32_16x16x64_bf16 v[28:31], a[184:187], a[104:111], v228
    v_cvt_pk_bf16_f32 v98, v84, v85
    v_cvt_pk_bf16_f32 v99, v86, v87
    v_smfmac_f32_16x16x64_bf16 v[28:31], a[188:191], a[112:119], v228
    v_smfmac_f32_16x16x64_bf16 v[44:47], a[180:183], a[120:127], v228
    s_waitcnt lgkmcnt(3)
    v_smfmac_f32_16x16x64_bf16 v[44:47], a[184:187], a[128:135], v228
    buffer_store_dwordx2 v[104:105], v233, s[8:11], s22 offen offset:256 sc0 sc1
    v_add_f32 v48, v14, v15
    v_smfmac_f32_16x16x64_bf16 v[44:47], a[188:191], a[136:143], v228
    s_add_u32 s22, s18, 392448
    v_add_f32 v12, v12, v13
    v_cndmask_b32 v12, v244, v12, s[52:53]
    v_mfma_f32_16x16x32_bf16 v[64:67], a[192:195], a[72:75], 0
    v_add_f32 v49, v30, v31
    v_add_f32 v28, v28, v29
    v_mfma_f32_16x16x32_bf16 v[64:67], a[196:199], a[76:79], v[64:67]
    v_cndmask_b32 v28, v244, v28, s[52:53]
    v_mfma_f32_16x16x32_bf16 v[64:67], a[200:203], a[80:83], v[64:67]
    v_add_f32 v50, v46, v47
    v_max3_f32 v52, v48, v49, v50
    v_mfma_f32_16x16x32_bf16 v[68:71], a[192:195], a[96:99], 0
    v_max_f32 v52, v52, v51
    v_add_f32 v44, v44, v45
    v_mfma_f32_16x16x32_bf16 v[68:71], a[196:199], a[100:103], v[68:71]
    v_max_f32_dpp v52, v52, v52 row_ror:8 row_mask:0xf bank_mask:0xf
    v_cndmask_b32 v44, v244, v44, s[52:53]
    v_mfma_f32_16x16x32_bf16 v[68:71], a[200:203], a[104:107], v[68:71]
    v_max_f32_dpp v52, v52, v52 row_ror:4 row_mask:0xf bank_mask:0xf
    v_mfma_f32_16x16x32_bf16 v[72:75], a[192:195], a[120:123], 0
    ds_read_b128 a[192:195], v220 offset:24576
    v_max_f32_dpp v52, v52, v52 row_ror:2 row_mask:0xf bank_mask:0xf
    v_mfma_f32_16x16x32_bf16 v[72:75], a[196:199], a[124:127], v[72:75]
    ds_read_b128 a[196:199], v220 offset:25600
    v_max_f32_dpp v52, v52, v52 row_ror:1 row_mask:0xf bank_mask:0xf
    v_mfma_f32_16x16x32_bf16 v[72:75], a[200:203], a[128:131], v[72:75]
    ds_read_b128 a[200:203], v220 offset:26624
    v_sub_f32 v48, v48, v52
    v_mfma_f32_16x16x32_bf16 v[64:67], a[204:207], a[84:87], v[64:67]
    v_sub_f32 v49, v49, v52
    v_sub_f32 v50, v50, v52
    v_mfma_f32_16x16x32_bf16 v[64:67], a[208:211], a[88:91], v[64:67]
    v_sub_f32 v51, v51, v52
    v_mfma_f32_16x16x32_bf16 v[64:67], a[212:215], a[92:95], v[64:67]
    buffer_store_dwordx2 v[106:107], v233, s[8:11], s23 offen offset:256 sc0 sc1
    v_mfma_f32_16x16x32_bf16 v[68:71], a[204:207], a[108:111], v[68:71]
    s_add_u32 s23, s18, 588672
    v_exp_f32 v48, v48
    v_mfma_f32_16x16x32_bf16 v[68:71], a[208:211], a[112:115], v[68:71]
    v_exp_f32 v49, v49
    v_mfma_f32_16x16x32_bf16 v[68:71], a[212:215], a[116:119], v[68:71]
    v_exp_f32 v50, v50
    v_mfma_f32_16x16x32_bf16 v[72:75], a[204:207], a[132:135], v[72:75]
    ds_read_b128 a[204:207], v220 offset:27648
    v_add_f32 v53, v48, v49
    v_mfma_f32_16x16x32_bf16 v[72:75], a[208:211], a[136:139], v[72:75]
    ds_read_b128 a[208:211], v220 offset:28672
    v_mfma_f32_16x16x32_bf16 v[72:75], a[212:215], a[140:143], v[72:75]
    ds_read_b128 a[212:215], v220 offset:29696
    v_mfma_f32_16x16x32_bf16 v[0:3], a[72:75], v[88:91], 0
    v_exp_f32 v51, v51
    v_mfma_f32_16x16x32_bf16 v[4:7], a[96:99], v[88:91], 0
    v_add_f32 v54, v50, v51
    v_add_f32 v53, v53, v54
    v_mfma_f32_16x16x32_bf16 v[8:11], a[120:123], v[88:91], 0
    v_cvt_pk_bf16_f32 v88, v64, v65
    v_cvt_pk_bf16_f32 v89, v66, v67
    v_mfma_f32_16x16x32_bf16 v[16:19], a[72:75], v[92:95], 0
    v_add_f32_dpp v53, v53, v53 row_ror:8 row_mask:0xf bank_mask:0xf
    v_mfma_f32_16x16x32_bf16 v[20:23], a[96:99], v[92:95], 0
    v_mfma_f32_16x16x32_bf16 v[24:27], a[120:123], v[92:95], 0
    v_cvt_pk_bf16_f32 v92, v68, v69
    v_cvt_pk_bf16_f32 v93, v70, v71
    v_mfma_f32_16x16x32_bf16 v[32:35], a[72:75], v[96:99], 0
    buffer_load_dwordx4 a[24:27], v224, s[4:7], s17 offen offset:0
    v_mfma_f32_16x16x32_bf16 v[36:39], a[96:99], v[96:99], 0
    buffer_load_dwordx4 a[28:31], v224, s[4:7], s17 offen offset:64
    v_mfma_f32_16x16x32_bf16 v[40:43], a[120:123], v[96:99], 0
    buffer_store_dwordx2 v[108:109], v233, s[8:11], s24 offen offset:256 sc0 sc1
    v_cvt_pk_bf16_f32 v96, v72, v73
    v_mfma_f32_16x16x32_bf16 v[76:79], a[216:219], a[72:75], 0
    v_cvt_pk_bf16_f32 v97, v74, v75
    v_add_f32_dpp v53, v53, v53 row_ror:4 row_mask:0xf bank_mask:0xf
    v_mfma_f32_16x16x32_bf16 v[76:79], a[220:223], a[76:79], v[76:79]
    v_mfma_f32_16x16x32_bf16 v[76:79], a[224:227], a[80:83], v[76:79]
    v_add_f32_dpp v53, v53, v53 row_ror:2 row_mask:0xf bank_mask:0xf
    v_mfma_f32_16x16x32_bf16 v[80:83], a[216:219], a[96:99], 0
    v_mfma_f32_16x16x32_bf16 v[80:83], a[220:223], a[100:103], v[80:83]
    v_add_f32_dpp v53, v53, v53 row_ror:1 row_mask:0xf bank_mask:0xf
    v_mfma_f32_16x16x32_bf16 v[80:83], a[224:227], a[104:107], v[80:83]
    v_rcp_f32 v53, v53
    v_mfma_f32_16x16x32_bf16 v[84:87], a[216:219], a[120:123], 0
    ds_read_b128 a[216:219], v220 offset:30720
    v_mul_f32 v48, v48, v53
    v_mfma_f32_16x16x32_bf16 v[84:87], a[220:223], a[124:127], v[84:87]
    ds_read_b128 a[220:223], v220 offset:31744
    v_mul_f32 v49, v49, v53
    v_mfma_f32_16x16x32_bf16 v[84:87], a[224:227], a[128:131], v[84:87]
    s_waitcnt lgkmcnt(2)
    ds_read_b128 a[224:227], v220 offset:32768
    v_mul_f32 v50, v50, v53
    v_mfma_f32_16x16x32_bf16 v[76:79], a[228:231], a[84:87], v[76:79]
    v_mul_f32 v51, v51, v53
    v_cvt_pk_bf16_f32 v52, v48, v49
    v_mfma_f32_16x16x32_bf16 v[76:79], a[232:235], a[88:91], v[76:79]
    ds_write_b16 v55, v52 offset:0
    v_mfma_f32_16x16x32_bf16 v[76:79], a[236:239], a[92:95], v[76:79]
    buffer_store_dwordx2 v[110:111], v233, s[8:11], s25 offen offset:256 sc0 sc1
    v_cvt_pk_bf16_f32 v54, v50, v51
    v_mfma_f32_16x16x32_bf16 v[80:83], a[228:231], a[108:111], v[80:83]
    ds_write_b16_d16_hi v55, v52 offset:4
    v_mfma_f32_16x16x32_bf16 v[80:83], a[232:235], a[112:115], v[80:83]
    ds_write_b16 v55, v54 offset:64
    v_mfma_f32_16x16x32_bf16 v[80:83], a[236:239], a[116:119], v[80:83]
    ds_write_b16_d16_hi v55, v54 offset:68
    v_mfma_f32_16x16x32_bf16 v[84:87], a[228:231], a[132:135], v[84:87]
    ds_read_b128 a[228:231], v220 offset:33792
    v_cvt_pk_bf16_f32 v90, v76, v77
    v_mfma_f32_16x16x32_bf16 v[84:87], a[232:235], a[136:139], v[84:87]
    ds_read_b128 a[232:235], v220 offset:34816
    v_cvt_pk_bf16_f32 v91, v78, v79
    v_mfma_f32_16x16x32_bf16 v[84:87], a[236:239], a[140:143], v[84:87]
    ds_read_b128 a[236:239], v220 offset:35840
    v_cvt_pk_bf16_f32 v94, v80, v81
    v_mfma_f32_16x16x32_bf16 v[64:67], a[192:195], a[72:75], 0
    ds_read_b128 v[48:51], v227 offset:0
    v_cvt_pk_bf16_f32 v95, v82, v83
    v_mfma_f32_16x16x32_bf16 v[64:67], a[196:199], a[76:79], v[64:67]
    v_mfma_f32_16x16x32_bf16 v[64:67], a[200:203], a[80:83], v[64:67]
    v_mfma_f32_16x16x32_bf16 v[68:71], a[192:195], a[96:99], 0
    v_cvt_pk_bf16_f32 v98, v84, v85
    v_cvt_pk_bf16_f32 v99, v86, v87
    v_mfma_f32_16x16x32_bf16 v[68:71], a[196:199], a[100:103], v[68:71]
    v_mfma_f32_16x16x32_bf16 v[68:71], a[200:203], a[104:107], v[68:71]
    buffer_store_dwordx2 v[112:113], v233, s[8:11], s26 offen offset:256 sc0 sc1
    v_mfma_f32_16x16x32_bf16 v[72:75], a[192:195], a[120:123], 0
    ds_read_b128 a[192:195], v220 offset:36864
    v_mfma_f32_16x16x32_bf16 v[72:75], a[196:199], a[124:127], v[72:75]
    ds_read_b128 a[196:199], v220 offset:37888
    v_mfma_f32_16x16x32_bf16 v[72:75], a[200:203], a[128:131], v[72:75]
L_pad13:
    s_cbranch_execz L_pad17
    ds_read_b128 a[200:203], v220 offset:38912
    v_mfma_f32_16x16x32_bf16 v[64:67], a[204:207], a[84:87], v[64:67]
    v_mfma_f32_16x16x32_bf16 v[64:67], a[208:211], a[88:91], v[64:67]
    v_mfma_f32_16x16x32_bf16 v[64:67], a[212:215], a[92:95], v[64:67]
    v_mfma_f32_16x16x32_bf16 v[68:71], a[204:207], a[108:111], v[68:71]
    v_mfma_f32_16x16x32_bf16 v[68:71], a[208:211], a[112:115], v[68:71]
    v_mfma_f32_16x16x32_bf16 v[68:71], a[212:215], a[116:119], v[68:71]
    v_mfma_f32_16x16x32_bf16 v[72:75], a[204:207], a[132:135], v[72:75]
    ds_read_b128 a[204:207], v220 offset:39936
    v_mfma_f32_16x16x32_bf16 v[72:75], a[208:211], a[136:139], v[72:75]
    ds_read_b128 a[208:211], v220 offset:40960
    v_mfma_f32_16x16x32_bf16 v[72:75], a[212:215], a[140:143], v[72:75]
    ds_read_b128 a[212:215], v220 offset:41984
    v_mfma_f32_16x16x32_bf16 v[0:3], a[76:79], v[88:91], v[0:3]
    buffer_store_dwordx2 v[114:115], v235, s[8:11], s20 offen offset:1792 sc0 sc1
    v_mfma_f32_16x16x32_bf16 v[4:7], a[100:103], v[88:91], v[4:7]
    v_mfma_f32_16x16x32_bf16 v[8:11], a[124:127], v[88:91], v[8:11]
    v_cvt_pk_bf16_f32 v88, v64, v65
    v_cvt_pk_bf16_f32 v89, v66, v67
    v_mfma_f32_16x16x32_bf16 v[16:19], a[76:79], v[92:95], v[16:19]
    v_mfma_f32_16x16x32_bf16 v[20:23], a[100:103], v[92:95], v[20:23]
    v_mfma_f32_16x16x32_bf16 v[24:27], a[124:127], v[92:95], v[24:27]
    v_cvt_pk_bf16_f32 v92, v68, v69
    v_cvt_pk_bf16_f32 v93, v70, v71
    v_mfma_f32_16x16x32_bf16 v[32:35], a[76:79], v[96:99], v[32:35]
    v_mfma_f32_16x16x32_bf16 v[36:39], a[100:103], v[96:99], v[36:39]
    v_mfma_f32_16x16x32_bf16 v[40:43], a[124:127], v[96:99], v[40:43]
    v_cvt_pk_bf16_f32 v96, v72, v73
    v_cvt_pk_bf16_f32 v97, v74, v75
    v_mfma_f32_16x16x32_bf16 v[56:59], a[248:251], v[124:127], 0
    v_mfma_f32_16x16x32_bf16 v[56:59], a[252:255], v[128:131], v[56:59]
    v_mfma_f32_16x16x32_bf16 v[60:63], a[248:251], v[132:135], 0
    v_mfma_f32_16x16x32_bf16 v[60:63], a[252:255], v[136:139], v[60:63]
    s_waitcnt lgkmcnt(1)
    v_mfma_f32_16x16x32_bf16 v[76:79], a[216:219], a[72:75], 0
    buffer_load_dwordx4 a[48:51], v225, s[4:7], s17 offen offset:0
    v_mfma_f32_16x16x32_bf16 v[76:79], a[220:223], a[76:79], v[76:79]
    buffer_load_dwordx4 a[52:55], v225, s[4:7], s17 offen offset:64
    v_mfma_f32_16x16x32_bf16 v[76:79], a[224:227], a[80:83], v[76:79]
    buffer_store_dwordx2 v[250:251], v241, s[8:11], s26 offen offset:2560 sc0 sc1
    v_mfma_f32_16x16x32_bf16 v[80:83], a[216:219], a[96:99], 0
    v_mfma_f32_16x16x32_bf16 v[80:83], a[220:223], a[100:103], v[80:83]
    v_cvt_pk_bf16_f32 v116, v56, v60
    v_cvt_pk_bf16_f32 v118, v57, v61
    v_mfma_f32_16x16x32_bf16 v[80:83], a[224:227], a[104:107], v[80:83]
    v_cvt_pk_bf16_f32 v120, v58, v62
    v_cvt_pk_bf16_f32 v122, v59, v63
    v_mfma_f32_16x16x32_bf16 v[84:87], a[216:219], a[120:123], 0
    ds_read_b128 a[216:219], v220 offset:43008
    v_mfma_f32_16x16x32_bf16 v[84:87], a[220:223], a[124:127], v[84:87]
    ds_read_b128 a[220:223], v220 offset:44032
    v_mfma_f32_16x16x32_bf16 v[84:87], a[224:227], a[128:131], v[84:87]
    ds_read_b128 a[224:227], v220 offset:45056
    v_mfma_f32_16x16x32_bf16 v[76:79], a[228:231], a[84:87], v[76:79]
    v_mfma_f32_16x16x32_bf16 v[76:79], a[232:235], a[88:91], v[76:79]
    v_mfma_f32_16x16x32_bf16 v[76:79], a[236:239], a[92:95], v[76:79]
    v_mfma_f32_16x16x32_bf16 v[80:83], a[228:231], a[108:111], v[80:83]
    v_mfma_f32_16x16x32_bf16 v[80:83], a[232:235], a[112:115], v[80:83]
    v_mfma_f32_16x16x32_bf16 v[80:83], a[236:239], a[116:119], v[80:83]
    v_mfma_f32_16x16x32_bf16 v[84:87], a[228:231], a[132:135], v[84:87]
    ds_read_b128 a[228:231], v220 offset:46080
    v_mfma_f32_16x16x32_bf16 v[84:87], a[232:235], a[136:139], v[84:87]
    ds_read_b128 a[232:235], v220 offset:47104
    v_mfma_f32_16x16x32_bf16 v[84:87], a[236:239], a[140:143], v[84:87]
    ds_read_b128 a[236:239], v220 offset:48128
    v_cvt_pk_bf16_f32 v90, v76, v77
    v_mfma_f32_16x16x32_bf16 v[64:67], a[192:195], a[72:75], 0
    v_cvt_pk_bf16_f32 v91, v78, v79
    v_cvt_pk_bf16_f32 v94, v80, v81
    v_mfma_f32_16x16x32_bf16 v[64:67], a[196:199], a[76:79], v[64:67]
    v_cvt_pk_bf16_f32 v95, v82, v83
    v_mfma_f32_16x16x32_bf16 v[64:67], a[200:203], a[80:83], v[64:67]
    v_cvt_pk_bf16_f32 v98, v84, v85
    v_cvt_pk_bf16_f32 v99, v86, v87
    v_mfma_f32_16x16x32_bf16 v[68:71], a[192:195], a[96:99], 0
    v_mfma_f32_16x16x32_bf16 v[68:71], a[196:199], a[100:103], v[68:71]
    v_mfma_f32_16x16x32_bf16 v[68:71], a[200:203], a[104:107], v[68:71]
    v_mfma_f32_16x16x32_bf16 v[72:75], a[192:195], a[120:123], 0
    ds_read_b128 a[192:195], v220 offset:49152
    v_mfma_f32_16x16x32_bf16 v[72:75], a[196:199], a[124:127], v[72:75]
    ds_read_b128 a[196:199], v220 offset:50176
    v_mfma_f32_16x16x32_bf16 v[72:75], a[200:203], a[128:131], v[72:75]
    ds_read_b128 a[200:203], v220 offset:51200
    v_mfma_f32_16x16x32_bf16 v[64:67], a[204:207], a[84:87], v[64:67]
    v_mfma_f32_16x16x32_bf16 v[64:67], a[208:211], a[88:91], v[64:67]
    s_waitcnt lgkmcnt(6)
    v_mfma_f32_16x16x32_bf16 v[64:67], a[212:215], a[92:95], v[64:67]
    v_mfma_f32_16x16x32_bf16 v[68:71], a[204:207], a[108:111], v[68:71]
    v_mfma_f32_16x16x32_bf16 v[68:71], a[208:211], a[112:115], v[68:71]
    v_mfma_f32_16x16x32_bf16 v[68:71], a[212:215], a[116:119], v[68:71]
    v_mfma_f32_16x16x32_bf16 v[72:75], a[204:207], a[132:135], v[72:75]
    ds_read_b128 a[204:207], v220 offset:52224
    v_mfma_f32_16x16x32_bf16 v[72:75], a[208:211], a[136:139], v[72:75]
    ds_read_b128 a[208:211], v220 offset:53248
    v_mfma_f32_16x16x32_bf16 v[72:75], a[212:215], a[140:143], v[72:75]
    ds_read_b128 a[212:215], v220 offset:54272
    v_mfma_f32_16x16x32_bf16 v[56:59], a[248:251], v[140:143], 0
    v_mfma_f32_16x16x32_bf16 v[56:59], a[252:255], v[144:147], v[56:59]
    v_mfma_f32_16x16x32_bf16 v[60:63], a[248:251], v[148:151], 0
    buffer_load_dwordx4 a[8:11], v223, s[4:7], s17 offen offset:128
    v_mfma_f32_16x16x32_bf16 v[60:63], a[252:255], v[152:155], v[60:63]
    buffer_load_dwordx4 a[12:15], v223, s[4:7], s17 offen offset:192
    v_mfma_f32_16x16x32_bf16 v[0:3], a[80:83], v[88:91], v[0:3]
    v_mfma_f32_16x16x32_bf16 v[4:7], a[104:107], v[88:91], v[4:7]
    v_mfma_f32_16x16x32_bf16 v[8:11], a[128:131], v[88:91], v[8:11]
    v_cvt_pk_bf16_f32 v88, v64, v65
    v_cvt_pk_bf16_f32 v89, v66, v67
    v_mfma_f32_16x16x32_bf16 v[16:19], a[80:83], v[92:95], v[16:19]
    v_mfma_f32_16x16x32_bf16 v[20:23], a[104:107], v[92:95], v[20:23]
    v_cvt_pk_bf16_f32 v117, v56, v60
    v_cvt_pk_bf16_f32 v119, v57, v61
    v_mfma_f32_16x16x32_bf16 v[24:27], a[128:131], v[92:95], v[24:27]
    buffer_store_dwordx2 v[116:117], v235, s[8:11], s20 offen offset:1920 sc0 sc1
    v_cvt_pk_bf16_f32 v121, v58, v62
    v_mfma_f32_16x16x32_bf16 v[32:35], a[80:83], v[96:99], v[32:35]
    v_cvt_pk_bf16_f32 v123, v59, v63
    v_cvt_pk_bf16_f32 v92, v68, v69
    v_mfma_f32_16x16x32_bf16 v[36:39], a[104:107], v[96:99], v[36:39]
    v_cvt_pk_bf16_f32 v93, v70, v71
    v_mfma_f32_16x16x32_bf16 v[40:43], a[128:131], v[96:99], v[40:43]
    v_cvt_pk_bf16_f32 v96, v72, v73
    v_cvt_pk_bf16_f32 v97, v74, v75
    v_mfma_f32_16x16x32_bf16 v[76:79], a[216:219], a[72:75], 0
    v_mfma_f32_16x16x32_bf16 v[76:79], a[220:223], a[76:79], v[76:79]
    v_mfma_f32_16x16x32_bf16 v[76:79], a[224:227], a[80:83], v[76:79]
    v_mfma_f32_16x16x32_bf16 v[80:83], a[216:219], a[96:99], 0
    v_mfma_f32_16x16x32_bf16 v[80:83], a[220:223], a[100:103], v[80:83]
    v_mfma_f32_16x16x32_bf16 v[80:83], a[224:227], a[104:107], v[80:83]
    v_mfma_f32_16x16x32_bf16 v[84:87], a[216:219], a[120:123], 0
    ds_read_b128 a[216:219], v220 offset:55296
    v_mfma_f32_16x16x32_bf16 v[84:87], a[220:223], a[124:127], v[84:87]
    ds_read_b128 a[220:223], v220 offset:56320
    v_mfma_f32_16x16x32_bf16 v[84:87], a[224:227], a[128:131], v[84:87]
    s_waitcnt lgkmcnt(2)
    ds_read_b128 a[224:227], v220 offset:57344
    v_mfma_f32_16x16x32_bf16 v[76:79], a[228:231], a[84:87], v[76:79]
    buffer_store_dwordx2 v[118:119], v235, s[8:11], s20 offen offset:2304 sc0 sc1
    v_mfma_f32_16x16x32_bf16 v[76:79], a[232:235], a[88:91], v[76:79]
    v_mfma_f32_16x16x32_bf16 v[76:79], a[236:239], a[92:95], v[76:79]
    v_mfma_f32_16x16x32_bf16 v[80:83], a[228:231], a[108:111], v[80:83]
    v_mfma_f32_16x16x32_bf16 v[80:83], a[232:235], a[112:115], v[80:83]
    v_mfma_f32_16x16x32_bf16 v[80:83], a[236:239], a[116:119], v[80:83]
    v_mfma_f32_16x16x32_bf16 v[84:87], a[228:231], a[132:135], v[84:87]
    ds_read_b128 a[228:231], v220 offset:58368
    v_mfma_f32_16x16x32_bf16 v[84:87], a[232:235], a[136:139], v[84:87]
    ds_read_b128 a[232:235], v220 offset:59392
    v_mfma_f32_16x16x32_bf16 v[84:87], a[236:239], a[140:143], v[84:87]
    ds_read_b128 a[236:239], v220 offset:60416
    v_cvt_pk_bf16_f32 v90, v76, v77
    v_mfma_f32_16x16x32_bf16 v[56:59], a[248:251], v[156:159], 0
    v_cvt_pk_bf16_f32 v91, v78, v79
    v_cvt_pk_bf16_f32 v94, v80, v81
    v_mfma_f32_16x16x32_bf16 v[56:59], a[252:255], v[160:163], v[56:59]
    v_cvt_pk_bf16_f32 v95, v82, v83
    v_mfma_f32_16x16x32_bf16 v[60:63], a[248:251], v[164:167], 0
    v_cvt_pk_bf16_f32 v98, v84, v85
    v_cvt_pk_bf16_f32 v99, v86, v87
    v_mfma_f32_16x16x32_bf16 v[60:63], a[252:255], v[168:171], v[60:63]
    v_mfma_f32_16x16x32_bf16 v[64:67], a[192:195], a[72:75], 0
    buffer_store_dwordx2 v[120:121], v237, s[8:11], s24 offen offset:1536 sc0 sc1
    v_mfma_f32_16x16x32_bf16 v[64:67], a[196:199], a[76:79], v[64:67]
    v_mfma_f32_16x16x32_bf16 v[64:67], a[200:203], a[80:83], v[64:67]
    v_mfma_f32_16x16x32_bf16 v[68:71], a[192:195], a[96:99], 0
    v_mfma_f32_16x16x32_bf16 v[68:71], a[196:199], a[100:103], v[68:71]
    v_mfma_f32_16x16x32_bf16 v[68:71], a[200:203], a[104:107], v[68:71]
    v_mfma_f32_16x16x32_bf16 v[72:75], a[192:195], a[120:123], 0
    ds_read_b128 a[192:195], v220 offset:61440
    v_cvt_pk_bf16_f32 v100, v56, v60
    v_mfma_f32_16x16x32_bf16 v[72:75], a[196:199], a[124:127], v[72:75]
    ds_read_b128 a[196:199], v220 offset:62464
    v_cvt_pk_bf16_f32 v102, v57, v61
    v_mfma_f32_16x16x32_bf16 v[72:75], a[200:203], a[128:131], v[72:75]
    ds_read_b128 a[200:203], v220 offset:63488
    v_cvt_pk_bf16_f32 v104, v58, v62
    v_mfma_f32_16x16x32_bf16 v[64:67], a[204:207], a[84:87], v[64:67]
    v_cvt_pk_bf16_f32 v106, v59, v63
    v_mfma_f32_16x16x32_bf16 v[64:67], a[208:211], a[88:91], v[64:67]
    v_mfma_f32_16x16x32_bf16 v[64:67], a[212:215], a[92:95], v[64:67]
    v_mfma_f32_16x16x32_bf16 v[68:71], a[204:207], a[108:111], v[68:71]
    v_mfma_f32_16x16x32_bf16 v[68:71], a[208:211], a[112:115], v[68:71]
    buffer_store_dwordx2 v[122:123], v239, s[8:11], s24 offen offset:0 sc0 sc1
    v_mfma_f32_16x16x32_bf16 v[68:71], a[212:215], a[116:119], v[68:71]
    v_mfma_f32_16x16x32_bf16 v[72:75], a[204:207], a[132:135], v[72:75]
    ds_read_b128 a[204:207], v220 offset:64512
    v_mfma_f32_16x16x32_bf16 v[72:75], a[208:211], a[136:139], v[72:75]
    ds_read_b128 a[208:211], v221 offset:0
    v_mfma_f32_16x16x32_bf16 v[72:75], a[212:215], a[140:143], v[72:75]
    ds_read_b128 a[212:215], v221 offset:1024
    v_mfma_f32_16x16x32_bf16 v[0:3], a[84:87], v[88:91], v[0:3]
    v_mfma_f32_16x16x32_bf16 v[4:7], a[108:111], v[88:91], v[4:7]
    v_mfma_f32_16x16x32_bf16 v[8:11], a[132:135], v[88:91], v[8:11]
    v_cvt_pk_bf16_f32 v88, v64, v65
    v_cvt_pk_bf16_f32 v89, v66, v67
    v_mfma_f32_16x16x32_bf16 v[16:19], a[84:87], v[92:95], v[16:19]
    v_mfma_f32_16x16x32_bf16 v[20:23], a[108:111], v[92:95], v[20:23]
    v_mfma_f32_16x16x32_bf16 v[24:27], a[132:135], v[92:95], v[24:27]
    v_cvt_pk_bf16_f32 v92, v68, v69
    v_cvt_pk_bf16_f32 v93, v70, v71
    v_mfma_f32_16x16x32_bf16 v[32:35], a[84:87], v[96:99], v[32:35]
    v_mfma_f32_16x16x32_bf16 v[36:39], a[108:111], v[96:99], v[36:39]
    v_mfma_f32_16x16x32_bf16 v[40:43], a[132:135], v[96:99], v[40:43]
    buffer_load_dwordx4 a[32:35], v224, s[4:7], s17 offen offset:128
    v_mfma_f32_16x16x32_bf16 v[56:59], a[248:251], v[172:175], 0
    buffer_load_dwordx4 a[36:39], v224, s[4:7], s17 offen offset:192
    v_mfma_f32_16x16x32_bf16 v[56:59], a[252:255], v[176:179], v[56:59]
    v_cvt_pk_bf16_f32 v96, v72, v73
    v_cvt_pk_bf16_f32 v97, v74, v75
    v_mfma_f32_16x16x32_bf16 v[60:63], a[248:251], v[180:183], 0
    v_mfma_f32_16x16x32_bf16 v[60:63], a[252:255], v[184:187], v[60:63]
    s_waitcnt lgkmcnt(1)
    v_mfma_f32_16x16x32_bf16 v[76:79], a[216:219], a[72:75], 0
    v_mfma_f32_16x16x32_bf16 v[76:79], a[220:223], a[76:79], v[76:79]
    v_mfma_f32_16x16x32_bf16 v[76:79], a[224:227], a[80:83], v[76:79]
    v_mfma_f32_16x16x32_bf16 v[80:83], a[216:219], a[96:99], 0
    v_mfma_f32_16x16x32_bf16 v[80:83], a[220:223], a[100:103], v[80:83]
    v_mfma_f32_16x16x32_bf16 v[80:83], a[224:227], a[104:107], v[80:83]
    v_mfma_f32_16x16x32_bf16 v[84:87], a[216:219], a[120:123], 0
    ds_read_b128 a[216:219], v221 offset:2048
    v_cvt_pk_bf16_f32 v101, v56, v60
    v_mfma_f32_16x16x32_bf16 v[84:87], a[220:223], a[124:127], v[84:87]
    ds_read_b128 a[220:223], v221 offset:3072
    v_cvt_pk_bf16_f32 v103, v57, v61
    v_mfma_f32_16x16x32_bf16 v[84:87], a[224:227], a[128:131], v[84:87]
    ds_read_b128 a[224:227], v221 offset:4096
    v_cvt_pk_bf16_f32 v105, v58, v62
    v_mfma_f32_16x16x32_bf16 v[76:79], a[228:231], a[84:87], v[76:79]
    buffer_store_dwordx2 v[100:101], v235, s[8:11], s20 offen offset:2048 sc0 sc1
    v_cvt_pk_bf16_f32 v107, v59, v63
    v_mfma_f32_16x16x32_bf16 v[76:79], a[232:235], a[88:91], v[76:79]
    v_mfma_f32_16x16x32_bf16 v[76:79], a[236:239], a[92:95], v[76:79]
    v_mfma_f32_16x16x32_bf16 v[80:83], a[228:231], a[108:111], v[80:83]
    v_mfma_f32_16x16x32_bf16 v[80:83], a[232:235], a[112:115], v[80:83]
    v_mfma_f32_16x16x32_bf16 v[80:83], a[236:239], a[116:119], v[80:83]
    v_mfma_f32_16x16x32_bf16 v[84:87], a[228:231], a[132:135], v[84:87]
    ds_read_b128 a[228:231], v221 offset:5120
    v_mfma_f32_16x16x32_bf16 v[84:87], a[232:235], a[136:139], v[84:87]
    ds_read_b128 a[232:235], v221 offset:6144
    v_mfma_f32_16x16x32_bf16 v[84:87], a[236:239], a[140:143], v[84:87]
    ds_read_b128 a[236:239], v221 offset:7168
    v_cvt_pk_bf16_f32 v90, v76, v77
    v_mfma_f32_16x16x32_bf16 v[64:67], a[192:195], a[72:75], 0
    v_cvt_pk_bf16_f32 v91, v78, v79
    v_cvt_pk_bf16_f32 v94, v80, v81
    v_mfma_f32_16x16x32_bf16 v[64:67], a[196:199], a[76:79], v[64:67]
    v_cvt_pk_bf16_f32 v95, v82, v83
    v_mfma_f32_16x16x32_bf16 v[64:67], a[200:203], a[80:83], v[64:67]
    v_cvt_pk_bf16_f32 v98, v84, v85
    v_cvt_pk_bf16_f32 v99, v86, v87
    v_mfma_f32_16x16x32_bf16 v[68:71], a[192:195], a[96:99], 0
    v_mfma_f32_16x16x32_bf16 v[68:71], a[196:199], a[100:103], v[68:71]
    buffer_load_dword v243, v242, s[84:87], s89 offen
    v_mfma_f32_16x16x32_bf16 v[68:71], a[200:203], a[104:107], v[68:71]
    buffer_store_dwordx2 v[102:103], v235, s[8:11], s20 offen offset:2432 sc0 sc1
    v_mfma_f32_16x16x32_bf16 v[72:75], a[192:195], a[120:123], 0
    ds_read_b128 a[192:195], v221 offset:8192
    v_mfma_f32_16x16x32_bf16 v[72:75], a[196:199], a[124:127], v[72:75]
    ds_read_b128 a[196:199], v221 offset:9216
    v_mfma_f32_16x16x32_bf16 v[72:75], a[200:203], a[128:131], v[72:75]
    ds_read_b128 a[200:203], v221 offset:10240
    v_mfma_f32_16x16x32_bf16 v[64:67], a[204:207], a[84:87], v[64:67]
    v_mfma_f32_16x16x32_bf16 v[64:67], a[208:211], a[88:91], v[64:67]
    s_waitcnt lgkmcnt(6)
    v_mfma_f32_16x16x32_bf16 v[64:67], a[212:215], a[92:95], v[64:67]
    v_mfma_f32_16x16x32_bf16 v[68:71], a[204:207], a[108:111], v[68:71]
    v_mfma_f32_16x16x32_bf16 v[68:71], a[208:211], a[112:115], v[68:71]
    v_mfma_f32_16x16x32_bf16 v[68:71], a[212:215], a[116:119], v[68:71]
    v_mfma_f32_16x16x32_bf16 v[72:75], a[204:207], a[132:135], v[72:75]
    ds_read_b128 a[204:207], v221 offset:11264
    v_mfma_f32_16x16x32_bf16 v[72:75], a[208:211], a[136:139], v[72:75]
    ds_read_b128 a[208:211], v221 offset:12288
    v_mfma_f32_16x16x32_bf16 v[72:75], a[212:215], a[140:143], v[72:75]
    ds_read_b128 a[212:215], v221 offset:13312
    v_mfma_f32_16x16x32_bf16 v[56:59], a[248:251], v[188:191], 0
    buffer_load_dwordx4 a[56:59], v225, s[4:7], s17 offen offset:128
    v_mfma_f32_16x16x32_bf16 v[56:59], a[252:255], v[192:195], v[56:59]
    buffer_load_dwordx4 a[60:63], v225, s[4:7], s17 offen offset:192
    v_mfma_f32_16x16x32_bf16 v[60:63], a[248:251], v[196:199], 0
    v_mfma_f32_16x16x32_bf16 v[60:63], a[252:255], v[200:203], v[60:63]
    v_mfma_f32_16x16x32_bf16 v[0:3], a[88:91], v[88:91], v[0:3]
    v_mfma_f32_16x16x32_bf16 v[4:7], a[112:115], v[88:91], v[4:7]
    v_mfma_f32_16x16x32_bf16 v[8:11], a[136:139], v[88:91], v[8:11]
    buffer_store_dwordx2 v[104:105], v237, s[8:11], s24 offen offset:1664 sc0 sc1
    v_cvt_pk_bf16_f32 v88, v64, v65
    v_mfma_f32_16x16x32_bf16 v[16:19], a[88:91], v[92:95], v[16:19]
    v_cvt_pk_bf16_f32 v89, v66, v67
    v_mfma_f32_16x16x32_bf16 v[20:23], a[112:115], v[92:95], v[20:23]
    v_cvt_pk_bf16_f32 v108, v56, v60
    v_cvt_pk_bf16_f32 v110, v57, v61
    v_mfma_f32_16x16x32_bf16 v[24:27], a[136:139], v[92:95], v[24:27]
    v_cvt_pk_bf16_f32 v112, v58, v62
    v_cvt_pk_bf16_f32 v114, v59, v63
    v_mfma_f32_16x16x32_bf16 v[32:35], a[88:91], v[96:99], v[32:35]
    v_cvt_pk_bf16_f32 v92, v68, v69
    v_cvt_pk_bf16_f32 v93, v70, v71
    v_mfma_f32_16x16x32_bf16 v[36:39], a[112:115], v[96:99], v[36:39]
    v_mfma_f32_16x16x32_bf16 v[40:43], a[136:139], v[96:99], v[40:43]
    v_cvt_pk_bf16_f32 v96, v72, v73
    v_cvt_pk_bf16_f32 v97, v74, v75
    v_mfma_f32_16x16x32_bf16 v[76:79], a[216:219], a[72:75], 0
    v_mfma_f32_16x16x32_bf16 v[76:79], a[220:223], a[76:79], v[76:79]
    v_mfma_f32_16x16x32_bf16 v[76:79], a[224:227], a[80:83], v[76:79]
    v_mfma_f32_16x16x32_bf16 v[80:83], a[216:219], a[96:99], 0
    v_mfma_f32_16x16x32_bf16 v[80:83], a[220:223], a[100:103], v[80:83]
    v_mfma_f32_16x16x32_bf16 v[80:83], a[224:227], a[104:107], v[80:83]
    v_mfma_f32_16x16x32_bf16 v[84:87], a[216:219], a[120:123], 0
    ds_read_b128 a[216:219], v221 offset:14336
    v_mfma_f32_16x16x32_bf16 v[84:87], a[220:223], a[124:127], v[84:87]
    ds_read_b128 a[220:223], v221 offset:15360
    v_mfma_f32_16x16x32_bf16 v[84:87], a[224:227], a[128:131], v[84:87]
    s_waitcnt lgkmcnt(2)
    ds_read_b128 a[224:227], v221 offset:16384
    v_mfma_f32_16x16x32_bf16 v[76:79], a[228:231], a[84:87], v[76:79]
    v_mfma_f32_16x16x32_bf16 v[76:79], a[232:235], a[88:91], v[76:79]
    v_mfma_f32_16x16x32_bf16 v[76:79], a[236:239], a[92:95], v[76:79]
    v_mfma_f32_16x16x32_bf16 v[80:83], a[228:231], a[108:111], v[80:83]
    buffer_store_dwordx2 v[106:107], v239, s[8:11], s24 offen offset:128 sc0 sc1
    v_mfma_f32_16x16x32_bf16 v[80:83], a[232:235], a[112:115], v[80:83]
    v_mfma_f32_16x16x32_bf16 v[80:83], a[236:239], a[116:119], v[80:83]
    v_mfma_f32_16x16x32_bf16 v[84:87], a[228:231], a[132:135], v[84:87]
    ds_read_b128 a[228:231], v221 offset:17408
    v_mfma_f32_16x16x32_bf16 v[84:87], a[232:235], a[136:139], v[84:87]
    ds_read_b128 a[232:235], v221 offset:18432
    v_cvt_pk_bf16_f32 v90, v76, v77
    v_mfma_f32_16x16x32_bf16 v[84:87], a[236:239], a[140:143], v[84:87]
    ds_read_b128 a[236:239], v221 offset:19456
    v_cvt_pk_bf16_f32 v91, v78, v79
    v_mfma_f32_16x16x32_bf16 v[56:59], a[248:251], v[204:207], 0
    v_cvt_pk_bf16_f32 v94, v80, v81
    v_cvt_pk_bf16_f32 v95, v82, v83
    v_mfma_f32_16x16x32_bf16 v[56:59], a[252:255], v[208:211], v[56:59]
    v_mfma_f32_16x16x32_bf16 v[60:63], a[248:251], v[212:215], 0
    v_mfma_f32_16x16x32_bf16 v[60:63], a[252:255], v[216:219], v[60:63]
    v_cvt_pk_bf16_f32 v98, v84, v85
    v_cvt_pk_bf16_f32 v99, v86, v87
    v_mfma_f32_16x16x32_bf16 v[64:67], a[72:75], a[192:195], 0
    v_mfma_f32_16x16x32_bf16 v[64:67], a[76:79], a[196:199], v[64:67]
    v_mfma_f32_16x16x32_bf16 v[64:67], a[80:83], a[200:203], v[64:67]
    v_mfma_f32_16x16x32_bf16 v[68:71], a[96:99], a[192:195], 0
    v_mfma_f32_16x16x32_bf16 v[68:71], a[100:103], a[196:199], v[68:71]
    v_mfma_f32_16x16x32_bf16 v[68:71], a[104:107], a[200:203], v[68:71]
    v_cvt_pk_bf16_f32 v109, v56, v60
    v_cvt_pk_bf16_f32 v111, v57, v61
    v_mfma_f32_16x16x32_bf16 v[72:75], a[120:123], a[192:195], 0
    ds_read_b128 a[192:195], v221 offset:20480
    v_mov_b32 v56, 0
    v_mfma_f32_16x16x32_bf16 v[72:75], a[124:127], a[196:199], v[72:75]
    ds_read_b128 a[196:199], v221 offset:21504
    v_mov_b32 v57, 0
    v_mfma_f32_16x16x32_bf16 v[72:75], a[128:131], a[200:203], v[72:75]
    ds_read_b128 a[200:203], v221 offset:22528
    v_cvt_pk_bf16_f32 v113, v58, v62
    v_mfma_f32_16x16x32_bf16 v[64:67], a[84:87], a[204:207], v[64:67]
    v_cvt_pk_bf16_f32 v115, v59, v63
    v_mov_b32 v60, 0
    v_mfma_f32_16x16x32_bf16 v[64:67], a[88:91], a[208:211], v[64:67]
    v_mov_b32 v61, 0
    v_mfma_f32_16x16x32_bf16 v[64:67], a[92:95], a[212:215], v[64:67]
    v_mfma_f32_16x16x32_bf16 v[68:71], a[108:111], a[204:207], v[68:71]
    v_mfma_f32_16x16x32_bf16 v[68:71], a[112:115], a[208:211], v[68:71]
    v_mfma_f32_16x16x32_bf16 v[68:71], a[116:119], a[212:215], v[68:71]
    v_mfma_f32_16x16x32_bf16 v[72:75], a[132:135], a[204:207], v[72:75]
    buffer_load_dwordx4 a[16:19], v223, s[4:7], s17 offen offset:256
    v_mfma_f32_16x16x32_bf16 v[72:75], a[136:139], a[208:211], v[72:75]
    buffer_load_dwordx4 a[20:23], v223, s[4:7], s17 offen offset:320
    v_mfma_f32_16x16x32_bf16 v[72:75], a[140:143], a[212:215], v[72:75]
    ds_read_b128 a[204:207], v221 offset:23552
    ds_read_b128 a[208:211], v221 offset:24576
    v_mfma_f32_16x16x32_bf16 v[0:3], a[92:95], v[88:91], v[0:3]
    ds_read_b128 a[212:215], v221 offset:25600
    v_cvt_pk_bf16_f32 v124, v64, v65
    v_mfma_f32_16x16x32_bf16 v[4:7], a[116:119], v[88:91], v[4:7]
    v_cvt_pk_bf16_f32 v125, v66, v67
    v_cvt_pk_bf16_f32 v126, v68, v69
    v_mfma_f32_16x16x32_bf16 v[8:11], a[140:143], v[88:91], v[8:11]
    v_cvt_pk_bf16_f32 v127, v70, v71
    v_cvt_pk_bf16_f32 v128, v72, v73
    v_mfma_f32_16x16x32_bf16 v[16:19], a[92:95], v[92:95], v[16:19]
    buffer_store_dwordx2 v[108:109], v235, s[8:11], s20 offen offset:2176 sc0 sc1
    v_cvt_pk_bf16_f32 v129, v74, v75
    v_mfma_f32_16x16x32_bf16 v[20:23], a[116:119], v[92:95], v[20:23]
    v_max3_f32 v245, v0, v1, v2
    v_max3_f32 v246, v3, v4, v5
    v_mfma_f32_16x16x32_bf16 v[24:27], a[140:143], v[92:95], v[24:27]
    v_max3_f32 v245, v245, v6, v7
    v_max3_f32 v246, v246, v8, v9
    v_mfma_f32_16x16x32_bf16 v[32:35], a[92:95], v[96:99], v[32:35]
    v_max3_f32 v245, v245, v10, v11
    v_max3_f32 v245, v245, v246, v12
    v_mfma_f32_16x16x32_bf16 v[36:39], a[116:119], v[96:99], v[36:39]
    v_mov_b32 v246, v245
    v_max3_f32 v250, v16, v17, v18
    v_mfma_f32_16x16x32_bf16 v[40:43], a[140:143], v[96:99], v[40:43]
    s_waitcnt lgkmcnt(3)
    v_permlane32_swap_b32 v245, v246
    v_mfma_f32_16x16x32_bf16 v[76:79], a[72:75], a[216:219], 0
    v_max_f32 v245, v245, v246
    v_mov_b32 v246, v245
    v_mfma_f32_16x16x32_bf16 v[76:79], a[76:79], a[220:223], v[76:79]
    v_max3_f32 v251, v19, v20, v21
    v_max3_f32 v250, v250, v22, v23
    v_mfma_f32_16x16x32_bf16 v[76:79], a[80:83], a[224:227], v[76:79]
    v_permlane16_swap_b32 v245, v246
    v_mfma_f32_16x16x32_bf16 v[80:83], a[96:99], a[216:219], 0
    v_max_f32 v245, v245, v246
    v_sub_f32 v0, v0, v245
    v_mfma_f32_16x16x32_bf16 v[80:83], a[100:103], a[220:223], v[80:83]
    v_sub_f32 v1, v1, v245
    v_sub_f32 v2, v2, v245
    v_mfma_f32_16x16x32_bf16 v[80:83], a[104:107], a[224:227], v[80:83]
    v_exp_f32 v0, v0
    v_mfma_f32_16x16x32_bf16 v[84:87], a[120:123], a[216:219], 0
    ds_read_b128 a[216:219], v221 offset:26624
    v_sub_f32 v3, v3, v245
    v_mfma_f32_16x16x32_bf16 v[84:87], a[124:127], a[220:223], v[84:87]
    ds_read_b128 a[220:223], v221 offset:27648
    v_sub_f32 v4, v4, v245
    v_mfma_f32_16x16x32_bf16 v[84:87], a[128:131], a[224:227], v[84:87]
    ds_read_b128 a[224:227], v221 offset:28672
    v_sub_f32 v5, v5, v245
    v_mfma_f32_16x16x32_bf16 v[76:79], a[84:87], a[228:231], v[76:79]
    v_exp_f32 v1, v1
    v_mfma_f32_16x16x32_bf16 v[76:79], a[88:91], a[232:235], v[76:79]
    v_exp_f32 v2, v2
    v_mfma_f32_16x16x32_bf16 v[76:79], a[92:95], a[236:239], v[76:79]
    v_exp_f32 v3, v3
    v_mfma_f32_16x16x32_bf16 v[80:83], a[108:111], a[228:231], v[80:83]
    v_exp_f32 v4, v4
    v_mfma_f32_16x16x32_bf16 v[80:83], a[112:115], a[232:235], v[80:83]
    buffer_store_dwordx2 v[110:111], v235, s[8:11], s20 offen offset:2560 sc0 sc1
    v_sub_f32 v6, v6, v245
    v_mfma_f32_16x16x32_bf16 v[80:83], a[116:119], a[236:239], v[80:83]
    s_mov_b32 s20, s18
    v_cvt_pk_bf16_f32 v132, v76, v77
    v_cvt_pk_bf16_f32 v133, v78, v79
    v_mfma_f32_16x16x32_bf16 v[84:87], a[132:135], a[228:231], v[84:87]
    ds_read_b128 a[228:231], v221 offset:29696
    v_sub_f32 v7, v7, v245
    v_mfma_f32_16x16x32_bf16 v[84:87], a[136:139], a[232:235], v[84:87]
    ds_read_b128 a[232:235], v221 offset:30720
    v_sub_f32 v8, v8, v245
    v_mfma_f32_16x16x32_bf16 v[84:87], a[140:143], a[236:239], v[84:87]
    ds_read_b128 a[236:239], v221 offset:31744
    v_cvt_pk_bf16_f32 v134, v80, v81
    v_mfma_f32_16x16x32_bf16 v[64:67], a[72:75], a[192:195], 0
    v_cvt_pk_bf16_f32 v135, v82, v83
    v_add_f32 v247, v0, v1
    v_mfma_f32_16x16x32_bf16 v[64:67], a[76:79], a[196:199], v[64:67]
    v_exp_f32 v5, v5
    v_mfma_f32_16x16x32_bf16 v[64:67], a[80:83], a[200:203], v[64:67]
    v_cvt_pk_bf16_f32 v136, v84, v85
    v_cvt_pk_bf16_f32 v137, v86, v87
    v_mfma_f32_16x16x32_bf16 v[68:71], a[96:99], a[192:195], 0
    v_exp_f32 v6, v6
    v_mfma_f32_16x16x32_bf16 v[68:71], a[100:103], a[196:199], v[68:71]
    v_exp_f32 v7, v7
    v_mfma_f32_16x16x32_bf16 v[68:71], a[104:107], a[200:203], v[68:71]
    v_exp_f32 v8, v8
    v_mfma_f32_16x16x32_bf16 v[72:75], a[120:123], a[192:195], 0
    ds_read_b128 a[192:195], v221 offset:32768
    v_sub_f32 v9, v9, v245
    v_mfma_f32_16x16x32_bf16 v[72:75], a[124:127], a[196:199], v[72:75]
    ds_read_b128 a[196:199], v221 offset:33792
    v_sub_f32 v10, v10, v245
    v_mfma_f32_16x16x32_bf16 v[72:75], a[128:131], a[200:203], v[72:75]
    s_waitcnt lgkmcnt(5)
    ds_read_b128 a[200:203], v221 offset:34816
    v_add_f32 v248, v2, v3
    v_mfma_f32_16x16x32_bf16 v[64:67], a[84:87], a[204:207], v[64:67]
    v_add_f32 v247, v247, v4
    v_sub_f32 v11, v11, v245
    v_mfma_f32_16x16x32_bf16 v[64:67], a[88:91], a[208:211], v[64:67]
    v_exp_f32 v9, v9
    v_mfma_f32_16x16x32_bf16 v[64:67], a[92:95], a[212:215], v[64:67]
    v_exp_f32 v10, v10
    v_mfma_f32_16x16x32_bf16 v[68:71], a[108:111], a[204:207], v[68:71]
    v_sub_f32 v12, v12, v245
    v_add_f32 v248, v248, v5
    v_mfma_f32_16x16x32_bf16 v[68:71], a[112:115], a[208:211], v[68:71]
    v_add_f32 v247, v247, v6
    v_add_f32 v248, v248, v7
    v_mfma_f32_16x16x32_bf16 v[68:71], a[116:119], a[212:215], v[68:71]
    buffer_store_dwordx2 v[112:113], v237, s[8:11], s24 offen offset:1792 sc0 sc1
    v_cvt_pk_bf16_f32 v140, v64, v65
    v_mfma_f32_16x16x32_bf16 v[72:75], a[132:135], a[204:207], v[72:75]
    ds_read_b128 a[204:207], v221 offset:35840
    v_cvt_pk_bf16_f32 v141, v66, v67
    v_mfma_f32_16x16x32_bf16 v[72:75], a[136:139], a[208:211], v[72:75]
    ds_read_b128 a[208:211], v221 offset:36864
    v_add_f32 v247, v247, v8
    v_mfma_f32_16x16x32_bf16 v[72:75], a[140:143], a[212:215], v[72:75]
    ds_read_b128 a[212:215], v221 offset:37888
    v_cvt_pk_bf16_f32 v142, v68, v69
    v_mfma_f32_16x16x32_bf16 v[76:79], a[72:75], a[216:219], 0
    v_cvt_pk_bf16_f32 v143, v70, v71
    v_add_f32 v248, v248, v9
    v_mfma_f32_16x16x32_bf16 v[76:79], a[76:79], a[220:223], v[76:79]
    v_exp_f32 v11, v11
    v_mfma_f32_16x16x32_bf16 v[76:79], a[80:83], a[224:227], v[76:79]
    v_cvt_pk_bf16_f32 v144, v72, v73
    v_cvt_pk_bf16_f32 v145, v74, v75
    v_mfma_f32_16x16x32_bf16 v[80:83], a[96:99], a[216:219], 0
    v_exp_f32 v12, v12
    v_mfma_f32_16x16x32_bf16 v[80:83], a[100:103], a[220:223], v[80:83]
    v_add_f32 v247, v247, v10
    v_add_f32 v248, v248, v11
    v_mfma_f32_16x16x32_bf16 v[80:83], a[104:107], a[224:227], v[80:83]
    v_add_f32 v247, v247, v12
    v_add_f32 v247, v247, v248
    v_mfma_f32_16x16x32_bf16 v[84:87], a[120:123], a[216:219], 0
    ds_read_b128 a[216:219], v221 offset:38912
    v_mov_b32 v248, v247
    v_mfma_f32_16x16x32_bf16 v[84:87], a[124:127], a[220:223], v[84:87]
    ds_read_b128 a[220:223], v221 offset:39936
    v_max3_f32 v251, v251, v24, v25
    v_mfma_f32_16x16x32_bf16 v[84:87], a[128:131], a[224:227], v[84:87]
    s_waitcnt lgkmcnt(5)
    ds_read_b128 a[224:227], v221 offset:40960
    v_max3_f32 v250, v250, v26, v27
    v_mfma_f32_16x16x32_bf16 v[76:79], a[84:87], a[228:231], v[76:79]
    buffer_load_dwordx4 a[40:43], v224, s[4:7], s17 offen offset:256
    v_mfma_f32_16x16x32_bf16 v[76:79], a[88:91], a[232:235], v[76:79]
    buffer_load_dwordx4 a[44:47], v224, s[4:7], s17 offen offset:320
    v_mfma_f32_16x16x32_bf16 v[76:79], a[92:95], a[236:239], v[76:79]
    v_permlane32_swap_b32 v247, v248
    v_mfma_f32_16x16x32_bf16 v[80:83], a[108:111], a[228:231], v[80:83]
    v_add_f32 v247, v247, v248
    v_mov_b32 v248, v247
    v_mfma_f32_16x16x32_bf16 v[80:83], a[112:115], a[232:235], v[80:83]
    v_max3_f32 v250, v250, v251, v28
    v_mov_b32 v251, v250
    v_mfma_f32_16x16x32_bf16 v[80:83], a[116:119], a[236:239], v[80:83]
    buffer_store_dwordx2 v[114:115], v239, s[8:11], s24 offen offset:256 sc0 sc1
    v_cvt_pk_bf16_f32 v148, v76, v77
    v_mfma_f32_16x16x32_bf16 v[84:87], a[132:135], a[228:231], v[84:87]
    s_add_u32 s24, s18, 784896
    ds_read_b128 a[228:231], v221 offset:41984
    v_cvt_pk_bf16_f32 v149, v78, v79
    v_mfma_f32_16x16x32_bf16 v[84:87], a[136:139], a[232:235], v[84:87]
    s_add_u32 s25, s18, 981120
    ds_read_b128 a[232:235], v221 offset:43008
    v_max3_f32 v245, v32, v33, v34
    v_mfma_f32_16x16x32_bf16 v[84:87], a[140:143], a[236:239], v[84:87]
    s_add_u32 s26, s18, 1177344
L_pad14:
    s_cbranch_execz L_vax
    ds_read_b128 a[236:239], v221 offset:44032
    v_cvt_pk_bf16_f32 v150, v80, v81
    v_mfma_f32_16x16x32_bf16 v[64:67], a[72:75], a[192:195], 0
    s_mov_b32 s18, s17
    v_cvt_pk_bf16_f32 v151, v82, v83
    v_max3_f32 v246, v35, v36, v37
    v_mfma_f32_16x16x32_bf16 v[64:67], a[76:79], a[196:199], v[64:67]
    v_permlane16_swap_b32 v247, v248
    v_mfma_f32_16x16x32_bf16 v[64:67], a[80:83], a[200:203], v[64:67]
    v_cvt_pk_bf16_f32 v152, v84, v85
    v_cvt_pk_bf16_f32 v153, v86, v87
    v_mfma_f32_16x16x32_bf16 v[68:71], a[96:99], a[192:195], 0
    v_add_f32 v247, v247, v248
    v_max3_f32 v245, v245, v38, v39
    v_mfma_f32_16x16x32_bf16 v[68:71], a[100:103], a[196:199], v[68:71]
    v_rcp_f32 v249, v247
    v_mfma_f32_16x16x32_bf16 v[68:71], a[104:107], a[200:203], v[68:71]
    v_mul_f32 v0, v0, v249
    v_mul_f32 v1, v1, v249
    v_mfma_f32_16x16x32_bf16 v[72:75], a[120:123], a[192:195], 0
    ds_read_b128 a[192:195], v221 offset:45056
    v_cvt_pk_bf16_f32 v0, v0, v1
    v_mfma_f32_16x16x32_bf16 v[72:75], a[124:127], a[196:199], v[72:75]
    ds_read_b128 a[196:199], v221 offset:46080
    v_mul_f32 v2, v2, v249
    v_mfma_f32_16x16x32_bf16 v[72:75], a[128:131], a[200:203], v[72:75]
    s_waitcnt lgkmcnt(5)
    ds_read_b128 a[200:203], v221 offset:47104
    v_mul_f32 v3, v3, v249
    v_mfma_f32_16x16x32_bf16 v[64:67], a[84:87], a[204:207], v[64:67]
    v_cvt_pk_bf16_f32 v1, v2, v3
    v_mul_f32 v4, v4, v249
    v_mfma_f32_16x16x32_bf16 v[64:67], a[88:91], a[208:211], v[64:67]
    v_mul_f32 v5, v5, v249
    v_mul_f32 v6, v6, v249
    v_mfma_f32_16x16x32_bf16 v[64:67], a[92:95], a[212:215], v[64:67]
    v_mul_f32 v7, v7, v249
    v_cvt_pk_bf16_f32 v2, v4, v5
    v_mfma_f32_16x16x32_bf16 v[68:71], a[108:111], a[204:207], v[68:71]
    v_cvt_pk_bf16_f32 v3, v6, v7
    v_mul_f32 v8, v8, v249
    v_mfma_f32_16x16x32_bf16 v[68:71], a[112:115], a[208:211], v[68:71]
    v_mul_f32 v9, v9, v249
    v_mul_f32 v10, v10, v249
    v_mfma_f32_16x16x32_bf16 v[68:71], a[116:119], a[212:215], v[68:71]
    v_mul_f32 v11, v11, v249
    v_cvt_pk_bf16_f32 v4, v8, v9
    v_mfma_f32_16x16x32_bf16 v[72:75], a[132:135], a[204:207], v[72:75]
    ds_read_b128 a[204:207], v221 offset:48128
    v_cvt_pk_bf16_f32 v5, v10, v11
    v_mfma_f32_16x16x32_bf16 v[72:75], a[136:139], a[208:211], v[72:75]
    ds_read_b128 a[208:211], v221 offset:49152
    v_mul_f32 v12, v12, v249
    v_mfma_f32_16x16x32_bf16 v[72:75], a[140:143], a[212:215], v[72:75]
    ds_read_b128 a[212:215], v221 offset:50176
    v_cvt_pk_bf16_f32 v6, 0, v12
    v_mfma_f32_16x16x32_bf16 v[76:79], a[72:75], a[216:219], 0
    v_mov_b32 v7, 0
    v_cvt_pk_bf16_f32 v156, v64, v65
    v_mfma_f32_16x16x32_bf16 v[76:79], a[76:79], a[220:223], v[76:79]
    v_cvt_pk_bf16_f32 v157, v66, v67
    v_cvt_pk_bf16_f32 v158, v68, v69
    v_mfma_f32_16x16x32_bf16 v[76:79], a[80:83], a[224:227], v[76:79]
    v_cvt_pk_bf16_f32 v159, v70, v71
    v_cvt_pk_bf16_f32 v160, v72, v73
    v_mfma_f32_16x16x32_bf16 v[80:83], a[96:99], a[216:219], 0
    v_cvt_pk_bf16_f32 v161, v74, v75
    v_max3_f32 v246, v246, v40, v41
    v_mfma_f32_16x16x32_bf16 v[80:83], a[100:103], a[220:223], v[80:83]
    v_permlane32_swap_b32 v250, v251
    v_mfma_f32_16x16x32_bf16 v[80:83], a[104:107], a[224:227], v[80:83]
    v_max_f32 v250, v250, v251
    v_mov_b32 v251, v250
    v_mfma_f32_16x16x32_bf16 v[84:87], a[120:123], a[216:219], 0
    ds_read_b128 a[216:219], v221 offset:51200
    v_max3_f32 v245, v245, v42, v43
    v_mfma_f32_16x16x32_bf16 v[84:87], a[124:127], a[220:223], v[84:87]
    ds_read_b128 a[220:223], v221 offset:52224
    v_max3_f32 v245, v245, v246, v44
    v_mfma_f32_16x16x32_bf16 v[84:87], a[128:131], a[224:227], v[84:87]
    s_waitcnt lgkmcnt(5)
    ds_read_b128 a[224:227], v221 offset:53248
    v_mov_b32 v246, v245
    v_mfma_f32_16x16x32_bf16 v[76:79], a[84:87], a[228:231], v[76:79]
    v_permlane16_swap_b32 v250, v251
    v_mfma_f32_16x16x32_bf16 v[76:79], a[88:91], a[232:235], v[76:79]
    v_max_f32 v250, v250, v251
    v_sub_f32 v16, v16, v250
    v_mfma_f32_16x16x32_bf16 v[76:79], a[92:95], a[236:239], v[76:79]
    v_sub_f32 v17, v17, v250
    v_sub_f32 v18, v18, v250
    v_mfma_f32_16x16x32_bf16 v[80:83], a[108:111], a[228:231], v[80:83]
    v_exp_f32 v16, v16
    v_mfma_f32_16x16x32_bf16 v[80:83], a[112:115], a[232:235], v[80:83]
    v_exp_f32 v17, v17
    v_mfma_f32_16x16x32_bf16 v[80:83], a[116:119], a[236:239], v[80:83]
    v_sub_f32 v19, v19, v250
    v_cvt_pk_bf16_f32 v164, v76, v77
    v_mfma_f32_16x16x32_bf16 v[84:87], a[132:135], a[228:231], v[84:87]
    ds_read_b128 a[228:231], v221 offset:54272
    v_cvt_pk_bf16_f32 v165, v78, v79
    v_mfma_f32_16x16x32_bf16 v[84:87], a[136:139], a[232:235], v[84:87]
    buffer_load_dwordx4 a[64:67], v225, s[4:7], s17 offen offset:256
    v_mfma_f32_16x16x32_bf16 v[84:87], a[140:143], a[236:239], v[84:87]
    buffer_load_dwordx4 a[68:71], v225, s[4:7], s17 offen offset:320
    v_smfmac_f32_16x16x64_bf16 v[56:59], v[48:51], v[124:131], v228
    ds_read_b128 a[232:235], v221 offset:55296
    ds_read_b128 a[236:239], v221 offset:56320
    v_smfmac_f32_16x16x64_bf16 v[60:63], v[48:51], v[132:139], v228
    v_cvt_pk_bf16_f32 v166, v80, v81
    v_cvt_pk_bf16_f32 v167, v82, v83
    v_mfma_f32_16x16x32_bf16 v[8:11], v[0:3], v[124:127], 0
    v_cvt_pk_bf16_f32 v168, v84, v85
    v_cvt_pk_bf16_f32 v169, v86, v87
    v_mfma_f32_16x16x32_bf16 v[8:11], v[4:7], v[128:131], v[8:11]
    v_add_f32 v56, v56, v57
    v_mov_b32 v57, 0
    v_mfma_f32_16x16x32_bf16 v[12:15], v[0:3], v[132:135], 0
    v_add_f32 v60, v60, v61
    v_cvt_pk_bf16_f32 v88, v56, v60
    v_mfma_f32_16x16x32_bf16 v[12:15], v[4:7], v[136:139], v[12:15]
    v_mov_b32 v56, 0
    v_mov_b32 v60, 0
    v_mfma_f32_16x16x32_bf16 v[64:67], a[72:75], a[192:195], 0
    v_mov_b32 v61, 0
    v_sub_f32 v20, v20, v250
    v_mfma_f32_16x16x32_bf16 v[64:67], a[76:79], a[196:199], v[64:67]
    v_exp_f32 v18, v18
    v_mfma_f32_16x16x32_bf16 v[64:67], a[80:83], a[200:203], v[64:67]
    v_cvt_pk_bf16_f32 v100, v8, v12
    v_cvt_pk_bf16_f32 v102, v9, v13
    v_mfma_f32_16x16x32_bf16 v[68:71], a[96:99], a[192:195], 0
    v_cvt_pk_bf16_f32 v104, v10, v14
    v_cvt_pk_bf16_f32 v106, v11, v15
    v_mfma_f32_16x16x32_bf16 v[68:71], a[100:103], a[196:199], v[68:71]
    v_exp_f32 v19, v19
    v_mfma_f32_16x16x32_bf16 v[68:71], a[104:107], a[200:203], v[68:71]
    v_exp_f32 v20, v20
    v_mfma_f32_16x16x32_bf16 v[72:75], a[120:123], a[192:195], 0
    ds_read_b128 a[192:195], v221 offset:57344
    v_sub_f32 v21, v21, v250
    v_mfma_f32_16x16x32_bf16 v[72:75], a[124:127], a[196:199], v[72:75]
    ds_read_b128 a[196:199], v221 offset:58368
    v_sub_f32 v22, v22, v250
    v_mfma_f32_16x16x32_bf16 v[72:75], a[128:131], a[200:203], v[72:75]
    s_waitcnt lgkmcnt(3)
    ds_read_b128 a[200:203], v221 offset:59392
    v_sub_f32 v23, v23, v250
    v_mfma_f32_16x16x32_bf16 v[64:67], a[84:87], a[204:207], v[64:67]
    v_exp_f32 v21, v21
    v_mfma_f32_16x16x32_bf16 v[64:67], a[88:91], a[208:211], v[64:67]
    v_exp_f32 v22, v22
    v_mfma_f32_16x16x32_bf16 v[64:67], a[92:95], a[212:215], v[64:67]
    v_sub_f32 v24, v24, v250
    v_add_f32 v252, v16, v17
    v_mfma_f32_16x16x32_bf16 v[68:71], a[108:111], a[204:207], v[68:71]
    v_exp_f32 v23, v23
    v_mfma_f32_16x16x32_bf16 v[68:71], a[112:115], a[208:211], v[68:71]
    v_exp_f32 v24, v24
    v_mfma_f32_16x16x32_bf16 v[68:71], a[116:119], a[212:215], v[68:71]
    v_sub_f32 v25, v25, v250
    v_sub_f32 v26, v26, v250
    v_mfma_f32_16x16x32_bf16 v[72:75], a[132:135], a[204:207], v[72:75]
    ds_read_b128 a[204:207], v221 offset:60416
    v_add_f32 v253, v18, v19
    v_mfma_f32_16x16x32_bf16 v[72:75], a[136:139], a[208:211], v[72:75]
    ds_read_b128 a[208:211], v221 offset:61440
    v_add_f32 v252, v252, v20
    v_mfma_f32_16x16x32_bf16 v[72:75], a[140:143], a[212:215], v[72:75]
    ds_read_b128 a[212:215], v221 offset:62464
    v_sub_f32 v27, v27, v250
    v_smfmac_f32_16x16x64_bf16 v[56:59], v[48:51], v[140:147], v228
    v_exp_f32 v25, v25
    v_smfmac_f32_16x16x64_bf16 v[60:63], v[48:51], v[148:155], v228
    v_exp_f32 v26, v26
    v_mfma_f32_16x16x32_bf16 v[8:11], v[0:3], v[140:143], 0
    v_sub_f32 v28, v28, v250
    v_add_f32 v253, v253, v21
    v_mfma_f32_16x16x32_bf16 v[8:11], v[4:7], v[144:147], v[8:11]
    v_add_f32 v252, v252, v22
    v_add_f32 v253, v253, v23
    v_mfma_f32_16x16x32_bf16 v[12:15], v[0:3], v[148:151], 0
    v_exp_f32 v27, v27
    v_mfma_f32_16x16x32_bf16 v[12:15], v[4:7], v[152:155], v[12:15]
    v_exp_f32 v28, v28
    v_mfma_f32_16x16x32_bf16 v[76:79], a[72:75], a[216:219], 0
    v_add_f32 v252, v252, v24
    v_add_f32 v253, v253, v25
    v_mfma_f32_16x16x32_bf16 v[76:79], a[76:79], a[220:223], v[76:79]
    v_add_f32 v252, v252, v26
    v_add_f32 v253, v253, v27
    v_mfma_f32_16x16x32_bf16 v[76:79], a[80:83], a[224:227], v[76:79]
    v_add_f32 v252, v252, v28
    v_add_f32 v252, v252, v253
    v_mfma_f32_16x16x32_bf16 v[80:83], a[96:99], a[216:219], 0
    v_mov_b32 v253, v252
    v_add_f32 v56, v56, v57
    v_mfma_f32_16x16x32_bf16 v[80:83], a[100:103], a[220:223], v[80:83]
    v_permlane32_swap_b32 v252, v253
    v_mfma_f32_16x16x32_bf16 v[80:83], a[104:107], a[224:227], v[80:83]
    v_add_f32 v252, v252, v253
    v_mov_b32 v253, v252
    v_mfma_f32_16x16x32_bf16 v[84:87], a[120:123], a[216:219], 0
    ds_read_b128 a[216:219], v221 offset:63488
    v_add_f32 v60, v60, v61
    v_mfma_f32_16x16x32_bf16 v[84:87], a[124:127], a[220:223], v[84:87]
    ds_read_b128 a[220:223], v221 offset:64512
    v_cvt_pk_bf16_f32 v89, v56, v60
    v_mfma_f32_16x16x32_bf16 v[84:87], a[128:131], a[224:227], v[84:87]
    ds_read_b128 a[224:227], v222 offset:0
    v_mov_b32 v56, 0
    v_mfma_f32_16x16x32_bf16 v[76:79], a[84:87], a[228:231], v[76:79]
    buffer_store_dwordx2 v[88:89], v241, s[8:11], s26 offen offset:2304 sc0 sc1
    v_mov_b32 v57, 0
    v_mfma_f32_16x16x32_bf16 v[76:79], a[88:91], a[232:235], v[76:79]
    s_waitcnt lgkmcnt(3)
    v_permlane16_swap_b32 v252, v253
    v_mfma_f32_16x16x32_bf16 v[76:79], a[92:95], a[236:239], v[76:79]
    v_add_f32 v252, v252, v253
    v_mov_b32 v60, 0
    v_mfma_f32_16x16x32_bf16 v[80:83], a[108:111], a[228:231], v[80:83]
    v_rcp_f32 v254, v252
    v_mfma_f32_16x16x32_bf16 v[80:83], a[112:115], a[232:235], v[80:83]
    v_mul_f32 v16, v16, v254
    v_mul_f32 v17, v17, v254
    v_mfma_f32_16x16x32_bf16 v[80:83], a[116:119], a[236:239], v[80:83]
    v_cvt_pk_bf16_f32 v16, v16, v17
    v_mul_f32 v18, v18, v254
    v_mfma_f32_16x16x32_bf16 v[84:87], a[132:135], a[228:231], v[84:87]
    ds_read_b128 a[228:231], v222 offset:1024
    v_mul_f32 v19, v19, v254
    v_mfma_f32_16x16x32_bf16 v[84:87], a[136:139], a[232:235], v[84:87]
    ds_read_b128 a[232:235], v222 offset:2048
    v_cvt_pk_bf16_f32 v17, v18, v19
    v_mfma_f32_16x16x32_bf16 v[84:87], a[140:143], a[236:239], v[84:87]
    ds_read_b128 a[236:239], v222 offset:3072
    v_mul_f32 v20, v20, v254
    v_mul_f32 v21, v21, v254
    v_mul_f32 v22, v22, v254
    v_mul_f32 v23, v23, v254
    v_cvt_pk_bf16_f32 v18, v20, v21
    v_cvt_pk_bf16_f32 v19, v22, v23
    v_mul_f32 v24, v24, v254
    v_mul_f32 v25, v25, v254
    v_mul_f32 v26, v26, v254
    v_mul_f32 v27, v27, v254
    v_cvt_pk_bf16_f32 v20, v24, v25
    v_cvt_pk_bf16_f32 v21, v26, v27
    v_mfma_f32_16x16x32_bf16 v[24:27], v[16:19], v[124:127], 0
    v_mul_f32 v28, v28, v254
    v_cvt_pk_bf16_f32 v22, 0, v28
    v_mov_b32 v23, 0
    s_nop 0
    s_nop 0
    v_mfma_f32_16x16x32_bf16 v[24:27], v[20:23], v[128:131], v[24:27]
    v_mov_b32 v61, 0
    v_cvt_pk_bf16_f32 v101, v8, v12
    v_mfma_f32_16x16x32_bf16 v[28:31], v[16:19], v[132:135], 0
    buffer_store_dwordx2 v[100:101], v233, s[8:11], s20 offen offset:0 sc0 sc1
    v_cvt_pk_bf16_f32 v103, v9, v13
    v_mfma_f32_16x16x32_bf16 v[28:31], v[20:23], v[136:139], v[28:31]
    v_cvt_pk_bf16_f32 v105, v10, v14
    v_cvt_pk_bf16_f32 v107, v11, v15
    v_smfmac_f32_16x16x64_bf16 v[56:59], v[48:51], v[156:163], v228
    v_cvt_pk_bf16_f32 v172, v64, v65
    v_cvt_pk_bf16_f32 v173, v66, v67
    v_smfmac_f32_16x16x64_bf16 v[60:63], v[48:51], v[164:171], v228
    v_cvt_pk_bf16_f32 v174, v68, v69
    v_cvt_pk_bf16_f32 v175, v70, v71
    v_mfma_f32_16x16x32_bf16 v[8:11], v[0:3], v[156:159], 0
    v_cvt_pk_bf16_f32 v108, v24, v28
    v_cvt_pk_bf16_f32 v110, v25, v29
    v_mfma_f32_16x16x32_bf16 v[8:11], v[4:7], v[160:163], v[8:11]
    v_cvt_pk_bf16_f32 v112, v26, v30
    v_cvt_pk_bf16_f32 v114, v27, v31
    v_mfma_f32_16x16x32_bf16 v[12:15], v[0:3], v[164:167], 0
    v_cvt_pk_bf16_f32 v176, v72, v73
    v_cvt_pk_bf16_f32 v177, v74, v75
    v_mfma_f32_16x16x32_bf16 v[12:15], v[4:7], v[168:171], v[12:15]
    v_add_f32 v56, v56, v57
    v_add_f32 v60, v60, v61
    v_mfma_f32_16x16x32_bf16 v[24:27], v[16:19], v[140:143], 0
    buffer_store_dwordx2 v[102:103], v233, s[8:11], s21 offen offset:0 sc0 sc1
    v_cvt_pk_bf16_f32 v90, v56, v60
    v_mfma_f32_16x16x32_bf16 v[24:27], v[20:23], v[144:147], v[24:27]
    v_mov_b32 v56, 0
    v_mov_b32 v57, 0
    v_mfma_f32_16x16x32_bf16 v[28:31], v[16:19], v[148:151], 0
    v_cvt_pk_bf16_f32 v180, v76, v77
    v_cvt_pk_bf16_f32 v181, v78, v79
    v_mfma_f32_16x16x32_bf16 v[28:31], v[20:23], v[152:155], v[28:31]
    v_cvt_pk_bf16_f32 v182, v80, v81
    v_cvt_pk_bf16_f32 v183, v82, v83
    v_mfma_f32_16x16x32_bf16 v[64:67], a[72:75], a[192:195], 0
    v_cvt_pk_bf16_f32 v184, v84, v85
    v_cvt_pk_bf16_f32 v185, v86, v87
    v_mfma_f32_16x16x32_bf16 v[64:67], a[76:79], a[196:199], v[64:67]
    v_mov_b32 v60, 0
    v_mov_b32 v61, 0
    v_mfma_f32_16x16x32_bf16 v[64:67], a[80:83], a[200:203], v[64:67]
    v_cvt_pk_bf16_f32 v109, v24, v28
    v_cvt_pk_bf16_f32 v111, v25, v29
    v_mfma_f32_16x16x32_bf16 v[68:71], a[96:99], a[192:195], 0
    v_cvt_pk_bf16_f32 v113, v26, v30
    v_cvt_pk_bf16_f32 v115, v27, v31
    v_mfma_f32_16x16x32_bf16 v[68:71], a[100:103], a[196:199], v[68:71]
    buffer_store_dwordx2 v[104:105], v233, s[8:11], s22 offen offset:0 sc0 sc1
    v_cvt_pk_bf16_f32 v116, v8, v12
    v_mfma_f32_16x16x32_bf16 v[68:71], a[104:107], a[200:203], v[68:71]
    v_cvt_pk_bf16_f32 v118, v9, v13
    v_cvt_pk_bf16_f32 v120, v10, v14
    v_mfma_f32_16x16x32_bf16 v[72:75], a[120:123], a[192:195], 0
    ds_read_b128 a[192:195], v222 offset:4096
    v_cvt_pk_bf16_f32 v122, v11, v15
    v_mfma_f32_16x16x32_bf16 v[72:75], a[124:127], a[196:199], v[72:75]
    ds_read_b128 a[196:199], v222 offset:5120
    v_mfma_f32_16x16x32_bf16 v[72:75], a[128:131], a[200:203], v[72:75]
    ds_read_b128 a[200:203], v222 offset:6144
    v_mfma_f32_16x16x32_bf16 v[64:67], a[84:87], a[204:207], v[64:67]
    v_permlane32_swap_b32 v245, v246
    v_mfma_f32_16x16x32_bf16 v[64:67], a[88:91], a[208:211], v[64:67]
    v_max_f32 v245, v245, v246
    v_mov_b32 v246, v245
    v_mfma_f32_16x16x32_bf16 v[64:67], a[92:95], a[212:215], v[64:67]
    v_mfma_f32_16x16x32_bf16 v[68:71], a[108:111], a[204:207], v[68:71]
    buffer_store_dwordx2 v[106:107], v233, s[8:11], s23 offen offset:0 sc0 sc1
    v_mfma_f32_16x16x32_bf16 v[68:71], a[112:115], a[208:211], v[68:71]
    v_permlane16_swap_b32 v245, v246
    v_mfma_f32_16x16x32_bf16 v[68:71], a[116:119], a[212:215], v[68:71]
    v_max_f32 v245, v245, v246
    v_sub_f32 v32, v32, v245
    v_mfma_f32_16x16x32_bf16 v[72:75], a[132:135], a[204:207], v[72:75]
    ds_read_b128 a[204:207], v222 offset:7168
    v_cvt_pk_bf16_f32 v188, v64, v65
    v_mfma_f32_16x16x32_bf16 v[72:75], a[136:139], a[208:211], v[72:75]
    ds_read_b128 a[208:211], v222 offset:8192
    v_cvt_pk_bf16_f32 v189, v66, v67
    v_mfma_f32_16x16x32_bf16 v[72:75], a[140:143], a[212:215], v[72:75]
    ds_read_b128 a[212:215], v222 offset:9216
    v_cvt_pk_bf16_f32 v190, v68, v69
    v_mfma_f32_16x16x32_bf16 v[24:27], v[16:19], v[156:159], 0
    v_cvt_pk_bf16_f32 v191, v70, v71
    v_sub_f32 v33, v33, v245
    v_mfma_f32_16x16x32_bf16 v[24:27], v[20:23], v[160:163], v[24:27]
    v_exp_f32 v32, v32
    v_mfma_f32_16x16x32_bf16 v[28:31], v[16:19], v[164:167], 0
    buffer_store_dwordx2 v[108:109], v233, s[8:11], s24 offen offset:0 sc0 sc1
    v_cvt_pk_bf16_f32 v192, v72, v73
    v_mfma_f32_16x16x32_bf16 v[28:31], v[20:23], v[168:171], v[28:31]
    v_cvt_pk_bf16_f32 v193, v74, v75
    v_sub_f32 v34, v34, v245
    v_smfmac_f32_16x16x64_bf16 v[56:59], v[48:51], v[172:179], v228
    v_exp_f32 v33, v33
    v_smfmac_f32_16x16x64_bf16 v[60:63], v[48:51], v[180:187], v228
    v_sub_f32 v35, v35, v245
    v_sub_f32 v36, v36, v245
    v_mfma_f32_16x16x32_bf16 v[8:11], v[0:3], v[172:175], 0
    v_cvt_pk_bf16_f32 v92, v24, v28
    v_cvt_pk_bf16_f32 v94, v25, v29
    v_mfma_f32_16x16x32_bf16 v[8:11], v[4:7], v[176:179], v[8:11]
    v_cvt_pk_bf16_f32 v96, v26, v30
    v_cvt_pk_bf16_f32 v98, v27, v31
    v_mfma_f32_16x16x32_bf16 v[12:15], v[0:3], v[180:183], 0
    v_add_f32 v56, v56, v57
    v_add_f32 v60, v60, v61
    v_mfma_f32_16x16x32_bf16 v[12:15], v[4:7], v[184:187], v[12:15]
    v_cvt_pk_bf16_f32 v91, v56, v60
    v_mov_b32 v56, 0
    v_mfma_f32_16x16x32_bf16 v[24:27], v[16:19], v[172:175], 0
    buffer_store_dwordx2 v[110:111], v233, s[8:11], s25 offen offset:0 sc0 sc1
    v_mov_b32 v57, 0
    v_mfma_f32_16x16x32_bf16 v[24:27], v[20:23], v[176:179], v[24:27]
    v_mov_b32 v60, 0
    v_mov_b32 v61, 0
    v_mfma_f32_16x16x32_bf16 v[28:31], v[16:19], v[180:183], 0
    v_cvt_pk_bf16_f32 v117, v8, v12
    v_cvt_pk_bf16_f32 v119, v9, v13
    v_mfma_f32_16x16x32_bf16 v[28:31], v[20:23], v[184:187], v[28:31]
    s_waitcnt lgkmcnt(0)
    v_cvt_pk_bf16_f32 v121, v10, v14
    v_cvt_pk_bf16_f32 v123, v11, v15
    v_mfma_f32_16x16x32_bf16 v[76:79], a[72:75], a[216:219], 0
    v_exp_f32 v34, v34
    v_mfma_f32_16x16x32_bf16 v[76:79], a[76:79], a[220:223], v[76:79]
    v_exp_f32 v35, v35
    v_mfma_f32_16x16x32_bf16 v[76:79], a[80:83], a[224:227], v[76:79]
    v_exp_f32 v36, v36
    v_mfma_f32_16x16x32_bf16 v[80:83], a[96:99], a[216:219], 0
    v_cvt_pk_bf16_f32 v93, v24, v28
    v_cvt_pk_bf16_f32 v95, v25, v29
    v_mfma_f32_16x16x32_bf16 v[80:83], a[100:103], a[220:223], v[80:83]
    buffer_store_dwordx2 v[112:113], v233, s[8:11], s26 offen offset:0 sc0 sc1
    v_cvt_pk_bf16_f32 v97, v26, v30
    v_mfma_f32_16x16x32_bf16 v[80:83], a[104:107], a[224:227], v[80:83]
    v_cvt_pk_bf16_f32 v99, v27, v31
    v_sub_f32 v37, v37, v245
    v_mfma_f32_16x16x32_bf16 v[84:87], a[120:123], a[216:219], 0
    ds_read_b128 a[216:219], v222 offset:10240
    v_sub_f32 v38, v38, v245
    v_mfma_f32_16x16x32_bf16 v[84:87], a[124:127], a[220:223], v[84:87]
    ds_read_b128 a[220:223], v222 offset:11264
    v_sub_f32 v39, v39, v245
    v_mfma_f32_16x16x32_bf16 v[84:87], a[128:131], a[224:227], v[84:87]
    ds_read_b128 a[224:227], v222 offset:12288
    v_sub_f32 v40, v40, v245
    v_mfma_f32_16x16x32_bf16 v[76:79], a[84:87], a[228:231], v[76:79]
    v_exp_f32 v37, v37
    v_mfma_f32_16x16x32_bf16 v[76:79], a[88:91], a[232:235], v[76:79]
    v_exp_f32 v38, v38
    v_mfma_f32_16x16x32_bf16 v[76:79], a[92:95], a[236:239], v[76:79]
    v_add_f32 v247, v32, v33
    v_sub_f32 v41, v41, v245
    v_mfma_f32_16x16x32_bf16 v[80:83], a[108:111], a[228:231], v[80:83]
    buffer_store_dwordx2 v[114:115], v235, s[8:11], s20 offen offset:1536 sc0 sc1
    v_sub_f32 v42, v42, v245
    v_mfma_f32_16x16x32_bf16 v[80:83], a[112:115], a[232:235], v[80:83]
    v_exp_f32 v39, v39
    v_mfma_f32_16x16x32_bf16 v[80:83], a[116:119], a[236:239], v[80:83]
    v_cvt_pk_bf16_f32 v196, v76, v77
    v_cvt_pk_bf16_f32 v197, v78, v79
    v_mfma_f32_16x16x32_bf16 v[84:87], a[132:135], a[228:231], v[84:87]
    ds_read_b128 a[228:231], v222 offset:13312
    v_add_f32 v248, v34, v35
    v_mfma_f32_16x16x32_bf16 v[84:87], a[136:139], a[232:235], v[84:87]
    ds_read_b128 a[232:235], v222 offset:14336
    v_add_f32 v247, v247, v36
    v_mfma_f32_16x16x32_bf16 v[84:87], a[140:143], a[236:239], v[84:87]
    ds_read_b128 a[236:239], v222 offset:15360
    v_cvt_pk_bf16_f32 v198, v80, v81
    v_mfma_f32_16x16x32_bf16 v[64:67], a[72:75], a[192:195], 0
    v_cvt_pk_bf16_f32 v199, v82, v83
    v_sub_f32 v43, v43, v245
    v_mfma_f32_16x16x32_bf16 v[64:67], a[76:79], a[196:199], v[64:67]
    v_exp_f32 v40, v40
    v_mfma_f32_16x16x32_bf16 v[64:67], a[80:83], a[200:203], v[64:67]
    buffer_store_dwordx2 v[90:91], v241, s[8:11], s26 offen offset:2432 sc0 sc1
    v_cvt_pk_bf16_f32 v200, v84, v85
    v_mfma_f32_16x16x32_bf16 v[68:71], a[96:99], a[192:195], 0
    v_cvt_pk_bf16_f32 v201, v86, v87
    v_sub_f32 v44, v44, v245
    v_mfma_f32_16x16x32_bf16 v[68:71], a[100:103], a[196:199], v[68:71]
    v_exp_f32 v41, v41
    v_mfma_f32_16x16x32_bf16 v[68:71], a[104:107], a[200:203], v[68:71]
    v_exp_f32 v42, v42
    v_mfma_f32_16x16x32_bf16 v[72:75], a[120:123], a[192:195], 0
    ds_read_b128 a[192:195], v220 offset:0
    v_add_f32 v248, v248, v37
    v_mfma_f32_16x16x32_bf16 v[72:75], a[124:127], a[196:199], v[72:75]
    ds_read_b128 a[196:199], v220 offset:1024
    v_add_f32 v247, v247, v38
    v_mfma_f32_16x16x32_bf16 v[72:75], a[128:131], a[200:203], v[72:75]
    ds_read_b128 a[200:203], v220 offset:2048
    v_add_f32 v248, v248, v39
    v_mfma_f32_16x16x32_bf16 v[64:67], a[84:87], a[204:207], v[64:67]
    v_exp_f32 v43, v43
    v_mfma_f32_16x16x32_bf16 v[64:67], a[88:91], a[208:211], v[64:67]
    buffer_store_dwordx2 v[116:117], v233, s[8:11], s20 offen offset:128 sc0 sc1
    v_add_f32 v247, v247, v40
    v_mfma_f32_16x16x32_bf16 v[64:67], a[92:95], a[212:215], v[64:67]
    v_exp_f32 v44, v44
    v_mfma_f32_16x16x32_bf16 v[68:71], a[108:111], a[204:207], v[68:71]
    v_add_f32 v248, v248, v41
    v_add_f32 v247, v247, v42
    v_mfma_f32_16x16x32_bf16 v[68:71], a[112:115], a[208:211], v[68:71]
    v_add_f32 v248, v248, v43
    v_add_f32 v247, v247, v44
    v_mfma_f32_16x16x32_bf16 v[68:71], a[116:119], a[212:215], v[68:71]
    v_add_f32 v247, v247, v248
    v_mov_b32 v248, v247
    v_mfma_f32_16x16x32_bf16 v[72:75], a[132:135], a[204:207], v[72:75]
    ds_read_b128 a[204:207], v220 offset:3072
    v_cvt_pk_bf16_f32 v204, v64, v65
    v_mfma_f32_16x16x32_bf16 v[72:75], a[136:139], a[208:211], v[72:75]
    ds_read_b128 a[208:211], v220 offset:4096
    v_cvt_pk_bf16_f32 v205, v66, v67
    v_mfma_f32_16x16x32_bf16 v[72:75], a[140:143], a[212:215], v[72:75]
    ds_read_b128 a[212:215], v220 offset:5120
    v_cvt_pk_bf16_f32 v206, v68, v69
    v_smfmac_f32_16x16x64_bf16 v[56:59], v[48:51], v[188:195], v228
    buffer_store_dwordx2 v[118:119], v233, s[8:11], s21 offen offset:128 sc0 sc1
    v_cvt_pk_bf16_f32 v207, v70, v71
    v_smfmac_f32_16x16x64_bf16 v[60:63], v[48:51], v[196:203], v228
    v_permlane32_swap_b32 v247, v248
    v_mfma_f32_16x16x32_bf16 v[8:11], v[0:3], v[188:191], 0
    v_add_f32 v247, v247, v248
    v_mov_b32 v248, v247
    v_mfma_f32_16x16x32_bf16 v[8:11], v[4:7], v[192:195], v[8:11]
    v_add_f32 v56, v56, v57
    v_cvt_pk_bf16_f32 v208, v72, v73
    v_mfma_f32_16x16x32_bf16 v[12:15], v[0:3], v[196:199], 0
    v_permlane16_swap_b32 v247, v248
    v_mfma_f32_16x16x32_bf16 v[12:15], v[4:7], v[200:203], v[12:15]
    v_add_f32 v247, v247, v248
    v_add_f32 v60, v60, v61
    v_mfma_f32_16x16x32_bf16 v[24:27], v[16:19], v[188:191], 0
    v_rcp_f32 v249, v247
    v_mfma_f32_16x16x32_bf16 v[24:27], v[20:23], v[192:195], v[24:27]
    v_cvt_pk_bf16_f32 v250, v56, v60
    v_cvt_pk_bf16_f32 v209, v74, v75
    v_mfma_f32_16x16x32_bf16 v[28:31], v[16:19], v[196:199], 0
    buffer_store_dwordx2 v[120:121], v233, s[8:11], s22 offen offset:128 sc0 sc1
    v_cvt_pk_bf16_f32 v100, v8, v12
    v_mfma_f32_16x16x32_bf16 v[28:31], v[20:23], v[200:203], v[28:31]
    s_waitcnt lgkmcnt(3)
    v_cvt_pk_bf16_f32 v102, v9, v13
    v_cvt_pk_bf16_f32 v104, v10, v14
    v_mfma_f32_16x16x32_bf16 v[76:79], a[72:75], a[216:219], 0
    v_cvt_pk_bf16_f32 v106, v11, v15
    v_mfma_f32_16x16x32_bf16 v[76:79], a[76:79], a[220:223], v[76:79]
    v_mfma_f32_16x16x32_bf16 v[76:79], a[80:83], a[224:227], v[76:79]
    v_mfma_f32_16x16x32_bf16 v[80:83], a[96:99], a[216:219], 0
    v_mfma_f32_16x16x32_bf16 v[80:83], a[100:103], a[220:223], v[80:83]
    v_cvt_pk_bf16_f32 v108, v24, v28
    v_cvt_pk_bf16_f32 v110, v25, v29
    v_mfma_f32_16x16x32_bf16 v[80:83], a[104:107], a[224:227], v[80:83]
    v_cvt_pk_bf16_f32 v112, v26, v30
    v_cvt_pk_bf16_f32 v114, v27, v31
    v_mfma_f32_16x16x32_bf16 v[84:87], a[120:123], a[216:219], 0
    buffer_store_dwordx2 v[122:123], v233, s[8:11], s23 offen offset:128 sc0 sc1
    ds_read_b128 a[216:219], v220 offset:6144
    v_mfma_f32_16x16x32_bf16 v[84:87], a[124:127], a[220:223], v[84:87]
    ds_read_b128 a[220:223], v220 offset:7168
    v_mfma_f32_16x16x32_bf16 v[84:87], a[128:131], a[224:227], v[84:87]
    ds_read_b128 a[224:227], v220 offset:8192
    v_mfma_f32_16x16x32_bf16 v[76:79], a[84:87], a[228:231], v[76:79]
    v_mfma_f32_16x16x32_bf16 v[76:79], a[88:91], a[232:235], v[76:79]
    v_mfma_f32_16x16x32_bf16 v[76:79], a[92:95], a[236:239], v[76:79]
    v_mfma_f32_16x16x32_bf16 v[80:83], a[108:111], a[228:231], v[80:83]
    v_mfma_f32_16x16x32_bf16 v[80:83], a[112:115], a[232:235], v[80:83]
    v_mfma_f32_16x16x32_bf16 v[80:83], a[116:119], a[236:239], v[80:83]
    buffer_store_dwordx2 v[92:93], v233, s[8:11], s24 offen offset:128 sc0 sc1
    v_mfma_f32_16x16x32_bf16 v[84:87], a[132:135], a[228:231], v[84:87]
    ds_read_b128 a[228:231], v220 offset:9216
    v_mfma_f32_16x16x32_bf16 v[84:87], a[136:139], a[232:235], v[84:87]
    ds_read_b128 a[232:235], v220 offset:10240
    v_mfma_f32_16x16x32_bf16 v[84:87], a[140:143], a[236:239], v[84:87]
    ds_read_b128 a[236:239], v220 offset:11264
    buffer_store_dwordx2 v[94:95], v233, s[8:11], s25 offen offset:128 sc0 sc1
    buffer_store_dwordx2 v[96:97], v233, s[8:11], s26 offen offset:128 sc0 sc1
    buffer_store_dwordx2 v[98:99], v235, s[8:11], s20 offen offset:1664 sc0 sc1
    s_cmp_lg_u32 s19, 4
    s_cbranch_scc1 L_b0
L_epi:
    s_waitcnt vmcnt(57)
    v_mfma_f32_16x16x32_bf16 v[64:67], a[192:195], a[0:3], 0
    s_lshl_b32 s30, s19, 3
    v_mov_b32 v56, 0
    v_mov_b32 v57, 0
    s_waitcnt vmcnt(56)
    v_mfma_f32_16x16x32_bf16 v[64:67], a[196:199], a[4:7], v[64:67]
    s_mul_i32 s70, s19, 10
    v_cvt_pk_bf16_f32 v212, v76, v77
    v_cvt_pk_bf16_f32 v213, v78, v79
    s_waitcnt vmcnt(42)
    v_mfma_f32_16x16x32_bf16 v[64:67], a[200:203], a[8:11], v[64:67]
    s_lshl_b64 s[52:53], s[40:41], s30
    v_cvt_pk_bf16_f32 v214, v80, v81
    v_cvt_pk_bf16_f32 v215, v82, v83
    v_mfma_f32_16x16x32_bf16 v[68:71], a[192:195], a[24:27], 0
    s_lshl_b64 s[70:71], 1, s70
    v_cvt_pk_bf16_f32 v216, v84, v85
    v_cvt_pk_bf16_f32 v217, v86, v87
    v_mfma_f32_16x16x32_bf16 v[68:71], a[196:199], a[28:31], v[68:71]
    s_add_u32 s19, s19, 1
    v_mov_b32 v60, 0
    v_mov_b32 v61, 0
    s_waitcnt vmcnt(36)
    v_mfma_f32_16x16x32_bf16 v[68:71], a[200:203], a[32:35], v[68:71]
    v_mul_f32 v32, v32, v249
    v_mul_f32 v33, v33, v249
    v_mfma_f32_16x16x32_bf16 v[72:75], a[192:195], a[48:51], 0
    ds_read_b128 a[192:195], v220 offset:12288
    v_cvt_pk_bf16_f32 v32, v32, v33
    v_mfma_f32_16x16x32_bf16 v[72:75], a[196:199], a[52:55], v[72:75]
    s_waitcnt vmcnt(31)
    ds_read_b128 a[196:199], v220 offset:13312
    v_mul_f32 v34, v34, v249
    v_mfma_f32_16x16x32_bf16 v[72:75], a[200:203], a[56:59], v[72:75]
    s_waitcnt lgkmcnt(2)
    ds_read_b128 a[200:203], v220 offset:14336
    v_mul_f32 v35, v35, v249
    v_mfma_f32_16x16x32_bf16 v[64:67], a[204:207], a[12:15], v[64:67]
    s_waitcnt vmcnt(27)
    v_cvt_pk_bf16_f32 v33, v34, v35
    v_mul_f32 v38, v38, v249
    v_mfma_f32_16x16x32_bf16 v[64:67], a[208:211], a[16:19], v[64:67]
    s_waitcnt vmcnt(26)
    v_mul_f32 v39, v39, v249
    v_cvt_pk_bf16_f32 v35, v38, v39
    v_mfma_f32_16x16x32_bf16 v[64:67], a[212:215], a[20:23], v[64:67]
    v_mul_f32 v44, v44, v249
    v_cvt_pk_bf16_f32 v38, 0, v44
    v_mfma_f32_16x16x32_bf16 v[68:71], a[204:207], a[36:39], v[68:71]
    s_waitcnt vmcnt(22)
    v_mov_b32 v44, 0
    v_mov_b32 v45, 0
    v_mfma_f32_16x16x32_bf16 v[68:71], a[208:211], a[40:43], v[68:71]
    s_waitcnt vmcnt(21)
    v_mov_b32 v46, 0
    v_mov_b32 v47, 0
    v_mfma_f32_16x16x32_bf16 v[68:71], a[212:215], a[44:47], v[68:71]
    v_cvt_pk_bf16_f32 v88, v64, v65
    v_cvt_pk_bf16_f32 v89, v66, v67
    v_mfma_f32_16x16x32_bf16 v[72:75], a[204:207], a[60:63], v[72:75]
    s_waitcnt vmcnt(19)
    ds_read_b128 a[204:207], v220 offset:15360
    v_mul_f32 v36, v36, v249
    v_mfma_f32_16x16x32_bf16 v[72:75], a[208:211], a[64:67], v[72:75]
    s_waitcnt vmcnt(18)
    ds_read_b128 a[208:211], v220 offset:16384
    v_mul_f32 v37, v37, v249
    v_mfma_f32_16x16x32_bf16 v[72:75], a[212:215], a[68:71], v[72:75]
    ds_read_b128 a[212:215], v220 offset:17408
    v_cvt_pk_bf16_f32 v92, v68, v69
L_pad15:
    s_cbranch_execz L_vax
    v_smfmac_f32_16x16x64_bf16 v[56:59], v[48:51], v[204:211], v228
    v_cvt_pk_bf16_f32 v93, v70, v71
    v_cvt_pk_bf16_f32 v34, v36, v37
    v_smfmac_f32_16x16x64_bf16 v[60:63], v[48:51], v[212:219], v228
    v_accvgpr_write_b32 a248, v32
    v_accvgpr_write_b32 a249, v33
    v_mfma_f32_16x16x32_bf16 v[8:11], v[0:3], v[204:207], 0
    v_cvt_pk_bf16_f32 v96, v72, v73
    v_cvt_pk_bf16_f32 v97, v74, v75
    v_mfma_f32_16x16x32_bf16 v[8:11], v[4:7], v[208:211], v[8:11]
    v_accvgpr_write_b32 a250, v34
    v_accvgpr_write_b32 a251, v35
    v_mfma_f32_16x16x32_bf16 v[12:15], v[0:3], v[212:215], 0
    v_mul_f32 v40, v40, v249
    v_mul_f32 v41, v41, v249
    v_mfma_f32_16x16x32_bf16 v[12:15], v[4:7], v[216:219], v[12:15]
    v_mul_f32 v42, v42, v249
    v_mul_f32 v43, v43, v249
    v_mfma_f32_16x16x32_bf16 v[24:27], v[16:19], v[204:207], 0
    v_cvt_pk_bf16_f32 v36, v40, v41
    v_cvt_pk_bf16_f32 v37, v42, v43
    v_mfma_f32_16x16x32_bf16 v[24:27], v[20:23], v[208:211], v[24:27]
    v_accvgpr_write_b32 a252, v36
    v_accvgpr_write_b32 a253, v37
    v_mfma_f32_16x16x32_bf16 v[28:31], v[16:19], v[212:215], 0
    v_cvt_pk_bf16_f32 v101, v8, v12
    v_cvt_pk_bf16_f32 v103, v9, v13
    v_mfma_f32_16x16x32_bf16 v[28:31], v[20:23], v[216:219], v[28:31]
    buffer_store_dwordx2 v[100:101], v233, s[8:11], s20 offen offset:256 sc0 sc1
    v_cvt_pk_bf16_f32 v105, v10, v14
    v_mfma_f32_16x16x32_bf16 v[76:79], a[216:219], a[0:3], 0
    v_cvt_pk_bf16_f32 v107, v11, v15
    v_mov_b32 v12, 0
    v_mfma_f32_16x16x32_bf16 v[76:79], a[220:223], a[4:7], v[76:79]
    v_mov_b32 v13, 0
    v_mov_b32 v14, 0
    v_mfma_f32_16x16x32_bf16 v[76:79], a[224:227], a[8:11], v[76:79]
    v_mov_b32 v15, 0
    v_cvt_pk_bf16_f32 v109, v24, v28
    v_mfma_f32_16x16x32_bf16 v[80:83], a[216:219], a[24:27], 0
    v_cvt_pk_bf16_f32 v111, v25, v29
    v_cvt_pk_bf16_f32 v113, v26, v30
    v_mfma_f32_16x16x32_bf16 v[80:83], a[220:223], a[28:31], v[80:83]
    v_cvt_pk_bf16_f32 v115, v27, v31
    v_mov_b32 v28, 0
    v_mfma_f32_16x16x32_bf16 v[80:83], a[224:227], a[32:35], v[80:83]
    v_mov_b32 v29, 0
    v_mov_b32 v30, 0
    v_mfma_f32_16x16x32_bf16 v[84:87], a[216:219], a[48:51], 0
    ds_read_b128 a[216:219], v220 offset:18432
    v_mov_b32 v31, 0
    v_mfma_f32_16x16x32_bf16 v[84:87], a[220:223], a[52:55], v[84:87]
    ds_read_b128 a[220:223], v220 offset:19456
    v_accvgpr_write_b32 a254, v38
    v_mfma_f32_16x16x32_bf16 v[84:87], a[224:227], a[56:59], v[84:87]
    ds_read_b128 a[224:227], v220 offset:20480
    v_add_f32 v56, v56, v57
    v_mfma_f32_16x16x32_bf16 v[76:79], a[228:231], a[12:15], v[76:79]
    v_add_f32 v60, v60, v61
    v_cvt_pk_bf16_f32 v251, v56, v60
    v_mfma_f32_16x16x32_bf16 v[76:79], a[232:235], a[16:19], v[76:79]
    v_cndmask_b32 v51, v244, v231, s[70:71]
    v_mad_i32_i24 v55, s30, -8, v226
    v_mfma_f32_16x16x32_bf16 v[76:79], a[236:239], a[20:23], v[76:79]
    v_mfma_f32_16x16x32_bf16 v[80:83], a[228:231], a[36:39], v[80:83]
    buffer_store_dwordx2 v[102:103], v233, s[8:11], s21 offen offset:256 sc0 sc1
    v_mfma_f32_16x16x32_bf16 v[80:83], a[232:235], a[40:43], v[80:83]
    s_add_u32 s21, s18, 196224
    v_mfma_f32_16x16x32_bf16 v[80:83], a[236:239], a[44:47], v[80:83]
    v_mfma_f32_16x16x32_bf16 v[84:87], a[228:231], a[60:63], v[84:87]
    ds_read_b128 a[228:231], v220 offset:21504
    v_mfma_f32_16x16x32_bf16 v[84:87], a[232:235], a[64:67], v[84:87]
    ds_read_b128 a[232:235], v220 offset:22528
    v_cvt_pk_bf16_f32 v90, v76, v77
    v_mfma_f32_16x16x32_bf16 v[84:87], a[236:239], a[68:71], v[84:87]
    ds_read_b128 a[236:239], v220 offset:23552
    v_cvt_pk_bf16_f32 v91, v78, v79
    v_smfmac_f32_16x16x64_bf16 v[12:15], a[168:171], a[0:7], v228
    v_cvt_pk_bf16_f32 v94, v80, v81
    v_cvt_pk_bf16_f32 v95, v82, v83
    v_smfmac_f32_16x16x64_bf16 v[12:15], a[172:175], a[8:15], v228
    v_smfmac_f32_16x16x64_bf16 v[12:15], a[176:179], a[16:23], v228
    v_smfmac_f32_16x16x64_bf16 v[28:31], a[168:171], a[24:31], v228
    v_cvt_pk_bf16_f32 v98, v84, v85
    v_cvt_pk_bf16_f32 v99, v86, v87
    v_smfmac_f32_16x16x64_bf16 v[28:31], a[172:175], a[32:39], v228
    v_smfmac_f32_16x16x64_bf16 v[28:31], a[176:179], a[40:47], v228
    v_smfmac_f32_16x16x64_bf16 v[44:47], a[168:171], a[48:55], v228
    s_waitcnt lgkmcnt(3)
    v_smfmac_f32_16x16x64_bf16 v[44:47], a[172:175], a[56:63], v228
    buffer_store_dwordx2 v[104:105], v233, s[8:11], s22 offen offset:256 sc0 sc1
    v_add_f32 v48, v14, v15
    v_smfmac_f32_16x16x64_bf16 v[44:47], a[176:179], a[64:71], v228
    s_add_u32 s22, s18, 392448
    v_add_f32 v12, v12, v13
    v_cndmask_b32 v12, v244, v12, s[52:53]
    v_mfma_f32_16x16x32_bf16 v[64:67], a[192:195], a[0:3], 0
    v_add_f32 v49, v30, v31
    v_add_f32 v28, v28, v29
    v_mfma_f32_16x16x32_bf16 v[64:67], a[196:199], a[4:7], v[64:67]
    v_cndmask_b32 v28, v244, v28, s[52:53]
    v_mfma_f32_16x16x32_bf16 v[64:67], a[200:203], a[8:11], v[64:67]
    v_add_f32 v50, v46, v47
    v_max3_f32 v52, v48, v49, v50
    v_mfma_f32_16x16x32_bf16 v[68:71], a[192:195], a[24:27], 0
    v_max_f32 v52, v52, v51
    v_add_f32 v44, v44, v45
    v_mfma_f32_16x16x32_bf16 v[68:71], a[196:199], a[28:31], v[68:71]
    v_max_f32_dpp v52, v52, v52 row_ror:8 row_mask:0xf bank_mask:0xf
    v_cndmask_b32 v44, v244, v44, s[52:53]
    v_mfma_f32_16x16x32_bf16 v[68:71], a[200:203], a[32:35], v[68:71]
    v_max_f32_dpp v52, v52, v52 row_ror:4 row_mask:0xf bank_mask:0xf
    v_mfma_f32_16x16x32_bf16 v[72:75], a[192:195], a[48:51], 0
    ds_read_b128 a[192:195], v220 offset:24576
    v_max_f32_dpp v52, v52, v52 row_ror:2 row_mask:0xf bank_mask:0xf
    v_mfma_f32_16x16x32_bf16 v[72:75], a[196:199], a[52:55], v[72:75]
    ds_read_b128 a[196:199], v220 offset:25600
    v_max_f32_dpp v52, v52, v52 row_ror:1 row_mask:0xf bank_mask:0xf
    v_mfma_f32_16x16x32_bf16 v[72:75], a[200:203], a[56:59], v[72:75]
    ds_read_b128 a[200:203], v220 offset:26624
    v_sub_f32 v48, v48, v52
    v_mfma_f32_16x16x32_bf16 v[64:67], a[204:207], a[12:15], v[64:67]
    v_sub_f32 v49, v49, v52
    v_sub_f32 v50, v50, v52
    v_mfma_f32_16x16x32_bf16 v[64:67], a[208:211], a[16:19], v[64:67]
    v_sub_f32 v51, v51, v52
    v_mfma_f32_16x16x32_bf16 v[64:67], a[212:215], a[20:23], v[64:67]
    buffer_store_dwordx2 v[106:107], v233, s[8:11], s23 offen offset:256 sc0 sc1
    v_mfma_f32_16x16x32_bf16 v[68:71], a[204:207], a[36:39], v[68:71]
    s_add_u32 s23, s18, 588672
    v_exp_f32 v48, v48
    v_mfma_f32_16x16x32_bf16 v[68:71], a[208:211], a[40:43], v[68:71]
    v_exp_f32 v49, v49
    v_mfma_f32_16x16x32_bf16 v[68:71], a[212:215], a[44:47], v[68:71]
    v_exp_f32 v50, v50
    v_mfma_f32_16x16x32_bf16 v[72:75], a[204:207], a[60:63], v[72:75]
    ds_read_b128 a[204:207], v220 offset:27648
    v_add_f32 v53, v48, v49
    v_mfma_f32_16x16x32_bf16 v[72:75], a[208:211], a[64:67], v[72:75]
    ds_read_b128 a[208:211], v220 offset:28672
    v_mfma_f32_16x16x32_bf16 v[72:75], a[212:215], a[68:71], v[72:75]
    ds_read_b128 a[212:215], v220 offset:29696
    v_mfma_f32_16x16x32_bf16 v[0:3], a[0:3], v[88:91], 0
    v_exp_f32 v51, v51
    v_mfma_f32_16x16x32_bf16 v[4:7], a[24:27], v[88:91], 0
    v_add_f32 v54, v50, v51
    v_add_f32 v53, v53, v54
    v_mfma_f32_16x16x32_bf16 v[8:11], a[48:51], v[88:91], 0
    v_cvt_pk_bf16_f32 v88, v64, v65
    v_cvt_pk_bf16_f32 v89, v66, v67
    v_mfma_f32_16x16x32_bf16 v[16:19], a[0:3], v[92:95], 0
    v_add_f32_dpp v53, v53, v53 row_ror:8 row_mask:0xf bank_mask:0xf
    v_mfma_f32_16x16x32_bf16 v[20:23], a[24:27], v[92:95], 0
    v_mfma_f32_16x16x32_bf16 v[24:27], a[48:51], v[92:95], 0
    v_cvt_pk_bf16_f32 v92, v68, v69
    v_cvt_pk_bf16_f32 v93, v70, v71
    v_mfma_f32_16x16x32_bf16 v[32:35], a[0:3], v[96:99], 0
    buffer_store_dwordx2 v[108:109], v233, s[8:11], s24 offen offset:256 sc0 sc1
    v_add_f32_dpp v53, v53, v53 row_ror:4 row_mask:0xf bank_mask:0xf
    v_mfma_f32_16x16x32_bf16 v[36:39], a[24:27], v[96:99], 0
    v_mfma_f32_16x16x32_bf16 v[40:43], a[48:51], v[96:99], 0
    v_cvt_pk_bf16_f32 v96, v72, v73
    v_cvt_pk_bf16_f32 v97, v74, v75
    v_mfma_f32_16x16x32_bf16 v[76:79], a[216:219], a[0:3], 0
    v_add_f32_dpp v53, v53, v53 row_ror:2 row_mask:0xf bank_mask:0xf
    v_mfma_f32_16x16x32_bf16 v[76:79], a[220:223], a[4:7], v[76:79]
    v_mfma_f32_16x16x32_bf16 v[76:79], a[224:227], a[8:11], v[76:79]
    v_add_f32_dpp v53, v53, v53 row_ror:1 row_mask:0xf bank_mask:0xf
    v_mfma_f32_16x16x32_bf16 v[80:83], a[216:219], a[24:27], 0
    v_rcp_f32 v53, v53
    v_mfma_f32_16x16x32_bf16 v[80:83], a[220:223], a[28:31], v[80:83]
    v_mul_f32 v48, v48, v53
    v_mul_f32 v49, v49, v53
    v_mfma_f32_16x16x32_bf16 v[80:83], a[224:227], a[32:35], v[80:83]
    v_mul_f32 v50, v50, v53
    v_mul_f32 v51, v51, v53
    v_mfma_f32_16x16x32_bf16 v[84:87], a[216:219], a[48:51], 0
    ds_read_b128 a[216:219], v220 offset:30720
    v_cvt_pk_bf16_f32 v52, v48, v49
    v_mfma_f32_16x16x32_bf16 v[84:87], a[220:223], a[52:55], v[84:87]
    ds_read_b128 a[220:223], v220 offset:31744
    v_cvt_pk_bf16_f32 v54, v50, v51
    v_mfma_f32_16x16x32_bf16 v[84:87], a[224:227], a[56:59], v[84:87]
    s_waitcnt lgkmcnt(2)
    ds_read_b128 a[224:227], v220 offset:32768
    v_mfma_f32_16x16x32_bf16 v[76:79], a[228:231], a[12:15], v[76:79]
    ds_write_b16 v55, v52 offset:0
    v_mfma_f32_16x16x32_bf16 v[76:79], a[232:235], a[16:19], v[76:79]
    buffer_store_dwordx2 v[110:111], v233, s[8:11], s25 offen offset:256 sc0 sc1
    v_mfma_f32_16x16x32_bf16 v[76:79], a[236:239], a[20:23], v[76:79]
    ds_write_b16_d16_hi v55, v52 offset:4
    v_mfma_f32_16x16x32_bf16 v[80:83], a[228:231], a[36:39], v[80:83]
    ds_write_b16 v55, v54 offset:64
    v_mfma_f32_16x16x32_bf16 v[80:83], a[232:235], a[40:43], v[80:83]
    ds_write_b16_d16_hi v55, v54 offset:68
    v_mfma_f32_16x16x32_bf16 v[80:83], a[236:239], a[44:47], v[80:83]
    ds_read_b128 v[48:51], v227 offset:0
    v_mfma_f32_16x16x32_bf16 v[84:87], a[228:231], a[60:63], v[84:87]
    ds_read_b128 a[228:231], v220 offset:33792
    v_cvt_pk_bf16_f32 v90, v76, v77
    v_mfma_f32_16x16x32_bf16 v[84:87], a[232:235], a[64:67], v[84:87]
    ds_read_b128 a[232:235], v220 offset:34816
    v_cvt_pk_bf16_f32 v91, v78, v79
    v_mfma_f32_16x16x32_bf16 v[84:87], a[236:239], a[68:71], v[84:87]
    ds_read_b128 a[236:239], v220 offset:35840
    v_cvt_pk_bf16_f32 v94, v80, v81
    v_mfma_f32_16x16x32_bf16 v[64:67], a[192:195], a[0:3], 0
    v_cvt_pk_bf16_f32 v95, v82, v83
    v_mfma_f32_16x16x32_bf16 v[64:67], a[196:199], a[4:7], v[64:67]
    v_mfma_f32_16x16x32_bf16 v[64:67], a[200:203], a[8:11], v[64:67]
    v_mfma_f32_16x16x32_bf16 v[68:71], a[192:195], a[24:27], 0
    v_mfma_f32_16x16x32_bf16 v[68:71], a[196:199], a[28:31], v[68:71]
    buffer_store_dwordx2 v[112:113], v233, s[8:11], s26 offen offset:256 sc0 sc1
    v_cvt_pk_bf16_f32 v98, v84, v85
    v_mfma_f32_16x16x32_bf16 v[68:71], a[200:203], a[32:35], v[68:71]
    v_cvt_pk_bf16_f32 v99, v86, v87
    v_mfma_f32_16x16x32_bf16 v[72:75], a[192:195], a[48:51], 0
    ds_read_b128 a[192:195], v220 offset:36864
    v_mfma_f32_16x16x32_bf16 v[72:75], a[196:199], a[52:55], v[72:75]
    ds_read_b128 a[196:199], v220 offset:37888
    v_mfma_f32_16x16x32_bf16 v[72:75], a[200:203], a[56:59], v[72:75]
    ds_read_b128 a[200:203], v220 offset:38912
    v_mfma_f32_16x16x32_bf16 v[64:67], a[204:207], a[12:15], v[64:67]
    v_mfma_f32_16x16x32_bf16 v[64:67], a[208:211], a[16:19], v[64:67]
    v_mfma_f32_16x16x32_bf16 v[64:67], a[212:215], a[20:23], v[64:67]
    v_mfma_f32_16x16x32_bf16 v[68:71], a[204:207], a[36:39], v[68:71]
    v_mfma_f32_16x16x32_bf16 v[68:71], a[208:211], a[40:43], v[68:71]
    v_mfma_f32_16x16x32_bf16 v[68:71], a[212:215], a[44:47], v[68:71]
    v_mfma_f32_16x16x32_bf16 v[72:75], a[204:207], a[60:63], v[72:75]
    ds_read_b128 a[204:207], v220 offset:39936
    v_mfma_f32_16x16x32_bf16 v[72:75], a[208:211], a[64:67], v[72:75]
    ds_read_b128 a[208:211], v220 offset:40960
    v_mfma_f32_16x16x32_bf16 v[72:75], a[212:215], a[68:71], v[72:75]
    ds_read_b128 a[212:215], v220 offset:41984
    v_mfma_f32_16x16x32_bf16 v[0:3], a[4:7], v[88:91], v[0:3]
    buffer_store_dwordx2 v[114:115], v235, s[8:11], s20 offen offset:1792 sc0 sc1
    v_mfma_f32_16x16x32_bf16 v[4:7], a[28:31], v[88:91], v[4:7]
    v_mfma_f32_16x16x32_bf16 v[8:11], a[52:55], v[88:91], v[8:11]
    v_cvt_pk_bf16_f32 v88, v64, v65
    v_cvt_pk_bf16_f32 v89, v66, v67
    v_mfma_f32_16x16x32_bf16 v[16:19], a[4:7], v[92:95], v[16:19]
    v_mfma_f32_16x16x32_bf16 v[20:23], a[28:31], v[92:95], v[20:23]
    v_mfma_f32_16x16x32_bf16 v[24:27], a[52:55], v[92:95], v[24:27]
    v_cvt_pk_bf16_f32 v92, v68, v69
    v_cvt_pk_bf16_f32 v93, v70, v71
    v_mfma_f32_16x16x32_bf16 v[32:35], a[4:7], v[96:99], v[32:35]
    v_mfma_f32_16x16x32_bf16 v[36:39], a[28:31], v[96:99], v[36:39]
    v_mfma_f32_16x16x32_bf16 v[40:43], a[52:55], v[96:99], v[40:43]
    v_cvt_pk_bf16_f32 v96, v72, v73
    v_cvt_pk_bf16_f32 v97, v74, v75
    v_mfma_f32_16x16x32_bf16 v[56:59], a[248:251], v[124:127], 0
    v_mfma_f32_16x16x32_bf16 v[56:59], a[252:255], v[128:131], v[56:59]
    v_mfma_f32_16x16x32_bf16 v[60:63], a[248:251], v[132:135], 0
    v_mfma_f32_16x16x32_bf16 v[60:63], a[252:255], v[136:139], v[60:63]
    s_waitcnt lgkmcnt(1)
    v_mfma_f32_16x16x32_bf16 v[76:79], a[216:219], a[0:3], 0
    buffer_store_dwordx2 v[250:251], v241, s[8:11], s26 offen offset:2560 sc0 sc1
    v_mfma_f32_16x16x32_bf16 v[76:79], a[220:223], a[4:7], v[76:79]
    v_mfma_f32_16x16x32_bf16 v[76:79], a[224:227], a[8:11], v[76:79]
    v_mfma_f32_16x16x32_bf16 v[80:83], a[216:219], a[24:27], 0
    v_mfma_f32_16x16x32_bf16 v[80:83], a[220:223], a[28:31], v[80:83]
    v_mfma_f32_16x16x32_bf16 v[80:83], a[224:227], a[32:35], v[80:83]
    v_mfma_f32_16x16x32_bf16 v[84:87], a[216:219], a[48:51], 0
    ds_read_b128 a[216:219], v220 offset:43008
    v_cvt_pk_bf16_f32 v116, v56, v60
    v_mfma_f32_16x16x32_bf16 v[84:87], a[220:223], a[52:55], v[84:87]
    ds_read_b128 a[220:223], v220 offset:44032
    v_cvt_pk_bf16_f32 v118, v57, v61
    v_mfma_f32_16x16x32_bf16 v[84:87], a[224:227], a[56:59], v[84:87]
    ds_read_b128 a[224:227], v220 offset:45056
    v_cvt_pk_bf16_f32 v120, v58, v62
    v_mfma_f32_16x16x32_bf16 v[76:79], a[228:231], a[12:15], v[76:79]
    v_cvt_pk_bf16_f32 v122, v59, v63
    v_mfma_f32_16x16x32_bf16 v[76:79], a[232:235], a[16:19], v[76:79]
    v_mfma_f32_16x16x32_bf16 v[76:79], a[236:239], a[20:23], v[76:79]
    v_mfma_f32_16x16x32_bf16 v[80:83], a[228:231], a[36:39], v[80:83]
    v_mfma_f32_16x16x32_bf16 v[80:83], a[232:235], a[40:43], v[80:83]
    v_mfma_f32_16x16x32_bf16 v[80:83], a[236:239], a[44:47], v[80:83]
    v_mfma_f32_16x16x32_bf16 v[84:87], a[228:231], a[60:63], v[84:87]
    ds_read_b128 a[228:231], v220 offset:46080
    v_mfma_f32_16x16x32_bf16 v[84:87], a[232:235], a[64:67], v[84:87]
    ds_read_b128 a[232:235], v220 offset:47104
    v_mfma_f32_16x16x32_bf16 v[84:87], a[236:239], a[68:71], v[84:87]
    ds_read_b128 a[236:239], v220 offset:48128
    v_cvt_pk_bf16_f32 v90, v76, v77
    v_mfma_f32_16x16x32_bf16 v[64:67], a[192:195], a[0:3], 0
    v_cvt_pk_bf16_f32 v91, v78, v79
    v_cvt_pk_bf16_f32 v94, v80, v81
    v_mfma_f32_16x16x32_bf16 v[64:67], a[196:199], a[4:7], v[64:67]
    v_cvt_pk_bf16_f32 v95, v82, v83
    v_mfma_f32_16x16x32_bf16 v[64:67], a[200:203], a[8:11], v[64:67]
    v_cvt_pk_bf16_f32 v98, v84, v85
    v_cvt_pk_bf16_f32 v99, v86, v87
    v_mfma_f32_16x16x32_bf16 v[68:71], a[192:195], a[24:27], 0
    v_mfma_f32_16x16x32_bf16 v[68:71], a[196:199], a[28:31], v[68:71]
    v_mfma_f32_16x16x32_bf16 v[68:71], a[200:203], a[32:35], v[68:71]
    v_mfma_f32_16x16x32_bf16 v[72:75], a[192:195], a[48:51], 0
    ds_read_b128 a[192:195], v220 offset:49152
    v_mfma_f32_16x16x32_bf16 v[72:75], a[196:199], a[52:55], v[72:75]
    ds_read_b128 a[196:199], v220 offset:50176
    v_mfma_f32_16x16x32_bf16 v[72:75], a[200:203], a[56:59], v[72:75]
    ds_read_b128 a[200:203], v220 offset:51200
    v_mfma_f32_16x16x32_bf16 v[64:67], a[204:207], a[12:15], v[64:67]
    v_mfma_f32_16x16x32_bf16 v[64:67], a[208:211], a[16:19], v[64:67]
    s_waitcnt lgkmcnt(6)
    v_mfma_f32_16x16x32_bf16 v[64:67], a[212:215], a[20:23], v[64:67]
    v_mfma_f32_16x16x32_bf16 v[68:71], a[204:207], a[36:39], v[68:71]
    v_mfma_f32_16x16x32_bf16 v[68:71], a[208:211], a[40:43], v[68:71]
    v_mfma_f32_16x16x32_bf16 v[68:71], a[212:215], a[44:47], v[68:71]
    v_mfma_f32_16x16x32_bf16 v[72:75], a[204:207], a[60:63], v[72:75]
    ds_read_b128 a[204:207], v220 offset:52224
    v_mfma_f32_16x16x32_bf16 v[72:75], a[208:211], a[64:67], v[72:75]
    ds_read_b128 a[208:211], v220 offset:53248
    v_mfma_f32_16x16x32_bf16 v[72:75], a[212:215], a[68:71], v[72:75]
    ds_read_b128 a[212:215], v220 offset:54272
    v_mfma_f32_16x16x32_bf16 v[56:59], a[248:251], v[140:143], 0
    v_mfma_f32_16x16x32_bf16 v[56:59], a[252:255], v[144:147], v[56:59]
    v_mfma_f32_16x16x32_bf16 v[60:63], a[248:251], v[148:151], 0
    v_mfma_f32_16x16x32_bf16 v[60:63], a[252:255], v[152:155], v[60:63]
    v_mfma_f32_16x16x32_bf16 v[0:3], a[8:11], v[88:91], v[0:3]
    v_mfma_f32_16x16x32_bf16 v[4:7], a[32:35], v[88:91], v[4:7]
    v_mfma_f32_16x16x32_bf16 v[8:11], a[56:59], v[88:91], v[8:11]
    v_cvt_pk_bf16_f32 v88, v64, v65
    v_cvt_pk_bf16_f32 v89, v66, v67
    v_mfma_f32_16x16x32_bf16 v[16:19], a[8:11], v[92:95], v[16:19]
    v_mfma_f32_16x16x32_bf16 v[20:23], a[32:35], v[92:95], v[20:23]
    v_mfma_f32_16x16x32_bf16 v[24:27], a[56:59], v[92:95], v[24:27]
    v_cvt_pk_bf16_f32 v117, v56, v60
    v_cvt_pk_bf16_f32 v119, v57, v61
    v_mfma_f32_16x16x32_bf16 v[32:35], a[8:11], v[96:99], v[32:35]
    buffer_store_dwordx2 v[116:117], v235, s[8:11], s20 offen offset:1920 sc0 sc1
    v_cvt_pk_bf16_f32 v121, v58, v62
    v_mfma_f32_16x16x32_bf16 v[36:39], a[32:35], v[96:99], v[36:39]
    v_cvt_pk_bf16_f32 v123, v59, v63
    v_cvt_pk_bf16_f32 v92, v68, v69
    v_mfma_f32_16x16x32_bf16 v[40:43], a[56:59], v[96:99], v[40:43]
    v_cvt_pk_bf16_f32 v93, v70, v71
    v_cvt_pk_bf16_f32 v96, v72, v73
    v_mfma_f32_16x16x32_bf16 v[76:79], a[216:219], a[0:3], 0
    v_cvt_pk_bf16_f32 v97, v74, v75
    v_mfma_f32_16x16x32_bf16 v[76:79], a[220:223], a[4:7], v[76:79]
    v_mfma_f32_16x16x32_bf16 v[76:79], a[224:227], a[8:11], v[76:79]
    v_mfma_f32_16x16x32_bf16 v[80:83], a[216:219], a[24:27], 0
    v_mfma_f32_16x16x32_bf16 v[80:83], a[220:223], a[28:31], v[80:83]
    v_mfma_f32_16x16x32_bf16 v[80:83], a[224:227], a[32:35], v[80:83]
    v_mfma_f32_16x16x32_bf16 v[84:87], a[216:219], a[48:51], 0
    ds_read_b128 a[216:219], v220 offset:55296
    v_mfma_f32_16x16x32_bf16 v[84:87], a[220:223], a[52:55], v[84:87]
    ds_read_b128 a[220:223], v220 offset:56320
    v_mfma_f32_16x16x32_bf16 v[84:87], a[224:227], a[56:59], v[84:87]
    s_waitcnt lgkmcnt(2)
    ds_read_b128 a[224:227], v220 offset:57344
    v_mfma_f32_16x16x32_bf16 v[76:79], a[228:231], a[12:15], v[76:79]
    v_mfma_f32_16x16x32_bf16 v[76:79], a[232:235], a[16:19], v[76:79]
    buffer_store_dwordx2 v[120:121], v237, s[8:11], s24 offen offset:1536 sc0 sc1
    v_mfma_f32_16x16x32_bf16 v[76:79], a[236:239], a[20:23], v[76:79]
    v_mfma_f32_16x16x32_bf16 v[80:83], a[228:231], a[36:39], v[80:83]
    v_mfma_f32_16x16x32_bf16 v[80:83], a[232:235], a[40:43], v[80:83]
    v_mfma_f32_16x16x32_bf16 v[80:83], a[236:239], a[44:47], v[80:83]
    v_mfma_f32_16x16x32_bf16 v[84:87], a[228:231], a[60:63], v[84:87]
    ds_read_b128 a[228:231], v220 offset:58368
    v_mfma_f32_16x16x32_bf16 v[84:87], a[232:235], a[64:67], v[84:87]
    ds_read_b128 a[232:235], v220 offset:59392
    v_mfma_f32_16x16x32_bf16 v[84:87], a[236:239], a[68:71], v[84:87]
    ds_read_b128 a[236:239], v220 offset:60416
    v_cvt_pk_bf16_f32 v90, v76, v77
    v_mfma_f32_16x16x32_bf16 v[56:59], a[248:251], v[156:159], 0
    v_cvt_pk_bf16_f32 v91, v78, v79
    v_cvt_pk_bf16_f32 v94, v80, v81
    v_mfma_f32_16x16x32_bf16 v[56:59], a[252:255], v[160:163], v[56:59]
    v_cvt_pk_bf16_f32 v95, v82, v83
    v_mfma_f32_16x16x32_bf16 v[60:63], a[248:251], v[164:167], 0
    v_cvt_pk_bf16_f32 v98, v84, v85
    v_cvt_pk_bf16_f32 v99, v86, v87
    v_mfma_f32_16x16x32_bf16 v[60:63], a[252:255], v[168:171], v[60:63]
    v_mfma_f32_16x16x32_bf16 v[64:67], a[192:195], a[0:3], 0
    v_mfma_f32_16x16x32_bf16 v[64:67], a[196:199], a[4:7], v[64:67]
    buffer_store_dwordx2 v[122:123], v239, s[8:11], s24 offen offset:0 sc0 sc1
    v_mfma_f32_16x16x32_bf16 v[64:67], a[200:203], a[8:11], v[64:67]
    v_mfma_f32_16x16x32_bf16 v[68:71], a[192:195], a[24:27], 0
    v_mfma_f32_16x16x32_bf16 v[68:71], a[196:199], a[28:31], v[68:71]
    v_mfma_f32_16x16x32_bf16 v[68:71], a[200:203], a[32:35], v[68:71]
    v_mfma_f32_16x16x32_bf16 v[72:75], a[192:195], a[48:51], 0
    ds_read_b128 a[192:195], v220 offset:61440
    v_cvt_pk_bf16_f32 v100, v56, v60
    v_mfma_f32_16x16x32_bf16 v[72:75], a[196:199], a[52:55], v[72:75]
    ds_read_b128 a[196:199], v220 offset:62464
    v_cvt_pk_bf16_f32 v102, v57, v61
    v_mfma_f32_16x16x32_bf16 v[72:75], a[200:203], a[56:59], v[72:75]
    ds_read_b128 a[200:203], v220 offset:63488
    v_cvt_pk_bf16_f32 v104, v58, v62
    v_mfma_f32_16x16x32_bf16 v[64:67], a[204:207], a[12:15], v[64:67]
    v_cvt_pk_bf16_f32 v106, v59, v63
    v_mfma_f32_16x16x32_bf16 v[64:67], a[208:211], a[16:19], v[64:67]
    v_mfma_f32_16x16x32_bf16 v[64:67], a[212:215], a[20:23], v[64:67]
    v_mfma_f32_16x16x32_bf16 v[68:71], a[204:207], a[36:39], v[68:71]
    v_mfma_f32_16x16x32_bf16 v[68:71], a[208:211], a[40:43], v[68:71]
    v_mfma_f32_16x16x32_bf16 v[68:71], a[212:215], a[44:47], v[68:71]
    buffer_store_dwordx2 v[118:119], v235, s[8:11], s20 offen offset:2304 sc0 sc1
    v_mfma_f32_16x16x32_bf16 v[72:75], a[204:207], a[60:63], v[72:75]
    ds_read_b128 a[204:207], v220 offset:64512
    v_mfma_f32_16x16x32_bf16 v[72:75], a[208:211], a[64:67], v[72:75]
    ds_read_b128 a[208:211], v221 offset:0
    v_mfma_f32_16x16x32_bf16 v[72:75], a[212:215], a[68:71], v[72:75]
    ds_read_b128 a[212:215], v221 offset:1024
    v_mfma_f32_16x16x32_bf16 v[0:3], a[12:15], v[88:91], v[0:3]
    v_mfma_f32_16x16x32_bf16 v[4:7], a[36:39], v[88:91], v[4:7]
    v_mfma_f32_16x16x32_bf16 v[8:11], a[60:63], v[88:91], v[8:11]
    v_cvt_pk_bf16_f32 v88, v64, v65
    v_cvt_pk_bf16_f32 v89, v66, v67
    v_mfma_f32_16x16x32_bf16 v[16:19], a[12:15], v[92:95], v[16:19]
    v_mfma_f32_16x16x32_bf16 v[20:23], a[36:39], v[92:95], v[20:23]
    v_mfma_f32_16x16x32_bf16 v[24:27], a[60:63], v[92:95], v[24:27]
    v_cvt_pk_bf16_f32 v92, v68, v69
    v_cvt_pk_bf16_f32 v93, v70, v71
    v_mfma_f32_16x16x32_bf16 v[32:35], a[12:15], v[96:99], v[32:35]
    v_mfma_f32_16x16x32_bf16 v[36:39], a[36:39], v[96:99], v[36:39]
    v_mfma_f32_16x16x32_bf16 v[40:43], a[60:63], v[96:99], v[40:43]
    v_cvt_pk_bf16_f32 v96, v72, v73
    v_cvt_pk_bf16_f32 v97, v74, v75
    v_mfma_f32_16x16x32_bf16 v[56:59], a[248:251], v[172:175], 0
    v_mfma_f32_16x16x32_bf16 v[56:59], a[252:255], v[176:179], v[56:59]
    v_mfma_f32_16x16x32_bf16 v[60:63], a[248:251], v[180:183], 0
    v_mfma_f32_16x16x32_bf16 v[60:63], a[252:255], v[184:187], v[60:63]
    s_waitcnt lgkmcnt(1)
    v_mfma_f32_16x16x32_bf16 v[76:79], a[216:219], a[0:3], 0
    v_mfma_f32_16x16x32_bf16 v[76:79], a[220:223], a[4:7], v[76:79]
    v_mfma_f32_16x16x32_bf16 v[76:79], a[224:227], a[8:11], v[76:79]
    v_mfma_f32_16x16x32_bf16 v[80:83], a[216:219], a[24:27], 0
    v_mfma_f32_16x16x32_bf16 v[80:83], a[220:223], a[28:31], v[80:83]
    v_mfma_f32_16x16x32_bf16 v[80:83], a[224:227], a[32:35], v[80:83]
    v_mfma_f32_16x16x32_bf16 v[84:87], a[216:219], a[48:51], 0
    ds_read_b128 a[216:219], v221 offset:2048
    v_cvt_pk_bf16_f32 v101, v56, v60
    v_mfma_f32_16x16x32_bf16 v[84:87], a[220:223], a[52:55], v[84:87]
    ds_read_b128 a[220:223], v221 offset:3072
    v_cvt_pk_bf16_f32 v103, v57, v61
    v_mfma_f32_16x16x32_bf16 v[84:87], a[224:227], a[56:59], v[84:87]
    ds_read_b128 a[224:227], v221 offset:4096
    v_cvt_pk_bf16_f32 v105, v58, v62
    v_mfma_f32_16x16x32_bf16 v[76:79], a[228:231], a[12:15], v[76:79]
    buffer_store_dwordx2 v[100:101], v235, s[8:11], s20 offen offset:2048 sc0 sc1
    v_cvt_pk_bf16_f32 v107, v59, v63
    v_mfma_f32_16x16x32_bf16 v[76:79], a[232:235], a[16:19], v[76:79]
    v_mfma_f32_16x16x32_bf16 v[76:79], a[236:239], a[20:23], v[76:79]
    v_mfma_f32_16x16x32_bf16 v[80:83], a[228:231], a[36:39], v[80:83]
    v_mfma_f32_16x16x32_bf16 v[80:83], a[232:235], a[40:43], v[80:83]
    v_mfma_f32_16x16x32_bf16 v[80:83], a[236:239], a[44:47], v[80:83]
    v_mfma_f32_16x16x32_bf16 v[84:87], a[228:231], a[60:63], v[84:87]
    ds_read_b128 a[228:231], v221 offset:5120
    v_mfma_f32_16x16x32_bf16 v[84:87], a[232:235], a[64:67], v[84:87]
    ds_read_b128 a[232:235], v221 offset:6144
    v_mfma_f32_16x16x32_bf16 v[84:87], a[236:239], a[68:71], v[84:87]
    ds_read_b128 a[236:239], v221 offset:7168
    v_cvt_pk_bf16_f32 v90, v76, v77
    v_mfma_f32_16x16x32_bf16 v[64:67], a[192:195], a[0:3], 0
    v_cvt_pk_bf16_f32 v91, v78, v79
    v_cvt_pk_bf16_f32 v94, v80, v81
    v_mfma_f32_16x16x32_bf16 v[64:67], a[196:199], a[4:7], v[64:67]
    v_cvt_pk_bf16_f32 v95, v82, v83
    v_mfma_f32_16x16x32_bf16 v[64:67], a[200:203], a[8:11], v[64:67]
    v_cvt_pk_bf16_f32 v98, v84, v85
    v_cvt_pk_bf16_f32 v99, v86, v87
    v_mfma_f32_16x16x32_bf16 v[68:71], a[192:195], a[24:27], 0
    v_mfma_f32_16x16x32_bf16 v[68:71], a[196:199], a[28:31], v[68:71]
    buffer_store_dwordx2 v[102:103], v235, s[8:11], s20 offen offset:2432 sc0 sc1
    v_mfma_f32_16x16x32_bf16 v[68:71], a[200:203], a[32:35], v[68:71]
    v_mfma_f32_16x16x32_bf16 v[72:75], a[192:195], a[48:51], 0
    ds_read_b128 a[192:195], v221 offset:8192
    v_mfma_f32_16x16x32_bf16 v[72:75], a[196:199], a[52:55], v[72:75]
    ds_read_b128 a[196:199], v221 offset:9216
    v_mfma_f32_16x16x32_bf16 v[72:75], a[200:203], a[56:59], v[72:75]
    ds_read_b128 a[200:203], v221 offset:10240
    v_mfma_f32_16x16x32_bf16 v[64:67], a[204:207], a[12:15], v[64:67]
    v_mfma_f32_16x16x32_bf16 v[64:67], a[208:211], a[16:19], v[64:67]
    s_waitcnt lgkmcnt(6)
    v_mfma_f32_16x16x32_bf16 v[64:67], a[212:215], a[20:23], v[64:67]
    v_mfma_f32_16x16x32_bf16 v[68:71], a[204:207], a[36:39], v[68:71]
    v_mfma_f32_16x16x32_bf16 v[68:71], a[208:211], a[40:43], v[68:71]
    v_mfma_f32_16x16x32_bf16 v[68:71], a[212:215], a[44:47], v[68:71]
    v_mfma_f32_16x16x32_bf16 v[72:75], a[204:207], a[60:63], v[72:75]
    ds_read_b128 a[204:207], v221 offset:11264
    v_mfma_f32_16x16x32_bf16 v[72:75], a[208:211], a[64:67], v[72:75]
    ds_read_b128 a[208:211], v221 offset:12288
    v_mfma_f32_16x16x32_bf16 v[72:75], a[212:215], a[68:71], v[72:75]
    ds_read_b128 a[212:215], v221 offset:13312
    v_mfma_f32_16x16x32_bf16 v[56:59], a[248:251], v[188:191], 0
    buffer_store_dwordx2 v[104:105], v237, s[8:11], s24 offen offset:1664 sc0 sc1
    v_mfma_f32_16x16x32_bf16 v[56:59], a[252:255], v[192:195], v[56:59]
    v_mfma_f32_16x16x32_bf16 v[60:63], a[248:251], v[196:199], 0
    v_mfma_f32_16x16x32_bf16 v[60:63], a[252:255], v[200:203], v[60:63]
    v_mfma_f32_16x16x32_bf16 v[0:3], a[16:19], v[88:91], v[0:3]
    v_mfma_f32_16x16x32_bf16 v[4:7], a[40:43], v[88:91], v[4:7]
    v_mfma_f32_16x16x32_bf16 v[8:11], a[64:67], v[88:91], v[8:11]
    v_cvt_pk_bf16_f32 v88, v64, v65
    v_cvt_pk_bf16_f32 v89, v66, v67
    v_mfma_f32_16x16x32_bf16 v[16:19], a[16:19], v[92:95], v[16:19]
    v_mfma_f32_16x16x32_bf16 v[20:23], a[40:43], v[92:95], v[20:23]
    v_mfma_f32_16x16x32_bf16 v[24:27], a[64:67], v[92:95], v[24:27]
    v_cvt_pk_bf16_f32 v108, v56, v60
    v_cvt_pk_bf16_f32 v110, v57, v61
    v_mfma_f32_16x16x32_bf16 v[32:35], a[16:19], v[96:99], v[32:35]
    v_cvt_pk_bf16_f32 v112, v58, v62
    v_cvt_pk_bf16_f32 v114, v59, v63
    v_mfma_f32_16x16x32_bf16 v[36:39], a[40:43], v[96:99], v[36:39]
    v_cvt_pk_bf16_f32 v92, v68, v69
    v_cvt_pk_bf16_f32 v93, v70, v71
    v_mfma_f32_16x16x32_bf16 v[40:43], a[64:67], v[96:99], v[40:43]
    v_cvt_pk_bf16_f32 v96, v72, v73
    v_cvt_pk_bf16_f32 v97, v74, v75
    v_mfma_f32_16x16x32_bf16 v[76:79], a[216:219], a[0:3], 0
    buffer_store_dwordx2 v[106:107], v239, s[8:11], s24 offen offset:128 sc0 sc1
    v_mfma_f32_16x16x32_bf16 v[76:79], a[220:223], a[4:7], v[76:79]
    v_mfma_f32_16x16x32_bf16 v[76:79], a[224:227], a[8:11], v[76:79]
    v_mfma_f32_16x16x32_bf16 v[80:83], a[216:219], a[24:27], 0
    v_mfma_f32_16x16x32_bf16 v[80:83], a[220:223], a[28:31], v[80:83]
    v_mfma_f32_16x16x32_bf16 v[80:83], a[224:227], a[32:35], v[80:83]
    v_mfma_f32_16x16x32_bf16 v[84:87], a[216:219], a[48:51], 0
    ds_read_b128 a[216:219], v221 offset:14336
    v_mfma_f32_16x16x32_bf16 v[84:87], a[220:223], a[52:55], v[84:87]
    ds_read_b128 a[220:223], v221 offset:15360
    v_mfma_f32_16x16x32_bf16 v[84:87], a[224:227], a[56:59], v[84:87]
    s_waitcnt lgkmcnt(2)
    ds_read_b128 a[224:227], v221 offset:16384
    v_mfma_f32_16x16x32_bf16 v[76:79], a[228:231], a[12:15], v[76:79]
    v_mfma_f32_16x16x32_bf16 v[76:79], a[232:235], a[16:19], v[76:79]
    v_mfma_f32_16x16x32_bf16 v[76:79], a[236:239], a[20:23], v[76:79]
    v_mfma_f32_16x16x32_bf16 v[80:83], a[228:231], a[36:39], v[80:83]
    v_mfma_f32_16x16x32_bf16 v[80:83], a[232:235], a[40:43], v[80:83]
    v_mfma_f32_16x16x32_bf16 v[80:83], a[236:239], a[44:47], v[80:83]
    v_mfma_f32_16x16x32_bf16 v[84:87], a[228:231], a[60:63], v[84:87]
    ds_read_b128 a[228:231], v221 offset:17408
    v_mfma_f32_16x16x32_bf16 v[84:87], a[232:235], a[64:67], v[84:87]
    ds_read_b128 a[232:235], v221 offset:18432
L_pad16:
    s_cbranch_execz L_vax
    v_mfma_f32_16x16x32_bf16 v[84:87], a[236:239], a[68:71], v[84:87]
    ds_read_b128 a[236:239], v221 offset:19456
    v_cvt_pk_bf16_f32 v90, v76, v77
    v_mfma_f32_16x16x32_bf16 v[56:59], a[248:251], v[204:207], 0
    v_cvt_pk_bf16_f32 v91, v78, v79
    v_cvt_pk_bf16_f32 v94, v80, v81
    v_mfma_f32_16x16x32_bf16 v[56:59], a[252:255], v[208:211], v[56:59]
    v_cvt_pk_bf16_f32 v95, v82, v83
    v_mfma_f32_16x16x32_bf16 v[60:63], a[248:251], v[212:215], 0
    v_cvt_pk_bf16_f32 v98, v84, v85
    v_cvt_pk_bf16_f32 v99, v86, v87
    v_mfma_f32_16x16x32_bf16 v[60:63], a[252:255], v[216:219], v[60:63]
    v_mfma_f32_16x16x32_bf16 v[64:67], a[0:3], a[192:195], 0
    v_mfma_f32_16x16x32_bf16 v[64:67], a[4:7], a[196:199], v[64:67]
    v_mfma_f32_16x16x32_bf16 v[64:67], a[8:11], a[200:203], v[64:67]
    v_mfma_f32_16x16x32_bf16 v[68:71], a[24:27], a[192:195], 0
    v_mfma_f32_16x16x32_bf16 v[68:71], a[28:31], a[196:199], v[68:71]
    v_mfma_f32_16x16x32_bf16 v[68:71], a[32:35], a[200:203], v[68:71]
    v_mfma_f32_16x16x32_bf16 v[72:75], a[48:51], a[192:195], 0
    ds_read_b128 a[192:195], v221 offset:20480
    v_cvt_pk_bf16_f32 v109, v56, v60
    v_mfma_f32_16x16x32_bf16 v[72:75], a[52:55], a[196:199], v[72:75]
    ds_read_b128 a[196:199], v221 offset:21504
    v_cvt_pk_bf16_f32 v111, v57, v61
    v_mfma_f32_16x16x32_bf16 v[72:75], a[56:59], a[200:203], v[72:75]
    ds_read_b128 a[200:203], v221 offset:22528
    v_mov_b32 v56, 0
    v_mfma_f32_16x16x32_bf16 v[64:67], a[12:15], a[204:207], v[64:67]
    buffer_store_dwordx2 v[108:109], v235, s[8:11], s20 offen offset:2176 sc0 sc1
    v_mov_b32 v57, 0
    v_mfma_f32_16x16x32_bf16 v[64:67], a[16:19], a[208:211], v[64:67]
    v_cvt_pk_bf16_f32 v113, v58, v62
    v_cvt_pk_bf16_f32 v115, v59, v63
    v_mfma_f32_16x16x32_bf16 v[64:67], a[20:23], a[212:215], v[64:67]
    v_mov_b32 v60, 0
    v_mov_b32 v61, 0
    v_mfma_f32_16x16x32_bf16 v[68:71], a[36:39], a[204:207], v[68:71]
    v_mfma_f32_16x16x32_bf16 v[68:71], a[40:43], a[208:211], v[68:71]
    v_mfma_f32_16x16x32_bf16 v[68:71], a[44:47], a[212:215], v[68:71]
    v_mfma_f32_16x16x32_bf16 v[72:75], a[60:63], a[204:207], v[72:75]
    ds_read_b128 a[204:207], v221 offset:23552
    v_mfma_f32_16x16x32_bf16 v[72:75], a[64:67], a[208:211], v[72:75]
    ds_read_b128 a[208:211], v221 offset:24576
    v_cvt_pk_bf16_f32 v124, v64, v65
    v_mfma_f32_16x16x32_bf16 v[72:75], a[68:71], a[212:215], v[72:75]
    ds_read_b128 a[212:215], v221 offset:25600
    v_cvt_pk_bf16_f32 v125, v66, v67
    v_mfma_f32_16x16x32_bf16 v[0:3], a[20:23], v[88:91], v[0:3]
    v_cvt_pk_bf16_f32 v126, v68, v69
    v_cvt_pk_bf16_f32 v127, v70, v71
    v_mfma_f32_16x16x32_bf16 v[4:7], a[44:47], v[88:91], v[4:7]
    v_mfma_f32_16x16x32_bf16 v[8:11], a[68:71], v[88:91], v[8:11]
    v_mfma_f32_16x16x32_bf16 v[16:19], a[20:23], v[92:95], v[16:19]
    v_cvt_pk_bf16_f32 v128, v72, v73
    v_cvt_pk_bf16_f32 v129, v74, v75
    v_mfma_f32_16x16x32_bf16 v[20:23], a[44:47], v[92:95], v[20:23]
    buffer_store_dwordx2 v[112:113], v237, s[8:11], s24 offen offset:1792 sc0 sc1
    v_max3_f32 v245, v0, v1, v2
    v_mfma_f32_16x16x32_bf16 v[24:27], a[68:71], v[92:95], v[24:27]
    v_max3_f32 v246, v3, v4, v5
    v_max3_f32 v245, v245, v6, v7
    v_mfma_f32_16x16x32_bf16 v[32:35], a[20:23], v[96:99], v[32:35]
    v_max3_f32 v246, v246, v8, v9
    v_max3_f32 v245, v245, v10, v11
    v_mfma_f32_16x16x32_bf16 v[36:39], a[44:47], v[96:99], v[36:39]
    v_max3_f32 v245, v245, v246, v12
    v_mov_b32 v246, v245
    v_mfma_f32_16x16x32_bf16 v[40:43], a[68:71], v[96:99], v[40:43]
    s_waitcnt lgkmcnt(3)
    v_max3_f32 v250, v16, v17, v18
    v_max3_f32 v251, v19, v20, v21
    v_mfma_f32_16x16x32_bf16 v[76:79], a[0:3], a[216:219], 0
    v_permlane32_swap_b32 v245, v246
    v_mfma_f32_16x16x32_bf16 v[76:79], a[4:7], a[220:223], v[76:79]
    v_max_f32 v245, v245, v246
    v_mov_b32 v246, v245
    v_mfma_f32_16x16x32_bf16 v[76:79], a[8:11], a[224:227], v[76:79]
    v_max3_f32 v250, v250, v22, v23
    v_max3_f32 v251, v251, v24, v25
    v_mfma_f32_16x16x32_bf16 v[80:83], a[24:27], a[216:219], 0
    v_permlane16_swap_b32 v245, v246
    v_mfma_f32_16x16x32_bf16 v[80:83], a[28:31], a[220:223], v[80:83]
    v_max_f32 v245, v245, v246
    v_sub_f32 v0, v0, v245
    v_mfma_f32_16x16x32_bf16 v[80:83], a[32:35], a[224:227], v[80:83]
    v_sub_f32 v1, v1, v245
    v_sub_f32 v2, v2, v245
    v_mfma_f32_16x16x32_bf16 v[84:87], a[48:51], a[216:219], 0
    ds_read_b128 a[216:219], v221 offset:26624
    v_sub_f32 v3, v3, v245
    v_mfma_f32_16x16x32_bf16 v[84:87], a[52:55], a[220:223], v[84:87]
    ds_read_b128 a[220:223], v221 offset:27648
    v_sub_f32 v4, v4, v245
    v_mfma_f32_16x16x32_bf16 v[84:87], a[56:59], a[224:227], v[84:87]
    ds_read_b128 a[224:227], v221 offset:28672
    v_sub_f32 v5, v5, v245
    v_mfma_f32_16x16x32_bf16 v[76:79], a[12:15], a[228:231], v[76:79]
    buffer_store_dwordx2 v[114:115], v239, s[8:11], s24 offen offset:256 sc0 sc1
    v_sub_f32 v6, v6, v245
    v_mfma_f32_16x16x32_bf16 v[76:79], a[16:19], a[232:235], v[76:79]
    s_add_u32 s24, s18, 784896
    v_exp_f32 v0, v0
    v_mfma_f32_16x16x32_bf16 v[76:79], a[20:23], a[236:239], v[76:79]
    s_add_u32 s25, s18, 981120
    v_exp_f32 v1, v1
    v_mfma_f32_16x16x32_bf16 v[80:83], a[36:39], a[228:231], v[80:83]
    s_add_u32 s26, s18, 1177344
    v_exp_f32 v2, v2
    v_mfma_f32_16x16x32_bf16 v[80:83], a[40:43], a[232:235], v[80:83]
    v_exp_f32 v3, v3
    v_mfma_f32_16x16x32_bf16 v[80:83], a[44:47], a[236:239], v[80:83]
    v_cvt_pk_bf16_f32 v132, v76, v77
    v_cvt_pk_bf16_f32 v133, v78, v79
    v_mfma_f32_16x16x32_bf16 v[84:87], a[60:63], a[228:231], v[84:87]
    ds_read_b128 a[228:231], v221 offset:29696
    v_sub_f32 v7, v7, v245
    v_mfma_f32_16x16x32_bf16 v[84:87], a[64:67], a[232:235], v[84:87]
    ds_read_b128 a[232:235], v221 offset:30720
    v_sub_f32 v8, v8, v245
    v_mfma_f32_16x16x32_bf16 v[84:87], a[68:71], a[236:239], v[84:87]
    ds_read_b128 a[236:239], v221 offset:31744
    v_cvt_pk_bf16_f32 v134, v80, v81
    v_mfma_f32_16x16x32_bf16 v[64:67], a[0:3], a[192:195], 0
    v_cvt_pk_bf16_f32 v135, v82, v83
    v_add_f32 v247, v0, v1
    v_mfma_f32_16x16x32_bf16 v[64:67], a[4:7], a[196:199], v[64:67]
    v_exp_f32 v4, v4
    v_mfma_f32_16x16x32_bf16 v[64:67], a[8:11], a[200:203], v[64:67]
    v_cvt_pk_bf16_f32 v136, v84, v85
    v_cvt_pk_bf16_f32 v137, v86, v87
    v_mfma_f32_16x16x32_bf16 v[68:71], a[24:27], a[192:195], 0
    v_exp_f32 v5, v5
    v_mfma_f32_16x16x32_bf16 v[68:71], a[28:31], a[196:199], v[68:71]
    buffer_store_dwordx2 v[110:111], v235, s[8:11], s20 offen offset:2560 sc0 sc1
    v_sub_f32 v9, v9, v245
    v_mfma_f32_16x16x32_bf16 v[68:71], a[32:35], a[200:203], v[68:71]
    s_mov_b32 s10, s31
    v_exp_f32 v6, v6
    v_mfma_f32_16x16x32_bf16 v[72:75], a[48:51], a[192:195], 0
    s_mov_b32 s20, s18
    ds_read_b128 a[192:195], v221 offset:32768
    v_sub_f32 v10, v10, v245
    v_mfma_f32_16x16x32_bf16 v[72:75], a[52:55], a[196:199], v[72:75]
    s_mov_b32 s18, s17
    ds_read_b128 a[196:199], v221 offset:33792
    v_add_f32 v248, v2, v3
    v_mfma_f32_16x16x32_bf16 v[72:75], a[56:59], a[200:203], v[72:75]
    s_waitcnt lgkmcnt(5)
    ds_read_b128 a[200:203], v221 offset:34816
    v_add_f32 v247, v247, v4
    v_mfma_f32_16x16x32_bf16 v[64:67], a[12:15], a[204:207], v[64:67]
    v_exp_f32 v7, v7
    v_mfma_f32_16x16x32_bf16 v[64:67], a[16:19], a[208:211], v[64:67]
    v_exp_f32 v8, v8
    v_mfma_f32_16x16x32_bf16 v[64:67], a[20:23], a[212:215], v[64:67]
    v_exp_f32 v9, v9
    v_mfma_f32_16x16x32_bf16 v[68:71], a[36:39], a[204:207], v[68:71]
    v_exp_f32 v10, v10
    v_mfma_f32_16x16x32_bf16 v[68:71], a[40:43], a[208:211], v[68:71]
    v_sub_f32 v11, v11, v245
    v_sub_f32 v12, v12, v245
    v_mfma_f32_16x16x32_bf16 v[68:71], a[44:47], a[212:215], v[68:71]
    v_add_f32 v248, v248, v5
    v_cvt_pk_bf16_f32 v140, v64, v65
    v_mfma_f32_16x16x32_bf16 v[72:75], a[60:63], a[204:207], v[72:75]
    ds_read_b128 a[204:207], v221 offset:35840
    v_cvt_pk_bf16_f32 v141, v66, v67
    v_mfma_f32_16x16x32_bf16 v[72:75], a[64:67], a[208:211], v[72:75]
    ds_read_b128 a[208:211], v221 offset:36864
    v_add_f32 v247, v247, v6
    v_mfma_f32_16x16x32_bf16 v[72:75], a[68:71], a[212:215], v[72:75]
    ds_read_b128 a[212:215], v221 offset:37888
    v_cvt_pk_bf16_f32 v142, v68, v69
    v_mfma_f32_16x16x32_bf16 v[76:79], a[0:3], a[216:219], 0
    v_cvt_pk_bf16_f32 v143, v70, v71
    v_add_f32 v248, v248, v7
    v_mfma_f32_16x16x32_bf16 v[76:79], a[4:7], a[220:223], v[76:79]
    v_exp_f32 v11, v11
    v_mfma_f32_16x16x32_bf16 v[76:79], a[8:11], a[224:227], v[76:79]
    v_cvt_pk_bf16_f32 v144, v72, v73
    v_cvt_pk_bf16_f32 v145, v74, v75
    v_mfma_f32_16x16x32_bf16 v[80:83], a[24:27], a[216:219], 0
    v_exp_f32 v12, v12
    v_mfma_f32_16x16x32_bf16 v[80:83], a[28:31], a[220:223], v[80:83]
    v_add_f32 v247, v247, v8
    v_add_f32 v248, v248, v9
    v_mfma_f32_16x16x32_bf16 v[80:83], a[32:35], a[224:227], v[80:83]
    v_add_f32 v247, v247, v10
    v_add_f32 v248, v248, v11
    v_mfma_f32_16x16x32_bf16 v[84:87], a[48:51], a[216:219], 0
    ds_read_b128 a[216:219], v221 offset:38912
    v_add_f32 v247, v247, v12
    v_mfma_f32_16x16x32_bf16 v[84:87], a[52:55], a[220:223], v[84:87]
    ds_read_b128 a[220:223], v221 offset:39936
    v_add_f32 v247, v247, v248
    v_mfma_f32_16x16x32_bf16 v[84:87], a[56:59], a[224:227], v[84:87]
    s_waitcnt lgkmcnt(5)
    ds_read_b128 a[224:227], v221 offset:40960
    v_mov_b32 v248, v247
    v_mfma_f32_16x16x32_bf16 v[76:79], a[12:15], a[228:231], v[76:79]
    v_max3_f32 v250, v250, v26, v27
    v_max3_f32 v250, v250, v251, v28
    v_mfma_f32_16x16x32_bf16 v[76:79], a[16:19], a[232:235], v[76:79]
    v_permlane32_swap_b32 v247, v248
    v_mfma_f32_16x16x32_bf16 v[76:79], a[20:23], a[236:239], v[76:79]
    v_add_f32 v247, v247, v248
    v_mov_b32 v248, v247
    v_mfma_f32_16x16x32_bf16 v[80:83], a[36:39], a[228:231], v[80:83]
    v_mov_b32 v251, v250
    v_max3_f32 v245, v32, v33, v34
    v_mfma_f32_16x16x32_bf16 v[80:83], a[40:43], a[232:235], v[80:83]
    v_permlane16_swap_b32 v247, v248
    v_mfma_f32_16x16x32_bf16 v[80:83], a[44:47], a[236:239], v[80:83]
    v_add_f32 v247, v247, v248
    v_cvt_pk_bf16_f32 v148, v76, v77
    v_mfma_f32_16x16x32_bf16 v[84:87], a[60:63], a[228:231], v[84:87]
    ds_read_b128 a[228:231], v221 offset:41984
    v_cvt_pk_bf16_f32 v149, v78, v79
    v_mfma_f32_16x16x32_bf16 v[84:87], a[64:67], a[232:235], v[84:87]
    ds_read_b128 a[232:235], v221 offset:43008
    v_max3_f32 v246, v35, v36, v37
    v_mfma_f32_16x16x32_bf16 v[84:87], a[68:71], a[236:239], v[84:87]
    ds_read_b128 a[236:239], v221 offset:44032
    v_cvt_pk_bf16_f32 v150, v80, v81
    v_smfmac_f32_16x16x64_bf16 v[56:59], v[48:51], v[124:131], v228
    v_rcp_f32 v249, v247
    v_smfmac_f32_16x16x64_bf16 v[60:63], v[48:51], v[132:139], v228
    v_mul_f32 v0, v0, v249
    v_mul_f32 v1, v1, v249
    v_mfma_f32_16x16x32_bf16 v[64:67], a[0:3], a[192:195], 0
    v_cvt_pk_bf16_f32 v0, v0, v1
    v_mul_f32 v2, v2, v249
    v_mfma_f32_16x16x32_bf16 v[64:67], a[4:7], a[196:199], v[64:67]
    v_mul_f32 v3, v3, v249
    v_cvt_pk_bf16_f32 v1, v2, v3
    v_mfma_f32_16x16x32_bf16 v[64:67], a[8:11], a[200:203], v[64:67]
    v_mul_f32 v4, v4, v249
    v_mul_f32 v5, v5, v249
    v_mfma_f32_16x16x32_bf16 v[68:71], a[24:27], a[192:195], 0
    v_mul_f32 v6, v6, v249
    v_mul_f32 v7, v7, v249
    v_mfma_f32_16x16x32_bf16 v[68:71], a[28:31], a[196:199], v[68:71]
    v_cvt_pk_bf16_f32 v2, v4, v5
    v_cvt_pk_bf16_f32 v3, v6, v7
    v_mfma_f32_16x16x32_bf16 v[68:71], a[32:35], a[200:203], v[68:71]
    v_mul_f32 v8, v8, v249
    v_mul_f32 v9, v9, v249
    v_mfma_f32_16x16x32_bf16 v[72:75], a[48:51], a[192:195], 0
    ds_read_b128 a[192:195], v221 offset:45056
    v_mul_f32 v10, v10, v249
    v_mfma_f32_16x16x32_bf16 v[72:75], a[52:55], a[196:199], v[72:75]
    ds_read_b128 a[196:199], v221 offset:46080
    v_mul_f32 v11, v11, v249
    v_mfma_f32_16x16x32_bf16 v[72:75], a[56:59], a[200:203], v[72:75]
    s_waitcnt lgkmcnt(5)
    ds_read_b128 a[200:203], v221 offset:47104
    v_cvt_pk_bf16_f32 v4, v8, v9
    v_mfma_f32_16x16x32_bf16 v[64:67], a[12:15], a[204:207], v[64:67]
    v_cvt_pk_bf16_f32 v5, v10, v11
    v_mul_f32 v12, v12, v249
    v_mfma_f32_16x16x32_bf16 v[64:67], a[16:19], a[208:211], v[64:67]
    v_cvt_pk_bf16_f32 v6, v12, 0
    v_mov_b32 v7, 0
    v_mfma_f32_16x16x32_bf16 v[64:67], a[20:23], a[212:215], v[64:67]
    v_add_f32 v56, v56, v57
    v_add_f32 v60, v60, v61
    v_mfma_f32_16x16x32_bf16 v[68:71], a[36:39], a[204:207], v[68:71]
    v_cvt_pk_bf16_f32 v88, v56, v60
    v_mov_b32 v56, 0
    v_mfma_f32_16x16x32_bf16 v[68:71], a[40:43], a[208:211], v[68:71]
    v_mov_b32 v57, 0
    v_cvt_pk_bf16_f32 v151, v82, v83
    v_mfma_f32_16x16x32_bf16 v[68:71], a[44:47], a[212:215], v[68:71]
    v_cvt_pk_bf16_f32 v152, v84, v85
    v_cvt_pk_bf16_f32 v153, v86, v87
    v_mfma_f32_16x16x32_bf16 v[72:75], a[60:63], a[204:207], v[72:75]
    ds_read_b128 a[204:207], v221 offset:48128
    v_mov_b32 v60, 0
    v_mfma_f32_16x16x32_bf16 v[72:75], a[64:67], a[208:211], v[72:75]
    ds_read_b128 a[208:211], v221 offset:49152
    v_mov_b32 v61, 0
    v_mfma_f32_16x16x32_bf16 v[72:75], a[68:71], a[212:215], v[72:75]
    ds_read_b128 a[212:215], v221 offset:50176
    v_cvt_pk_bf16_f32 v156, v64, v65
    v_mfma_f32_16x16x32_bf16 v[8:11], v[0:3], v[124:127], 0
    v_permlane32_swap_b32 v250, v251
    v_mfma_f32_16x16x32_bf16 v[8:11], v[4:7], v[128:131], v[8:11]
    v_max_f32 v250, v250, v251
    v_mov_b32 v251, v250
    v_mfma_f32_16x16x32_bf16 v[12:15], v[0:3], v[132:135], 0
    v_cvt_pk_bf16_f32 v157, v66, v67
    v_cvt_pk_bf16_f32 v158, v68, v69
    v_mfma_f32_16x16x32_bf16 v[12:15], v[4:7], v[136:139], v[12:15]
    v_permlane16_swap_b32 v250, v251
    v_smfmac_f32_16x16x64_bf16 v[56:59], v[48:51], v[140:147], v228
    v_max_f32 v250, v250, v251
    v_sub_f32 v16, v16, v250
    v_smfmac_f32_16x16x64_bf16 v[60:63], v[48:51], v[148:155], v228
    v_sub_f32 v17, v17, v250
    v_exp_f32 v16, v16
    v_exp_f32 v17, v17
    v_cvt_pk_bf16_f32 v100, v8, v12
    v_cvt_pk_bf16_f32 v102, v9, v13
    v_cvt_pk_bf16_f32 v104, v10, v14
    v_cvt_pk_bf16_f32 v106, v11, v15
    v_mfma_f32_16x16x32_bf16 v[8:11], v[0:3], v[140:143], 0
    v_add_f32 v56, v56, v57
    v_add_f32 v60, v60, v61
    v_mfma_f32_16x16x32_bf16 v[8:11], v[4:7], v[144:147], v[8:11]
    v_cvt_pk_bf16_f32 v89, v56, v60
    v_sub_f32 v18, v18, v250
    v_mfma_f32_16x16x32_bf16 v[12:15], v[0:3], v[148:151], 0
    buffer_store_dwordx2 v[88:89], v241, s[8:11], s26 offen offset:2304 sc0 sc1
    v_sub_f32 v19, v19, v250
    v_mfma_f32_16x16x32_bf16 v[12:15], v[4:7], v[152:155], v[12:15]
    v_sub_f32 v20, v20, v250
    v_sub_f32 v21, v21, v250
    v_mfma_f32_16x16x32_bf16 v[76:79], a[0:3], a[216:219], 0
    v_exp_f32 v18, v18
    v_mfma_f32_16x16x32_bf16 v[76:79], a[4:7], a[220:223], v[76:79]
    v_exp_f32 v19, v19
    v_mfma_f32_16x16x32_bf16 v[76:79], a[8:11], a[224:227], v[76:79]
    v_exp_f32 v20, v20
    v_mfma_f32_16x16x32_bf16 v[80:83], a[24:27], a[216:219], 0
    v_cvt_pk_bf16_f32 v101, v8, v12
    v_cvt_pk_bf16_f32 v103, v9, v13
    v_mfma_f32_16x16x32_bf16 v[80:83], a[28:31], a[220:223], v[80:83]
    buffer_store_dwordx2 v[100:101], v233, s[8:11], s20 offen offset:0 sc0 sc1
    v_sub_f32 v22, v22, v250
    v_mfma_f32_16x16x32_bf16 v[80:83], a[32:35], a[224:227], v[80:83]
    v_exp_f32 v21, v21
    v_mfma_f32_16x16x32_bf16 v[84:87], a[48:51], a[216:219], 0
    ds_read_b128 a[216:219], v221 offset:51200
    v_sub_f32 v23, v23, v250
    v_mfma_f32_16x16x32_bf16 v[84:87], a[52:55], a[220:223], v[84:87]
    buffer_store_dwordx2 v[102:103], v233, s[8:11], s21 offen offset:0 sc0 sc1
    v_sub_f32 v24, v24, v250
    v_mfma_f32_16x16x32_bf16 v[84:87], a[56:59], a[224:227], v[84:87]
    s_waitcnt lgkmcnt(1)
    ds_read_b128 a[220:223], v221 offset:52224
    v_add_f32 v252, v16, v17
    v_mfma_f32_16x16x32_bf16 v[76:79], a[12:15], a[228:231], v[76:79]
    ds_read_b128 a[224:227], v221 offset:53248
    v_cvt_pk_bf16_f32 v105, v10, v14
    v_mfma_f32_16x16x32_bf16 v[76:79], a[16:19], a[232:235], v[76:79]
    buffer_store_dwordx2 v[104:105], v233, s[8:11], s22 offen offset:0 sc0 sc1
    v_sub_f32 v25, v25, v250
    v_mfma_f32_16x16x32_bf16 v[76:79], a[20:23], a[236:239], v[76:79]
    v_exp_f32 v22, v22
    v_mfma_f32_16x16x32_bf16 v[80:83], a[36:39], a[228:231], v[80:83]
    v_exp_f32 v23, v23
    v_mfma_f32_16x16x32_bf16 v[80:83], a[40:43], a[232:235], v[80:83]
    v_exp_f32 v24, v24
    v_mfma_f32_16x16x32_bf16 v[80:83], a[44:47], a[236:239], v[80:83]
    v_sub_f32 v26, v26, v250
    v_add_f32 v253, v18, v19
    v_mfma_f32_16x16x32_bf16 v[84:87], a[60:63], a[228:231], v[84:87]
    ds_read_b128 a[228:231], v221 offset:54272
    v_add_f32 v252, v252, v20
    v_mfma_f32_16x16x32_bf16 v[84:87], a[64:67], a[232:235], v[84:87]
    ds_read_b128 a[232:235], v221 offset:55296
    v_sub_f32 v27, v27, v250
    v_mfma_f32_16x16x32_bf16 v[84:87], a[68:71], a[236:239], v[84:87]
    ds_read_b128 a[236:239], v221 offset:56320
    v_exp_f32 v25, v25
    v_exp_f32 v26, v26
    v_sub_f32 v28, v28, v250
    v_add_f32 v253, v253, v21
    v_add_f32 v252, v252, v22
    v_exp_f32 v27, v27
    v_exp_f32 v28, v28
    v_add_f32 v253, v253, v23
    v_add_f32 v252, v252, v24
    v_add_f32 v253, v253, v25
    v_add_f32 v252, v252, v26
    v_add_f32 v253, v253, v27
    v_add_f32 v252, v252, v28
    v_add_f32 v252, v252, v253
    v_mov_b32 v253, v252
    v_cvt_pk_bf16_f32 v107, v11, v15
    v_cvt_pk_bf16_f32 v159, v70, v71
    v_permlane32_swap_b32 v252, v253
    v_add_f32 v252, v252, v253
    v_mov_b32 v253, v252
    v_cvt_pk_bf16_f32 v160, v72, v73
    v_cvt_pk_bf16_f32 v161, v74, v75
    v_permlane16_swap_b32 v252, v253
    v_add_f32 v252, v252, v253
    v_rcp_f32 v254, v252
    v_mov_b32 v56, 0
    v_mul_f32 v16, v16, v254
    v_mul_f32 v17, v17, v254
    v_cvt_pk_bf16_f32 v16, v16, v17
    v_mul_f32 v18, v18, v254
    v_mul_f32 v19, v19, v254
    v_cvt_pk_bf16_f32 v17, v18, v19
    v_mul_f32 v20, v20, v254
    v_mul_f32 v21, v21, v254
    v_mul_f32 v22, v22, v254
    v_mul_f32 v23, v23, v254
    v_cvt_pk_bf16_f32 v18, v20, v21
    v_cvt_pk_bf16_f32 v19, v22, v23
    v_mul_f32 v24, v24, v254
    v_mul_f32 v25, v25, v254
    v_mul_f32 v26, v26, v254
    v_mul_f32 v27, v27, v254
    v_cvt_pk_bf16_f32 v20, v24, v25
    v_cvt_pk_bf16_f32 v21, v26, v27
    v_mfma_f32_16x16x32_bf16 v[24:27], v[16:19], v[124:127], 0
    buffer_store_dwordx2 v[106:107], v233, s[8:11], s23 offen offset:0 sc0 sc1
    v_mul_f32 v28, v28, v254
    v_cvt_pk_bf16_f32 v22, v28, 0
    v_mov_b32 v23, 0
    s_nop 0
    s_nop 0
    v_mfma_f32_16x16x32_bf16 v[24:27], v[20:23], v[128:131], v[24:27]
    v_mov_b32 v57, 0
    v_cvt_pk_bf16_f32 v164, v76, v77
    v_mfma_f32_16x16x32_bf16 v[28:31], v[16:19], v[132:135], 0
    v_cvt_pk_bf16_f32 v165, v78, v79
    v_cvt_pk_bf16_f32 v166, v80, v81
    v_mfma_f32_16x16x32_bf16 v[28:31], v[20:23], v[136:139], v[28:31]
    v_cvt_pk_bf16_f32 v167, v82, v83
    v_cvt_pk_bf16_f32 v168, v84, v85
    v_cvt_pk_bf16_f32 v169, v86, v87
    v_mov_b32 v60, 0
    v_mov_b32 v61, 0
    v_max3_f32 v245, v245, v38, v39
    v_max3_f32 v246, v246, v40, v41
    v_max3_f32 v245, v245, v42, v43
    v_max3_f32 v245, v245, v246, v44
    v_mov_b32 v246, v245
    v_cvt_pk_bf16_f32 v108, v24, v28
    v_cvt_pk_bf16_f32 v110, v25, v29
    v_cvt_pk_bf16_f32 v112, v26, v30
    v_cvt_pk_bf16_f32 v114, v27, v31
    v_mfma_f32_16x16x32_bf16 v[24:27], v[16:19], v[140:143], 0
    v_permlane32_swap_b32 v245, v246
    v_mfma_f32_16x16x32_bf16 v[24:27], v[20:23], v[144:147], v[24:27]
    v_max_f32 v245, v245, v246
    v_mov_b32 v246, v245
    v_mfma_f32_16x16x32_bf16 v[28:31], v[16:19], v[148:151], 0
    v_mfma_f32_16x16x32_bf16 v[28:31], v[20:23], v[152:155], v[28:31]
    v_permlane16_swap_b32 v245, v246
    v_mfma_f32_16x16x32_bf16 v[64:67], a[0:3], a[192:195], 0
    v_max_f32 v245, v245, v246
    v_sub_f32 v32, v32, v245
    v_mfma_f32_16x16x32_bf16 v[64:67], a[4:7], a[196:199], v[64:67]
    v_sub_f32 v33, v33, v245
    v_sub_f32 v34, v34, v245
    v_mfma_f32_16x16x32_bf16 v[64:67], a[8:11], a[200:203], v[64:67]
    v_cvt_pk_bf16_f32 v109, v24, v28
    v_cvt_pk_bf16_f32 v111, v25, v29
    v_mfma_f32_16x16x32_bf16 v[68:71], a[24:27], a[192:195], 0
    buffer_store_dwordx2 v[108:109], v233, s[8:11], s24 offen offset:0 sc0 sc1
    v_cvt_pk_bf16_f32 v113, v26, v30
    v_mfma_f32_16x16x32_bf16 v[68:71], a[28:31], a[196:199], v[68:71]
    v_cvt_pk_bf16_f32 v115, v27, v31
    v_sub_f32 v35, v35, v245
    v_mfma_f32_16x16x32_bf16 v[68:71], a[32:35], a[200:203], v[68:71]
    v_exp_f32 v32, v32
    v_mfma_f32_16x16x32_bf16 v[72:75], a[48:51], a[192:195], 0
    buffer_store_dwordx2 v[110:111], v233, s[8:11], s25 offen offset:0 sc0 sc1
    v_sub_f32 v36, v36, v245
    v_mfma_f32_16x16x32_bf16 v[72:75], a[52:55], a[196:199], v[72:75]
    ds_read_b128 a[192:195], v221 offset:57344
    v_sub_f32 v37, v37, v245
    v_mfma_f32_16x16x32_bf16 v[72:75], a[56:59], a[200:203], v[72:75]
    ds_read_b128 a[196:199], v221 offset:58368
    v_sub_f32 v38, v38, v245
    v_mfma_f32_16x16x32_bf16 v[64:67], a[12:15], a[204:207], v[64:67]
    buffer_store_dwordx2 v[112:113], v233, s[8:11], s26 offen offset:0 sc0 sc1
    v_sub_f32 v39, v39, v245
    v_mfma_f32_16x16x32_bf16 v[64:67], a[16:19], a[208:211], v[64:67]
    ds_read_b128 a[200:203], v221 offset:59392
    v_sub_f32 v40, v40, v245
    v_mfma_f32_16x16x32_bf16 v[64:67], a[20:23], a[212:215], v[64:67]
    v_exp_f32 v33, v33
    v_mfma_f32_16x16x32_bf16 v[68:71], a[36:39], a[204:207], v[68:71]
    buffer_store_dwordx2 v[114:115], v235, s[8:11], s20 offen offset:1536 sc0 sc1
    v_add_f32 v247, v32, v33
    v_mfma_f32_16x16x32_bf16 v[68:71], a[40:43], a[208:211], v[68:71]
    v_exp_f32 v34, v34
    v_mfma_f32_16x16x32_bf16 v[68:71], a[44:47], a[212:215], v[68:71]
    v_exp_f32 v35, v35
    v_mfma_f32_16x16x32_bf16 v[72:75], a[60:63], a[204:207], v[72:75]
    ds_read_b128 a[204:207], v221 offset:60416
    v_sub_f32 v41, v41, v245
    v_mfma_f32_16x16x32_bf16 v[72:75], a[64:67], a[208:211], v[72:75]
    ds_read_b128 a[208:211], v221 offset:61440
    v_sub_f32 v42, v42, v245
    v_mfma_f32_16x16x32_bf16 v[72:75], a[68:71], a[212:215], v[72:75]
    ds_read_b128 a[212:215], v221 offset:62464
    v_add_f32 v248, v34, v35
    v_smfmac_f32_16x16x64_bf16 v[56:59], v[48:51], v[156:163], v228
    v_exp_f32 v36, v36
    v_smfmac_f32_16x16x64_bf16 v[60:63], v[48:51], v[164:171], v228
    v_exp_f32 v37, v37
    v_mfma_f32_16x16x32_bf16 v[8:11], v[0:3], v[156:159], 0
    v_exp_f32 v38, v38
    v_mfma_f32_16x16x32_bf16 v[8:11], v[4:7], v[160:163], v[8:11]
    v_exp_f32 v39, v39
    v_mfma_f32_16x16x32_bf16 v[12:15], v[0:3], v[164:167], 0
    v_exp_f32 v40, v40
    v_mfma_f32_16x16x32_bf16 v[12:15], v[4:7], v[168:171], v[12:15]
    s_waitcnt lgkmcnt(4)
    v_add_f32 v247, v247, v36
    v_sub_f32 v43, v43, v245
    v_mfma_f32_16x16x32_bf16 v[76:79], a[0:3], a[216:219], 0
    v_exp_f32 v41, v41
    v_mfma_f32_16x16x32_bf16 v[76:79], a[4:7], a[220:223], v[76:79]
    v_exp_f32 v42, v42
    v_mfma_f32_16x16x32_bf16 v[76:79], a[8:11], a[224:227], v[76:79]
    v_sub_f32 v44, v44, v245
    v_add_f32 v248, v248, v37
    v_mfma_f32_16x16x32_bf16 v[80:83], a[24:27], a[216:219], 0
    v_add_f32 v247, v247, v38
    v_add_f32 v248, v248, v39
    v_mfma_f32_16x16x32_bf16 v[80:83], a[28:31], a[220:223], v[80:83]
    v_exp_f32 v43, v43
    v_mfma_f32_16x16x32_bf16 v[80:83], a[32:35], a[224:227], v[80:83]
    v_exp_f32 v44, v44
    v_mfma_f32_16x16x32_bf16 v[84:87], a[48:51], a[216:219], 0
    ds_read_b128 a[216:219], v221 offset:63488
    v_add_f32 v247, v247, v40
    v_mfma_f32_16x16x32_bf16 v[84:87], a[52:55], a[220:223], v[84:87]
    ds_read_b128 a[220:223], v221 offset:64512
    v_add_f32 v248, v248, v41
    v_mfma_f32_16x16x32_bf16 v[84:87], a[56:59], a[224:227], v[84:87]
    ds_read_b128 a[224:227], v222 offset:0
    v_add_f32 v247, v247, v42
    v_mfma_f32_16x16x32_bf16 v[76:79], a[12:15], a[228:231], v[76:79]
    v_add_f32 v248, v248, v43
    v_add_f32 v247, v247, v44
    v_mfma_f32_16x16x32_bf16 v[76:79], a[16:19], a[232:235], v[76:79]
    v_add_f32 v247, v247, v248
    v_mov_b32 v248, v247
    v_mfma_f32_16x16x32_bf16 v[76:79], a[20:23], a[236:239], v[76:79]
    v_cvt_pk_bf16_f32 v172, v64, v65
    v_cvt_pk_bf16_f32 v173, v66, v67
    v_mfma_f32_16x16x32_bf16 v[80:83], a[36:39], a[228:231], v[80:83]
    v_permlane32_swap_b32 v247, v248
    v_mfma_f32_16x16x32_bf16 v[80:83], a[40:43], a[232:235], v[80:83]
    v_add_f32 v247, v247, v248
    v_mov_b32 v248, v247
    v_mfma_f32_16x16x32_bf16 v[80:83], a[44:47], a[236:239], v[80:83]
    v_cvt_pk_bf16_f32 v174, v68, v69
    v_cvt_pk_bf16_f32 v175, v70, v71
    v_mfma_f32_16x16x32_bf16 v[84:87], a[60:63], a[228:231], v[84:87]
    ds_read_b128 a[228:231], v222 offset:1024
    v_cvt_pk_bf16_f32 v176, v72, v73
    v_mfma_f32_16x16x32_bf16 v[84:87], a[64:67], a[232:235], v[84:87]
    ds_read_b128 a[232:235], v222 offset:2048
    v_cvt_pk_bf16_f32 v177, v74, v75
    v_mfma_f32_16x16x32_bf16 v[84:87], a[68:71], a[236:239], v[84:87]
    ds_read_b128 a[236:239], v222 offset:3072
    v_permlane16_swap_b32 v247, v248
    v_add_f32 v247, v247, v248
    v_rcp_f32 v249, v247
    v_add_f32 v56, v56, v57
    v_mul_f32 v32, v32, v249
    v_mul_f32 v33, v33, v249
    v_cvt_pk_bf16_f32 v32, v32, v33
    v_mul_f32 v34, v34, v249
    v_mul_f32 v35, v35, v249
    v_cvt_pk_bf16_f32 v33, v34, v35
    v_mul_f32 v36, v36, v249
    v_mul_f32 v37, v37, v249
    v_mul_f32 v38, v38, v249
    v_mul_f32 v39, v39, v249
    v_cvt_pk_bf16_f32 v34, v36, v37
    v_cvt_pk_bf16_f32 v35, v38, v39
    v_mul_f32 v40, v40, v249
    v_mul_f32 v41, v41, v249
    v_mul_f32 v42, v42, v249
    v_mul_f32 v43, v43, v249
    v_cvt_pk_bf16_f32 v36, v40, v41
    v_cvt_pk_bf16_f32 v37, v42, v43
    v_mfma_f32_16x16x32_bf16 v[40:43], v[32:35], v[124:127], 0
    v_mul_f32 v44, v44, v249
    v_cvt_pk_bf16_f32 v38, v44, 0
    v_mov_b32 v39, 0
    s_nop 0
    s_nop 0
    v_mfma_f32_16x16x32_bf16 v[40:43], v[36:39], v[128:131], v[40:43]
    v_add_f32 v60, v60, v61
    v_cvt_pk_bf16_f32 v90, v56, v60
    v_mfma_f32_16x16x32_bf16 v[44:47], v[32:35], v[132:135], 0
    v_mov_b32 v56, 0
    v_mov_b32 v57, 0
    v_mfma_f32_16x16x32_bf16 v[44:47], v[36:39], v[136:139], v[44:47]
    v_cvt_pk_bf16_f32 v180, v76, v77
    v_cvt_pk_bf16_f32 v181, v78, v79
    v_mfma_f32_16x16x32_bf16 v[132:135], v[32:35], v[140:143], 0
    v_cvt_pk_bf16_f32 v182, v80, v81
    v_cvt_pk_bf16_f32 v183, v82, v83
    v_mfma_f32_16x16x32_bf16 v[132:135], v[36:39], v[144:147], v[132:135]
    v_cvt_pk_bf16_f32 v184, v84, v85
    v_cvt_pk_bf16_f32 v185, v86, v87
    v_mfma_f32_16x16x32_bf16 v[136:139], v[32:35], v[148:151], 0
    v_cvt_pk_bf16_f32 v124, v40, v44
    v_cvt_pk_bf16_f32 v126, v41, v45
    v_mfma_f32_16x16x32_bf16 v[136:139], v[36:39], v[152:155], v[136:139]
    v_cvt_pk_bf16_f32 v128, v42, v46
    v_cvt_pk_bf16_f32 v130, v43, v47
    v_mfma_f32_16x16x32_bf16 v[24:27], v[16:19], v[156:159], 0
    v_mov_b32 v60, 0
    v_mov_b32 v61, 0
    v_mfma_f32_16x16x32_bf16 v[24:27], v[20:23], v[160:163], v[24:27]
    v_cvt_pk_bf16_f32 v116, v8, v12
    v_cvt_pk_bf16_f32 v118, v9, v13
    v_mfma_f32_16x16x32_bf16 v[28:31], v[16:19], v[164:167], 0
    v_cvt_pk_bf16_f32 v125, v132, v136
    v_cvt_pk_bf16_f32 v127, v133, v137
    v_mfma_f32_16x16x32_bf16 v[28:31], v[20:23], v[168:171], v[28:31]
    buffer_store_dwordx2 v[124:125], v235, s[8:11], s20 offen offset:1920 sc0 sc1
    v_cvt_pk_bf16_f32 v129, v134, v138
    v_mfma_f32_16x16x32_bf16 v[64:67], a[0:3], a[192:195], 0
    v_cvt_pk_bf16_f32 v131, v135, v139
    v_cvt_pk_bf16_f32 v120, v10, v14
    v_mfma_f32_16x16x32_bf16 v[64:67], a[4:7], a[196:199], v[64:67]
    s_waitcnt lgkmcnt(0)
    v_cvt_pk_bf16_f32 v122, v11, v15
    v_mfma_f32_16x16x32_bf16 v[64:67], a[8:11], a[200:203], v[64:67]
    buffer_store_dwordx2 v[126:127], v235, s[8:11], s20 offen offset:2304 sc0 sc1
    v_cvt_pk_bf16_f32 v92, v24, v28
    v_mfma_f32_16x16x32_bf16 v[68:71], a[24:27], a[192:195], 0
L_pad17:
    s_cbranch_execz L_vax
    v_cvt_pk_bf16_f32 v94, v25, v29
    v_cvt_pk_bf16_f32 v96, v26, v30
    v_mfma_f32_16x16x32_bf16 v[68:71], a[28:31], a[196:199], v[68:71]
    v_cvt_pk_bf16_f32 v98, v27, v31
    v_mfma_f32_16x16x32_bf16 v[68:71], a[32:35], a[200:203], v[68:71]
    buffer_store_dwordx2 v[128:129], v237, s[8:11], s24 offen offset:1536 sc0 sc1
    v_mfma_f32_16x16x32_bf16 v[72:75], a[48:51], a[192:195], 0
    ds_read_b128 a[192:195], v222 offset:4096
    v_mfma_f32_16x16x32_bf16 v[72:75], a[52:55], a[196:199], v[72:75]
    ds_read_b128 a[196:199], v222 offset:5120
    v_mfma_f32_16x16x32_bf16 v[72:75], a[56:59], a[200:203], v[72:75]
    buffer_store_dwordx2 v[130:131], v239, s[8:11], s24 offen offset:0 sc0 sc1
    ds_read_b128 a[200:203], v222 offset:6144
    v_mfma_f32_16x16x32_bf16 v[64:67], a[12:15], a[204:207], v[64:67]
    v_mfma_f32_16x16x32_bf16 v[64:67], a[16:19], a[208:211], v[64:67]
    v_mfma_f32_16x16x32_bf16 v[64:67], a[20:23], a[212:215], v[64:67]
    v_mfma_f32_16x16x32_bf16 v[68:71], a[36:39], a[204:207], v[68:71]
    v_mfma_f32_16x16x32_bf16 v[68:71], a[40:43], a[208:211], v[68:71]
    v_mfma_f32_16x16x32_bf16 v[68:71], a[44:47], a[212:215], v[68:71]
    v_mfma_f32_16x16x32_bf16 v[72:75], a[60:63], a[204:207], v[72:75]
    ds_read_b128 a[204:207], v222 offset:7168
    v_mfma_f32_16x16x32_bf16 v[72:75], a[64:67], a[208:211], v[72:75]
    ds_read_b128 a[208:211], v222 offset:8192
    v_mfma_f32_16x16x32_bf16 v[72:75], a[68:71], a[212:215], v[72:75]
    ds_read_b128 a[212:215], v222 offset:9216
    v_cvt_pk_bf16_f32 v188, v64, v65
    v_smfmac_f32_16x16x64_bf16 v[56:59], v[48:51], v[172:179], v228
    v_cvt_pk_bf16_f32 v189, v66, v67
    v_cvt_pk_bf16_f32 v190, v68, v69
    v_smfmac_f32_16x16x64_bf16 v[60:63], v[48:51], v[180:187], v228
    v_cvt_pk_bf16_f32 v191, v70, v71
    v_mfma_f32_16x16x32_bf16 v[8:11], v[0:3], v[172:175], 0
    v_cvt_pk_bf16_f32 v192, v72, v73
    v_cvt_pk_bf16_f32 v193, v74, v75
    v_mfma_f32_16x16x32_bf16 v[8:11], v[4:7], v[176:179], v[8:11]
    v_add_f32 v56, v56, v57
    v_mov_b32 v57, 0
    v_mfma_f32_16x16x32_bf16 v[12:15], v[0:3], v[180:183], 0
    v_add_f32 v60, v60, v61
    v_cvt_pk_bf16_f32 v91, v56, v60
    v_mfma_f32_16x16x32_bf16 v[12:15], v[4:7], v[184:187], v[12:15]
    buffer_store_dwordx2 v[90:91], v241, s[8:11], s26 offen offset:2432 sc0 sc1
    v_mov_b32 v56, 0
    v_mfma_f32_16x16x32_bf16 v[24:27], v[16:19], v[172:175], 0
    v_mov_b32 v60, 0
    v_mov_b32 v61, 0
    v_mfma_f32_16x16x32_bf16 v[24:27], v[20:23], v[176:179], v[24:27]
    v_mfma_f32_16x16x32_bf16 v[28:31], v[16:19], v[180:183], 0
    v_mfma_f32_16x16x32_bf16 v[28:31], v[20:23], v[184:187], v[28:31]
    v_cvt_pk_bf16_f32 v117, v8, v12
    v_cvt_pk_bf16_f32 v119, v9, v13
    v_mfma_f32_16x16x32_bf16 v[40:43], v[32:35], v[156:159], 0
    buffer_store_dwordx2 v[116:117], v233, s[8:11], s20 offen offset:128 sc0 sc1
    v_cvt_pk_bf16_f32 v121, v10, v14
    v_mfma_f32_16x16x32_bf16 v[40:43], v[36:39], v[160:163], v[40:43]
    v_cvt_pk_bf16_f32 v123, v11, v15
    v_mfma_f32_16x16x32_bf16 v[44:47], v[32:35], v[164:167], 0
    v_cvt_pk_bf16_f32 v93, v24, v28
    v_cvt_pk_bf16_f32 v95, v25, v29
    v_mfma_f32_16x16x32_bf16 v[44:47], v[36:39], v[168:171], v[44:47]
    buffer_store_dwordx2 v[118:119], v233, s[8:11], s21 offen offset:128 sc0 sc1
    v_cvt_pk_bf16_f32 v97, v26, v30
    v_mfma_f32_16x16x32_bf16 v[148:151], v[32:35], v[172:175], 0
    v_cvt_pk_bf16_f32 v99, v27, v31
    v_mfma_f32_16x16x32_bf16 v[148:151], v[36:39], v[176:179], v[148:151]
    v_mfma_f32_16x16x32_bf16 v[152:155], v[32:35], v[180:183], 0
    buffer_store_dwordx2 v[92:93], v233, s[8:11], s24 offen offset:128 sc0 sc1
    v_mfma_f32_16x16x32_bf16 v[152:155], v[36:39], v[184:187], v[152:155]
    v_cvt_pk_bf16_f32 v132, v40, v44
    v_cvt_pk_bf16_f32 v134, v41, v45
    v_mfma_f32_16x16x32_bf16 v[76:79], a[0:3], a[216:219], 0
    v_cvt_pk_bf16_f32 v136, v42, v46
    v_cvt_pk_bf16_f32 v138, v43, v47
    v_mfma_f32_16x16x32_bf16 v[76:79], a[4:7], a[220:223], v[76:79]
    buffer_store_dwordx2 v[120:121], v233, s[8:11], s22 offen offset:128 sc0 sc1
    v_mfma_f32_16x16x32_bf16 v[76:79], a[8:11], a[224:227], v[76:79]
    v_cvt_pk_bf16_f32 v133, v148, v152
    v_cvt_pk_bf16_f32 v135, v149, v153
    v_mfma_f32_16x16x32_bf16 v[80:83], a[24:27], a[216:219], 0
    v_cvt_pk_bf16_f32 v137, v150, v154
    v_cvt_pk_bf16_f32 v139, v151, v155
    v_mfma_f32_16x16x32_bf16 v[80:83], a[28:31], a[220:223], v[80:83]
    buffer_store_dwordx2 v[94:95], v233, s[8:11], s25 offen offset:128 sc0 sc1
    v_mfma_f32_16x16x32_bf16 v[80:83], a[32:35], a[224:227], v[80:83]
    v_mfma_f32_16x16x32_bf16 v[84:87], a[48:51], a[216:219], 0
    ds_read_b128 a[216:219], v222 offset:10240
    v_mfma_f32_16x16x32_bf16 v[84:87], a[52:55], a[220:223], v[84:87]
    buffer_store_dwordx2 v[122:123], v233, s[8:11], s23 offen offset:128 sc0 sc1
    ds_read_b128 a[220:223], v222 offset:11264
    v_mfma_f32_16x16x32_bf16 v[84:87], a[56:59], a[224:227], v[84:87]
    ds_read_b128 a[224:227], v222 offset:12288
    v_mfma_f32_16x16x32_bf16 v[76:79], a[12:15], a[228:231], v[76:79]
    v_mfma_f32_16x16x32_bf16 v[76:79], a[16:19], a[232:235], v[76:79]
    buffer_store_dwordx2 v[96:97], v233, s[8:11], s26 offen offset:128 sc0 sc1
    v_mfma_f32_16x16x32_bf16 v[76:79], a[20:23], a[236:239], v[76:79]
    v_mfma_f32_16x16x32_bf16 v[80:83], a[36:39], a[228:231], v[80:83]
    v_mfma_f32_16x16x32_bf16 v[80:83], a[40:43], a[232:235], v[80:83]
    buffer_store_dwordx2 v[132:133], v235, s[8:11], s20 offen offset:2048 sc0 sc1
    v_mfma_f32_16x16x32_bf16 v[80:83], a[44:47], a[236:239], v[80:83]
    v_mfma_f32_16x16x32_bf16 v[84:87], a[60:63], a[228:231], v[84:87]
    ds_read_b128 a[228:231], v222 offset:13312
    v_mfma_f32_16x16x32_bf16 v[84:87], a[64:67], a[232:235], v[84:87]
    buffer_store_dwordx2 v[98:99], v235, s[8:11], s20 offen offset:1664 sc0 sc1
    v_cvt_pk_bf16_f32 v196, v76, v77
    v_mfma_f32_16x16x32_bf16 v[84:87], a[68:71], a[236:239], v[84:87]
    s_waitcnt lgkmcnt(4)
    ds_read_b128 a[232:235], v222 offset:14336
    v_cvt_pk_bf16_f32 v197, v78, v79
    v_mfma_f32_16x16x32_bf16 v[64:67], a[0:3], a[192:195], 0
    ds_read_b128 a[236:239], v222 offset:15360
    v_cvt_pk_bf16_f32 v198, v80, v81
    v_mfma_f32_16x16x32_bf16 v[64:67], a[4:7], a[196:199], v[64:67]
    buffer_store_dwordx2 v[134:135], v235, s[8:11], s20 offen offset:2432 sc0 sc1
    v_cvt_pk_bf16_f32 v199, v82, v83
    v_mfma_f32_16x16x32_bf16 v[64:67], a[8:11], a[200:203], v[64:67]
    v_cvt_pk_bf16_f32 v200, v84, v85
    v_cvt_pk_bf16_f32 v201, v86, v87
    v_mfma_f32_16x16x32_bf16 v[68:71], a[24:27], a[192:195], 0
    v_mfma_f32_16x16x32_bf16 v[68:71], a[28:31], a[196:199], v[68:71]
    buffer_store_dwordx2 v[136:137], v237, s[8:11], s24 offen offset:1664 sc0 sc1
    v_mfma_f32_16x16x32_bf16 v[68:71], a[32:35], a[200:203], v[68:71]
    v_mfma_f32_16x16x32_bf16 v[72:75], a[48:51], a[192:195], 0
    v_mfma_f32_16x16x32_bf16 v[72:75], a[52:55], a[196:199], v[72:75]
    buffer_store_dwordx2 v[138:139], v239, s[8:11], s24 offen offset:128 sc0 sc1
    v_mfma_f32_16x16x32_bf16 v[72:75], a[56:59], a[200:203], v[72:75]
    v_mfma_f32_16x16x32_bf16 v[64:67], a[12:15], a[204:207], v[64:67]
    v_mfma_f32_16x16x32_bf16 v[64:67], a[16:19], a[208:211], v[64:67]
    v_mfma_f32_16x16x32_bf16 v[64:67], a[20:23], a[212:215], v[64:67]
    v_mfma_f32_16x16x32_bf16 v[68:71], a[36:39], a[204:207], v[68:71]
    v_mfma_f32_16x16x32_bf16 v[68:71], a[40:43], a[208:211], v[68:71]
    v_mfma_f32_16x16x32_bf16 v[68:71], a[44:47], a[212:215], v[68:71]
    v_mfma_f32_16x16x32_bf16 v[72:75], a[60:63], a[204:207], v[72:75]
    v_mfma_f32_16x16x32_bf16 v[72:75], a[64:67], a[208:211], v[72:75]
    v_mfma_f32_16x16x32_bf16 v[72:75], a[68:71], a[212:215], v[72:75]
    v_smfmac_f32_16x16x64_bf16 v[56:59], v[48:51], v[188:195], v228
    v_smfmac_f32_16x16x64_bf16 v[60:63], v[48:51], v[196:203], v228
    v_cvt_pk_bf16_f32 v204, v64, v65
    v_cvt_pk_bf16_f32 v205, v66, v67
    v_mfma_f32_16x16x32_bf16 v[8:11], v[0:3], v[188:191], 0
    v_cvt_pk_bf16_f32 v206, v68, v69
    v_cvt_pk_bf16_f32 v207, v70, v71
    v_mfma_f32_16x16x32_bf16 v[8:11], v[4:7], v[192:195], v[8:11]
    v_cvt_pk_bf16_f32 v208, v72, v73
    v_add_f32 v56, v56, v57
    v_mfma_f32_16x16x32_bf16 v[12:15], v[0:3], v[196:199], 0
    v_add_f32 v60, v60, v61
    v_cvt_pk_bf16_f32 v250, v56, v60
    v_mfma_f32_16x16x32_bf16 v[12:15], v[4:7], v[200:203], v[12:15]
    v_cvt_pk_bf16_f32 v209, v74, v75
    v_mov_b32 v56, 0
    v_mfma_f32_16x16x32_bf16 v[24:27], v[16:19], v[188:191], 0
    v_mov_b32 v57, 0
    v_mov_b32 v60, 0
    v_mfma_f32_16x16x32_bf16 v[24:27], v[20:23], v[192:195], v[24:27]
    v_mov_b32 v61, 0
    v_mfma_f32_16x16x32_bf16 v[28:31], v[16:19], v[196:199], 0
    v_cvt_pk_bf16_f32 v100, v8, v12
    v_cvt_pk_bf16_f32 v102, v9, v13
    v_mfma_f32_16x16x32_bf16 v[28:31], v[20:23], v[200:203], v[28:31]
    v_cvt_pk_bf16_f32 v104, v10, v14
    v_cvt_pk_bf16_f32 v106, v11, v15
    v_mfma_f32_16x16x32_bf16 v[40:43], v[32:35], v[188:191], 0
    v_mfma_f32_16x16x32_bf16 v[40:43], v[36:39], v[192:195], v[40:43]
    v_mfma_f32_16x16x32_bf16 v[44:47], v[32:35], v[196:199], 0
    v_mfma_f32_16x16x32_bf16 v[44:47], v[36:39], v[200:203], v[44:47]
    s_waitcnt lgkmcnt(0)
    v_mfma_f32_16x16x32_bf16 v[76:79], a[0:3], a[216:219], 0
    v_mfma_f32_16x16x32_bf16 v[76:79], a[4:7], a[220:223], v[76:79]
    v_cvt_pk_bf16_f32 v108, v24, v28
    v_cvt_pk_bf16_f32 v110, v25, v29
    v_mfma_f32_16x16x32_bf16 v[76:79], a[8:11], a[224:227], v[76:79]
    v_cvt_pk_bf16_f32 v112, v26, v30
    v_cvt_pk_bf16_f32 v114, v27, v31
    v_mfma_f32_16x16x32_bf16 v[80:83], a[24:27], a[216:219], 0
    v_cvt_pk_bf16_f32 v140, v40, v44
    v_cvt_pk_bf16_f32 v142, v41, v45
    v_mfma_f32_16x16x32_bf16 v[80:83], a[28:31], a[220:223], v[80:83]
    v_cvt_pk_bf16_f32 v144, v42, v46
    v_cvt_pk_bf16_f32 v146, v43, v47
    v_mfma_f32_16x16x32_bf16 v[80:83], a[32:35], a[224:227], v[80:83]
    v_mfma_f32_16x16x32_bf16 v[84:87], a[48:51], a[216:219], 0
    v_mfma_f32_16x16x32_bf16 v[84:87], a[52:55], a[220:223], v[84:87]
    v_mfma_f32_16x16x32_bf16 v[84:87], a[56:59], a[224:227], v[84:87]
    v_mfma_f32_16x16x32_bf16 v[76:79], a[12:15], a[228:231], v[76:79]
    v_mfma_f32_16x16x32_bf16 v[76:79], a[16:19], a[232:235], v[76:79]
    v_mfma_f32_16x16x32_bf16 v[76:79], a[20:23], a[236:239], v[76:79]
    v_mfma_f32_16x16x32_bf16 v[80:83], a[36:39], a[228:231], v[80:83]
    v_mfma_f32_16x16x32_bf16 v[80:83], a[40:43], a[232:235], v[80:83]
    v_mfma_f32_16x16x32_bf16 v[80:83], a[44:47], a[236:239], v[80:83]
    v_mfma_f32_16x16x32_bf16 v[84:87], a[60:63], a[228:231], v[84:87]
    v_mfma_f32_16x16x32_bf16 v[84:87], a[64:67], a[232:235], v[84:87]
    v_mfma_f32_16x16x32_bf16 v[84:87], a[68:71], a[236:239], v[84:87]
    v_smfmac_f32_16x16x64_bf16 v[56:59], v[48:51], v[204:211], v228
    s_nop 0
    v_cvt_pk_bf16_f32 v212, v76, v77
    v_cvt_pk_bf16_f32 v213, v78, v79
    s_nop 0
    v_cvt_pk_bf16_f32 v214, v80, v81
    v_cvt_pk_bf16_f32 v215, v82, v83
    s_nop 0
    v_cvt_pk_bf16_f32 v216, v84, v85
    v_cvt_pk_bf16_f32 v217, v86, v87
    s_nop 0
    s_nop 0
    v_smfmac_f32_16x16x64_bf16 v[60:63], v[48:51], v[212:219], v228
    v_add_f32 v56, v56, v57
    v_mfma_f32_16x16x32_bf16 v[8:11], v[0:3], v[204:207], 0
    v_mfma_f32_16x16x32_bf16 v[8:11], v[4:7], v[208:211], v[8:11]
    v_mfma_f32_16x16x32_bf16 v[12:15], v[0:3], v[212:215], 0
    v_mfma_f32_16x16x32_bf16 v[12:15], v[4:7], v[216:219], v[12:15]
    v_mfma_f32_16x16x32_bf16 v[24:27], v[16:19], v[204:207], 0
    v_mfma_f32_16x16x32_bf16 v[24:27], v[20:23], v[208:211], v[24:27]
    v_mfma_f32_16x16x32_bf16 v[28:31], v[16:19], v[212:215], 0
    v_add_f32 v60, v60, v61
    v_cvt_pk_bf16_f32 v251, v56, v60
    v_mfma_f32_16x16x32_bf16 v[28:31], v[20:23], v[216:219], v[28:31]
    buffer_store_dwordx2 v[250:251], v241, s[8:11], s26 offen offset:2560 sc0 sc1
    v_mfma_f32_16x16x32_bf16 v[40:43], v[32:35], v[204:207], 0
    v_cvt_pk_bf16_f32 v101, v8, v12
    v_cvt_pk_bf16_f32 v103, v9, v13
    v_mfma_f32_16x16x32_bf16 v[40:43], v[36:39], v[208:211], v[40:43]
    buffer_store_dwordx2 v[100:101], v233, s[8:11], s20 offen offset:256 sc0 sc1
    v_cvt_pk_bf16_f32 v105, v10, v14
    v_mfma_f32_16x16x32_bf16 v[44:47], v[32:35], v[212:215], 0
    v_cvt_pk_bf16_f32 v107, v11, v15
    v_cvt_pk_bf16_f32 v109, v24, v28
    v_mfma_f32_16x16x32_bf16 v[44:47], v[36:39], v[216:219], v[44:47]
    buffer_store_dwordx2 v[102:103], v233, s[8:11], s21 offen offset:256 sc0 sc1
    v_cvt_pk_bf16_f32 v111, v25, v29
    v_cvt_pk_bf16_f32 v113, v26, v30
    v_cvt_pk_bf16_f32 v115, v27, v31
    buffer_store_dwordx2 v[104:105], v233, s[8:11], s22 offen offset:256 sc0 sc1
    buffer_store_dwordx2 v[106:107], v233, s[8:11], s23 offen offset:256 sc0 sc1
    buffer_store_dwordx2 v[108:109], v233, s[8:11], s24 offen offset:256 sc0 sc1
    buffer_store_dwordx2 v[110:111], v233, s[8:11], s25 offen offset:256 sc0 sc1
    v_cvt_pk_bf16_f32 v141, v40, v44
    v_cvt_pk_bf16_f32 v143, v41, v45
    v_cvt_pk_bf16_f32 v145, v42, v46
    v_cvt_pk_bf16_f32 v147, v43, v47
    buffer_store_dwordx2 v[112:113], v233, s[8:11], s26 offen offset:256 sc0 sc1
    buffer_store_dwordx2 v[114:115], v235, s[8:11], s20 offen offset:1792 sc0 sc1
    buffer_store_dwordx2 v[140:141], v235, s[8:11], s20 offen offset:2176 sc0 sc1
    buffer_store_dwordx2 v[142:143], v235, s[8:11], s20 offen offset:2560 sc0 sc1
    buffer_store_dwordx2 v[144:145], v237, s[8:11], s24 offen offset:1792 sc0 sc1
    buffer_store_dwordx2 v[146:147], v239, s[8:11], s24 offen offset:256 sc0 sc1
    v_lshrrev_b32 v242, 2, v220
    v_mov_b32 v243, 0
    s_mov_b64 exec, 0xff
    buffer_store_dword v243, v242, s[80:83], s3 offen
    s_mov_b64 exec, -1
    s_endpgm

L_main_done:
    s_endpgm
L_again:
    s_waitcnt vmcnt(0) lgkmcnt(0)
    v_accvgpr_write_b32 a240, v249
    s_mov_b32 s27, 0x4000
L_ag_loop:
    v_mov_b32 v249, 0
    buffer_load_dwordx4 v[124:127], v100, s[12:15], 0 offen offset:0 sc1
    buffer_load_dwordx4 v[128:131], v100, s[12:15], 0 offen offset:1024 sc1
    buffer_load_dwordx4 v[132:135], v100, s[12:15], 0 offen offset:2048 sc1
    buffer_load_dwordx4 v[136:139], v101, s[12:15], 0 offen offset:0 sc1
    buffer_load_dwordx4 v[140:143], v101, s[12:15], 0 offen offset:1024 sc1
    buffer_load_dwordx4 v[144:147], v101, s[12:15], 0 offen offset:2048 sc1
    buffer_load_dwordx4 v[148:151], v102, s[12:15], 0 offen offset:0 sc1
    buffer_load_dwordx4 v[152:155], v102, s[12:15], 0 offen offset:1024 sc1
    buffer_load_dwordx4 v[156:159], v102, s[12:15], 0 offen offset:2048 sc1
    buffer_load_dwordx4 v[160:163], v103, s[12:15], 0 offen offset:0 sc1
    buffer_load_dwordx4 v[164:167], v103, s[12:15], 0 offen offset:1024 sc1
    buffer_load_dwordx4 v[168:171], v103, s[12:15], 0 offen offset:2048 sc1
    buffer_load_dwordx4 v[172:175], v104, s[12:15], 0 offen offset:0 sc1
    buffer_load_dwordx4 v[176:179], v104, s[12:15], 0 offen offset:1024 sc1
    buffer_load_dwordx4 v[180:183], v104, s[12:15], 0 offen offset:2048 sc1
    buffer_load_dwordx4 v[184:187], v105, s[12:15], 0 offen offset:0 sc1
    buffer_load_dwordx4 v[188:191], v105, s[12:15], 0 offen offset:1024 sc1
    buffer_load_dwordx4 v[192:195], v105, s[12:15], 0 offen offset:2048 sc1
    s_waitcnt vmcnt(0)
    v_max3_u32 v249, v249, v124, v125
    v_max3_u32 v249, v249, v126, v127
    v_max3_u32 v249, v249, v128, v129
    v_max3_u32 v249, v249, v130, v131
    v_max3_u32 v249, v249, v132, v133
    v_max3_u32 v249, v249, v134, v135
    v_max3_u32 v249, v249, v136, v137
    v_max3_u32 v249, v249, v138, v139
    v_max3_u32 v249, v249, v140, v141
    v_max3_u32 v249, v249, v142, v143
    v_max3_u32 v249, v249, v144, v145
    v_max3_u32 v249, v249, v146, v147
    v_max3_u32 v249, v249, v148, v149
    v_max3_u32 v249, v249, v150, v151
    v_max3_u32 v249, v249, v152, v153
    v_max3_u32 v249, v249, v154, v155
    v_max3_u32 v249, v249, v156, v157
    v_max3_u32 v249, v249, v158, v159
    v_max3_u32 v249, v249, v160, v161
    v_max3_u32 v249, v249, v162, v163
    v_max3_u32 v249, v249, v164, v165
    v_max3_u32 v249, v249, v166, v167
    v_max3_u32 v249, v249, v168, v169
    v_max3_u32 v249, v249, v170, v171
    v_max3_u32 v249, v249, v172, v173
    v_max3_u32 v249, v249, v174, v175
    v_max3_u32 v249, v249, v176, v177
    v_max3_u32 v249, v249, v178, v179
    v_max3_u32 v249, v249, v180, v181
    v_max3_u32 v249, v249, v182, v183
    v_max3_u32 v249, v249, v184, v185
    v_max3_u32 v249, v249, v186, v187
    v_max3_u32 v249, v249, v188, v189
    v_max3_u32 v249, v249, v190, v191
    v_max3_u32 v249, v249, v192, v193
    v_max3_u32 v249, v249, v194, v195
    v_cmp_eq_u32 vcc, -1, v249
    s_sub_u32 s27, s27, 1
    s_cbranch_scc1 L_ag_x
    s_nop 1
    s_cbranch_vccnz L_ag_loop
L_ag_x:
    ds_write_b128 v100, v[124:127] offset:0
    ds_write_b128 v100, v[128:131] offset:1024
    ds_write_b128 v100, v[132:135] offset:2048
    ds_write_b128 v101, v[136:139] offset:0
    ds_write_b128 v101, v[140:143] offset:1024
    ds_write_b128 v101, v[144:147] offset:2048
    ds_write_b128 v102, v[148:151] offset:0
    ds_write_b128 v102, v[152:155] offset:1024
    ds_write_b128 v102, v[156:159] offset:2048
    ds_write_b128 v103, v[160:163] offset:0
    ds_write_b128 v103, v[164:167] offset:1024
    ds_write_b128 v103, v[168:171] offset:2048
    ds_write_b128 v104, v[172:175] offset:0
    ds_write_b128 v104, v[176:179] offset:1024
    ds_write_b128 v104, v[180:183] offset:2048
    ds_write_b128 v105, v[184:187] offset:0
    ds_write_b128 v105, v[188:191] offset:1024
    ds_write_b128 v105, v[192:195] offset:2048
    s_waitcnt lgkmcnt(0)
    v_mov_b32 v131, 0
    v_mov_b32 v139, 0
    v_mov_b32 v147, 0
    v_mov_b32 v155, 0
    v_mov_b32 v163, 0
    v_mov_b32 v171, 0
    v_mov_b32 v179, 0
    v_mov_b32 v187, 0
    v_mov_b32 v195, 0
    v_mov_b32 v203, 0
    v_mov_b32 v211, 0
    v_mov_b32 v219, 0
    v_accvgpr_read_b32 v249, a240
    s_nop 4
    s_cmp_eq_u32 s38, 0
    s_cbranch_scc1 L_back0
    s_cmp_eq_u32 s38, 1
    s_cbranch_scc1 L_back1
    s_cmp_eq_u32 s38, 2
    s_cbranch_scc1 L_back2
    s_branch L_back3
L_alone:
    s_waitcnt vmcnt(0) lgkmcnt(0)
    s_lshl_b32 s42, s2, 2
    s_add_u32 s42, s42, s38
    s_mul_i32 s42, s42, 147456
    s_add_u32 s42, s42, 8388608
    s_add_u32 s12, s34, s42
    s_addc_u32 s13, s35, 0
    s_and_b32 s13, s13, 0xffff
    s_mov_b32 s14, 147456
    s_mov_b32 s15, 0x20000
    s_mov_b32 s56, s94
    s_and_b32 s57, s95, 0xffff
    s_mov_b32 s58, 221184
    s_mov_b32 s59, 0x20000
    s_mov_b32 s60, s96
    s_and_b32 s61, s97, 0xffff
    s_mov_b32 s62, 73728
    s_mov_b32 s63, 0x20000
    v_lshrrev_b32 v5, 2, v3
    v_and_b32 v6, 3, v3
    v_lshl_add_u32 v5, v5, 3, v6
    v_mul_u32_u24 v5, 0x480, v5
    v_lshl_add_u32 v5, v4, 4, v5
    s_mov_b32 s30, 0
L_al_loop:
    s_cmp_ge_u32 s30, 18
    s_cselect_b32 s45, 1, 0
    s_cselect_b32 s42, 18, 0
    s_sub_u32 s44, s30, s42
    s_lshr_b32 s42, s75, 10
    s_add_u32 s44, s44, s42
    s_sub_u32 s42, s44, 72
    s_cselect_b32 s44, s44, s42
    s_mul_i32 s46, s44, 43
    s_lshr_b32 s46, s46, 8
    s_mul_i32 s47, s46, 6
    s_sub_u32 s47, s44, s47
    s_mul_i32 s42, s45, 72
    s_add_u32 s44, s44, s42
    s_lshl_b32 s101, s44, 10
    s_mul_i32 s42, s47, 36864
    s_mul_i32 s43, s45, 768
    s_add_u32 s42, s42, s43
    s_add_u32 s43, s42, 4608
    buffer_load_dwordx4 v[128:131], v5, s[56:59], s42 offen offset:0
    buffer_load_dwordx4 v[152:155], v5, s[56:59], s43 offen offset:0
    buffer_load_dwordx4 v[132:135], v5, s[56:59], s42 offen offset:64
    buffer_load_dwordx4 v[156:159], v5, s[56:59], s43 offen offset:64
    buffer_load_dwordx4 v[136:139], v5, s[56:59], s42 offen offset:128
    buffer_load_dwordx4 v[160:163], v5, s[56:59], s43 offen offset:128
    buffer_load_dwordx4 v[140:143], v5, s[56:59], s42 offen offset:192
    buffer_load_dwordx4 v[164:167], v5, s[56:59], s43 offen offset:192
    buffer_load_dwordx4 v[144:147], v5, s[56:59], s42 offen offset:256
    buffer_load_dwordx4 v[168:171], v5, s[56:59], s43 offen offset:256
    buffer_load_dwordx4 v[148:151], v5, s[56:59], s42 offen offset:320
    buffer_load_dwordx4 v[172:175], v5, s[56:59], s43 offen offset:320
    s_cmp_eq_u32 s45, 1
    s_cbranch_scc1 L_al_n
    s_lshr_b32 s42, s46, 1
    s_mul_i32 s42, s42, 36864
    s_and_b32 s43, s46, 1
    s_mul_i32 s43, s43, 4608
    s_add_u32 s42, s42, s43
    s_add_u32 s42, s42, 384
    buffer_load_dwordx4 v[176:179], v5, s[56:59], s42 offen offset:0
    buffer_load_dwordx4 v[180:183], v5, s[56:59], s42 offen offset:64
    buffer_load_dwordx4 v[184:187], v5, s[56:59], s42 offen offset:128
    buffer_load_dwordx4 v[188:191], v5, s[56:59], s42 offen offset:192
    buffer_load_dwordx4 v[192:195], v5, s[56:59], s42 offen offset:256
    buffer_load_dwordx4 v[196:199], v5, s[56:59], s42 offen offset:320
    s_mov_b32 s100, 0x3dd53b95
    s_waitcnt vmcnt(0)
    s_branch L_al_mm
L_al_n:
    s_mov_b32 s42, 2
    s_lshr_b32 s43, s46, 2
    s_mul_i32 s43, s43, 60
    s_add_u32 s43, s43, s46
    v_lshlrev_b32 v6, s42, v3
    v_add_u32 v6, s43, v6
    v_lshlrev_b32 v6, 1, v6
    v_mul_u32_u24 v7, 0xc00, v4
    v_add_u32 v6, v6, v7
    s_mov_b32 s27, 0
    buffer_load_ushort v32, v6, s[60:63], s27 offen offset:0
    buffer_load_ushort v33, v6, s[60:63], s27 offen offset:384
    buffer_load_ushort v34, v6, s[60:63], s27 offen offset:768
    buffer_load_ushort v35, v6, s[60:63], s27 offen offset:1152
    buffer_load_ushort v36, v6, s[60:63], s27 offen offset:1536
    buffer_load_ushort v37, v6, s[60:63], s27 offen offset:1920
    buffer_load_ushort v38, v6, s[60:63], s27 offen offset:2304
    buffer_load_ushort v39, v6, s[60:63], s27 offen offset:2688
    s_mov_b32 s27, 12288
    buffer_load_ushort v40, v6, s[60:63], s27 offen offset:0
    buffer_load_ushort v41, v6, s[60:63], s27 offen offset:384
    buffer_load_ushort v42, v6, s[60:63], s27 offen offset:768
    buffer_load_ushort v43, v6, s[60:63], s27 offen offset:1152
    buffer_load_ushort v44, v6, s[60:63], s27 offen offset:1536
    buffer_load_ushort v45, v6, s[60:63], s27 offen offset:1920
    buffer_load_ushort v46, v6, s[60:63], s27 offen offset:2304
    buffer_load_ushort v47, v6, s[60:63], s27 offen offset:2688
    s_mov_b32 s27, 24576
    buffer_load_ushort v48, v6, s[60:63], s27 offen offset:0
    buffer_load_ushort v49, v6, s[60:63], s27 offen offset:384
    buffer_load_ushort v50, v6, s[60:63], s27 offen offset:768
    buffer_load_ushort v51, v6, s[60:63], s27 offen offset:1152
    buffer_load_ushort v52, v6, s[60:63], s27 offen offset:1536
    buffer_load_ushort v53, v6, s[60:63], s27 offen offset:1920
    buffer_load_ushort v54, v6, s[60:63], s27 offen offset:2304
    buffer_load_ushort v55, v6, s[60:63], s27 offen offset:2688
    s_mov_b32 s27, 36864
    buffer_load_ushort v56, v6, s[60:63], s27 offen offset:0
    buffer_load_ushort v57, v6, s[60:63], s27 offen offset:384
    buffer_load_ushort v58, v6, s[60:63], s27 offen offset:768
    buffer_load_ushort v59, v6, s[60:63], s27 offen offset:1152
    buffer_load_ushort v60, v6, s[60:63], s27 offen offset:1536
    buffer_load_ushort v61, v6, s[60:63], s27 offen offset:1920
    buffer_load_ushort v62, v6, s[60:63], s27 offen offset:2304
    buffer_load_ushort v63, v6, s[60:63], s27 offen offset:2688
    s_mov_b32 s27, 49152
    buffer_load_ushort v64, v6, s[60:63], s27 offen offset:0
    buffer_load_ushort v65, v6, s[60:63], s27 offen offset:384
    buffer_load_ushort v66, v6, s[60:63], s27 offen offset:768
    buffer_load_ushort v67, v6, s[60:63], s27 offen offset:1152
    buffer_load_ushort v68, v6, s[60:63], s27 offen offset:1536
    buffer_load_ushort v69, v6, s[60:63], s27 offen offset:1920
    buffer_load_ushort v70, v6, s[60:63], s27 offen offset:2304
    buffer_load_ushort v71, v6, s[60:63], s27 offen offset:2688
    s_mov_b32 s27, 61440
    buffer_load_ushort v72, v6, s[60:63], s27 offen offset:0
    buffer_load_ushort v73, v6, s[60:63], s27 offen offset:384
    buffer_load_ushort v74, v6, s[60:63], s27 offen offset:768
    buffer_load_ushort v75, v6, s[60:63], s27 offen offset:1152
    buffer_load_ushort v76, v6, s[60:63], s27 offen offset:1536
    buffer_load_ushort v77, v6, s[60:63], s27 offen offset:1920
    buffer_load_ushort v78, v6, s[60:63], s27 offen offset:2304
    buffer_load_ushort v79, v6, s[60:63], s27 offen offset:2688
    s_mov_b32 s100, 1.0
    s_waitcnt vmcnt(0)
    v_lshl_or_b32 v176, v33, 16, v32
    v_lshl_or_b32 v177, v35, 16, v34
    v_lshl_or_b32 v178, v37, 16, v36
    v_lshl_or_b32 v179, v39, 16, v38
    v_lshl_or_b32 v180, v41, 16, v40
    v_lshl_or_b32 v181, v43, 16, v42
    v_lshl_or_b32 v182, v45, 16, v44
    v_lshl_or_b32 v183, v47, 16, v46
    v_lshl_or_b32 v184, v49, 16, v48
    v_lshl_or_b32 v185, v51, 16, v50
    v_lshl_or_b32 v186, v53, 16, v52
    v_lshl_or_b32 v187, v55, 16, v54
    v_lshl_or_b32 v188, v57, 16, v56
    v_lshl_or_b32 v189, v59, 16, v58
    v_lshl_or_b32 v190, v61, 16, v60
    v_lshl_or_b32 v191, v63, 16, v62
    v_lshl_or_b32 v192, v65, 16, v64
    v_lshl_or_b32 v193, v67, 16, v66
    v_lshl_or_b32 v194, v69, 16, v68
    v_lshl_or_b32 v195, v71, 16, v70
    v_lshl_or_b32 v196, v73, 16, v72
    v_lshl_or_b32 v197, v75, 16, v74
    v_lshl_or_b32 v198, v77, 16, v76
    v_lshl_or_b32 v199, v79, 16, v78
L_al_mm:
    s_nop 1
    v_mfma_f32_16x16x32_bf16 v[200:203], v[128:131], v[176:179], 0
    v_mfma_f32_16x16x32_bf16 v[204:207], v[152:155], v[176:179], 0
    v_mfma_f32_16x16x32_bf16 v[200:203], v[132:135], v[180:183], v[200:203]
    v_mfma_f32_16x16x32_bf16 v[204:207], v[156:159], v[180:183], v[204:207]
    v_mfma_f32_16x16x32_bf16 v[200:203], v[136:139], v[184:187], v[200:203]
    v_mfma_f32_16x16x32_bf16 v[204:207], v[160:163], v[184:187], v[204:207]
    v_mfma_f32_16x16x32_bf16 v[200:203], v[140:143], v[188:191], v[200:203]
    v_mfma_f32_16x16x32_bf16 v[204:207], v[164:167], v[188:191], v[204:207]
    v_mfma_f32_16x16x32_bf16 v[200:203], v[144:147], v[192:195], v[200:203]
    v_mfma_f32_16x16x32_bf16 v[204:207], v[168:171], v[192:195], v[204:207]
    v_mfma_f32_16x16x32_bf16 v[200:203], v[148:151], v[196:199], v[200:203]
    v_mfma_f32_16x16x32_bf16 v[204:207], v[172:175], v[196:199], v[204:207]
    s_nop 6
    v_mul_f32 v200, s100, v200
    v_mul_f32 v201, s100, v201
    v_mul_f32 v202, s100, v202
    v_mul_f32 v203, s100, v203
    v_mul_f32 v204, s100, v204
    v_mul_f32 v205, s100, v205
    v_mul_f32 v206, s100, v206
    v_mul_f32 v207, s100, v207
    v_cvt_pk_bf16_f32 v216, v200, v201
    v_min_u32 v216, -2, v216
    v_cvt_pk_bf16_f32 v217, v202, v203
    v_min_u32 v217, -2, v217
    v_cvt_pk_bf16_f32 v218, v204, v205
    v_min_u32 v218, -2, v218
    v_cvt_pk_bf16_f32 v219, v206, v207
    v_min_u32 v219, -2, v219
    buffer_store_dwordx4 v[216:219], v220, s[12:15], s101 offen sc1
    s_waitcnt vmcnt(0)
    s_add_u32 s30, s30, 1
    s_cmp_lt_u32 s30, 36
    s_cbranch_scc1 L_al_loop
    v_mov_b32 v29, 0
    s_mov_b32 s37, 0x10000
    s_mov_b32 s19, 0
    s_branch L_ldm
.section .rodata,"a"
.p2align 6
.amdhsa_kernel standalone__swin_window_attn__vision_kernel
  .amdhsa_next_free_vgpr 512
  .amdhsa_next_free_sgpr 102
  .amdhsa_accum_offset 256
  .amdhsa_group_segment_fixed_size 0
  .amdhsa_kernarg_size 48
  .amdhsa_user_sgpr_count 2
  .amdhsa_user_sgpr_kernarg_segment_ptr 1
  .amdhsa_system_sgpr_workgroup_id_x 1
.end_amdhsa_kernel
```
